```python
import torch

def _softmax(x, axis=-1):
    return torch.softmax(x, dim=axis)
def _gelu(x):
    return torch.nn.functional.gelu(x, approximate="tanh")
def _silu(x):
    return torch.nn.functional.silu(x)
def _sigmoid(x):
    return torch.sigmoid(x)
def _layernorm(x, axis=-1, eps=1e-5):
    m = x.mean(dim=axis, keepdim=True)
    v = x.var(dim=axis, keepdim=True, unbiased=False)
    return (x - m) / torch.sqrt(v + eps)
def _scatter_add(tgt, idx, src, axis=0):
    return tgt.clone().index_add_(axis, idx, src)
def _segment_sum(src, seg, n):
    out = torch.zeros((n,) + src.shape[1:], dtype=src.dtype)
    return out.index_add_(0, seg, src)
def _pad(x, pw):
    flat = tuple(v for pair in reversed(pw) for v in pair)
    return torch.nn.functional.pad(x, flat)

kernel_name = 'sequential_preLN__mha_block__glu_gated_reglu__prompt'

def setup_inputs():

    _w = (lambda a: (lambda t: t.to(torch.bfloat16) if t.is_floating_point() else t)(torch.as_tensor(a)))
    def _A_setup():
        B, S, D, H = 1, 2048, 640, 32
        return {
            "x": _w((lambda *s: torch.randn(*s, dtype=torch.bfloat16) * 0.05)(B, S, D)),
            "wqkv": _w((lambda *s: torch.randn(*s, dtype=torch.bfloat16) * 0.05)(D, 3 * D)),
            "wo": _w((lambda *s: torch.randn(*s, dtype=torch.bfloat16) * 0.05)(D, D)),
        }
    _A_in = _A_setup()

    def _B_setup():
        B, S, D, F = 1, 2048, 640, 1728
        return {
            "x": _w((lambda *s: torch.randn(*s, dtype=torch.bfloat16) * 0.05)(B, S, D)),
            "W_gate": _w((lambda *s: torch.randn(*s, dtype=torch.bfloat16) * 0.4)(D, F) * (2.0 / D) ** 0.5),
            "W_up": _w((lambda *s: torch.randn(*s, dtype=torch.bfloat16) * 0.4)(D, F) * (2.0 / D) ** 0.5),
            "W_down": _w((lambda *s: torch.randn(*s, dtype=torch.bfloat16) * 0.4)(F, D) * (1.0 / F) ** 0.5),
        }
    _B_in = _B_setup()

    return {
        "A_x": _A_in["x"],
        "A_wqkv": _A_in["wqkv"],
        "A_wo": _A_in["wo"],
        "B_x": _B_in["x"],
        "B_W_gate": _B_in["W_gate"],
        "B_W_up": _B_in["W_up"],
        "B_W_down": _B_in["W_down"],
    }

def reference(A_x, A_wqkv, A_wo, B_x, B_W_gate, B_W_up, B_W_down):
    def _A_ref(x, wqkv, wo):
        B, S, D = x.shape
        H = 32
        Dh = D // H
        qkv = (lambda x, *d: x.permute(*d))((x @ wqkv).reshape(B, S, 3, H, Dh), 2, 0, 3, 1, 4)
        q, k, v = qkv[0], qkv[1], qkv[2]
        scores = torch.einsum("bhqd,bhkd->bhqk", q, k) * (Dh ** -0.5)
        p = _softmax(scores, axis=-1)
        o = torch.einsum("bhqk,bhkd->bhqd", p, v)
        return (lambda x, *d: x.permute(*d))(o, 0, 2, 1, 3).reshape(B, S, D) @ wo

    def _B_ref(x, W_gate, W_up, W_down):
        gate = torch.einsum("bsd,df->bsf", x, W_gate)
        up = torch.einsum("bsd,df->bsf", x, W_up)
        gate = gate * (lambda x, dt: x.to(dt))(gate > 0, gate.dtype)
        h = gate * up
        return torch.einsum("bsf,fd->bsd", h, W_down)

    x = A_x
    h = x + _A_ref(_layernorm(x, axis=-1), A_wqkv, A_wo)
    h2 = h + _B_ref(_layernorm(h, axis=-1), B_W_gate, B_W_up, B_W_down)
    return h2
```

```asm
; @launch kernel=s1_qkv_kernel grid=(256,1,1) block=(512,1,1) lds=163840
; @launch kernel=s2_att_kernel grid=(256,1,1) block=(512,1,1) lds=163840
; @launch kernel=s3_wo_kernel grid=(256,1,1) block=(384,1,1) lds=157696
; @launch kernel=s4_gu_kernel grid=(256,1,1) block=(384,1,1) lds=158720
; @launch kernel=s5_dn_kernel grid=(256,1,1) block=(384,1,1) lds=147456
.amdgcn_target "amdgcn-amd-amdhsa--gfx950"
.text
.globl s1_qkv_kernel
.p2align 8
.type s1_qkv_kernel,@function
s1_qkv_kernel:
  s_cmp_ge_u32 s2, 256
  s_cbranch_scc1 s1_qkv_end_1
  s_load_dwordx4 s[4:7], s[0:1], 0
  s_load_dwordx2 s[8:9], s[0:1], 72
  s_and_b32 s10, s2, 7
  s_lshr_b32 s11, s2, 3
  s_lshr_b32 s24, s10, 1
  s_lshl_b32 s24, s24, 2
  s_and_b32 s3, s11, 3
  s_add_u32 s24, s24, s3
  s_and_b32 s25, s10, 1
  s_lshl_b32 s25, s25, 3
  s_lshr_b32 s3, s11, 2
  s_add_u32 s25, s25, s3
  s_cmp_ge_u32 s25, 15
  s_cbranch_scc1 s1_qkv_woj_2
  v_lshrrev_b32 v1, 6, v0
  v_and_b32 v0, 63, v0
  v_readfirstlane_b32 s26, v1
  v_lshrrev_b32 v2, 3, v0
  v_lshrrev_b32 v3, 4, v0
  v_and_b32 v4, 7, v0
  s_cmp_lt_u32 s26, 4
  s_cbranch_scc1 s1_qkv_c_3
  s_sub_u32 s27, s26, 4
  s_lshl_b32 s29, s27, 12
  s_lshl_b32 s3, s24, 7
  s_lshl_b32 s10, s27, 5
  s_add_u32 s3, s3, s10
  v_add_u32 v5, s3, v2
  s_movk_i32 s10, 1280
  v_mul_lo_u32 v5, v5, s10
  v_add_u32 v6, 0, v3
  v_and_b32 v6, 7, v6
  v_xor_b32 v6, v6, v4
  v_lshl_add_u32 v6, v6, 4, v5
  v_add_u32 v206, 0, v6
  v_add_u32 v6, 4, v3
  v_and_b32 v6, 7, v6
  v_xor_b32 v6, v6, v4
  v_lshl_add_u32 v6, v6, 4, v5
  v_add_u32 v207, 9216, v6
  v_add_u32 v6, 8, v3
  v_and_b32 v6, 7, v6
  v_xor_b32 v6, v6, v4
  v_lshl_add_u32 v6, v6, 4, v5
  v_add_u32 v208, 18432, v6
  v_add_u32 v6, 12, v3
  v_and_b32 v6, 7, v6
  v_xor_b32 v6, v6, v4
  v_lshl_add_u32 v6, v6, 4, v5
  v_add_u32 v209, 27648, v6
  s_lshl_b32 s3, s27, 4
  v_add_u32 v5, s3, v3
  s_movk_i32 s10, 3840
  v_mul_lo_u32 v5, v5, s10
  v_and_b32 v6, 15, v0
  v_lshlrev_b32 v7, 2, v3
  v_xor_b32 v6, v6, v7
  v_lshl_add_u32 v5, v6, 4, v5
  s_lshl_b32 s3, s25, 8
  v_add_u32 v5, s3, v5
  v_add_u32 v210, 0, v5
  v_add_u32 v211, 14336, v5
  v_add_u32 v212, 28672, v5
  v_add_u32 v213, 43008, v5
  s_waitcnt lgkmcnt(0)
  s_mov_b32 s12, s4
  s_and_b32 s13, s5, 0xffff
  s_mov_b32 s14, 0x280000
  s_mov_b32 s15, 0x00020000
  s_mov_b32 s16, s6
  s_and_b32 s17, s7, 0xffff
  s_mov_b32 s18, 0x258000
  s_mov_b32 s19, 0x00020000
  s_add_u32 m0, s29, 0
  s_mov_b32 s30, 0
  buffer_load_dwordx4 v206, s[12:15], s30 offen offset:0  lds
  buffer_load_dwordx4 v207, s[12:15], s30 offen offset:1024  lds
  buffer_load_dwordx4 v208, s[12:15], s30 offen offset:2048  lds
  buffer_load_dwordx4 v209, s[12:15], s30 offen offset:3072  lds
  s_add_u32 m0, s29, 16384
  s_mov_b32 s31, 0
  buffer_load_dwordx4 v210, s[16:19], s31 offen offset:0  lds
  buffer_load_dwordx4 v211, s[16:19], s31 offen offset:1024  lds
  buffer_load_dwordx4 v212, s[16:19], s31 offen offset:2048  lds
  buffer_load_dwordx4 v213, s[16:19], s31 offen offset:3072  lds
  s_and_b32 s10, s2, 7
  s_lshr_b32 s3, s10, 1
  s_lshl_b32 s3, s3, 9
  s_lshl_b32 s32, s11, 4
  s_add_u32 s3, s3, s32
  s_lshl_b32 s32, s27, 2
  s_add_u32 s3, s3, s32
  v_and_b32 v8, 3, v0
  v_add_u32 v8, s3, v8
  v_mul_u32_u24 v8, 1280, v8
  v_lshrrev_b32 v9, 2, v0
  v_lshl_add_u32 v8, v9, 7, v8
  s_lshl_b32 s3, s11, 1
  s_lshr_b32 s32, s27, 1
  s_add_u32 s3, s3, s32
  s_mul_i32 s3, s3, 3840
  s_and_b32 s32, s10, 1
  s_lshl_b32 s32, s32, 11
  s_add_u32 s3, s3, s32
  s_and_b32 s32, s27, 1
  s_lshl_b32 s32, s32, 10
  s_add_u32 s3, s3, s32
  v_mov_b32 v10, 245760
  v_mul_lo_u32 v9, v2, v10
  v_lshl_add_u32 v9, v4, 7, v9
  v_add_u32 v9, s3, v9
  s_mov_b64 exec, 0xfff
  s_movk_i32 s32, 128
  buffer_load_dword v10, v8, s[12:15], s32 offen
  s_mov_b64 exec, 0xffffff
  s_mov_b32 s32, 245760
  buffer_load_dword v11, v9, s[16:19], s32 offen
  s_mov_b64 exec, -1
  s_waitcnt vmcnt(2)
  s_barrier
  s_add_u32 m0, s29, 32768
  s_mov_b32 s30, 128
  buffer_load_dwordx4 v206, s[12:15], s30 offen offset:0  lds
  buffer_load_dwordx4 v207, s[12:15], s30 offen offset:1024  lds
  buffer_load_dwordx4 v208, s[12:15], s30 offen offset:2048  lds
  buffer_load_dwordx4 v209, s[12:15], s30 offen offset:3072  lds
  s_add_u32 m0, s29, 49152
  s_mov_b32 s31, 245760
  buffer_load_dwordx4 v210, s[16:19], s31 offen offset:0  lds
  buffer_load_dwordx4 v211, s[16:19], s31 offen offset:1024  lds
  buffer_load_dwordx4 v212, s[16:19], s31 offen offset:2048  lds
  buffer_load_dwordx4 v213, s[16:19], s31 offen offset:3072  lds
  s_mov_b64 exec, 0xfff
  s_movk_i32 s32, 512
  buffer_load_dword v10, v8, s[12:15], s32 offen
  s_mov_b64 exec, 0xffffff
  s_mov_b32 s32, 983040
  buffer_load_dword v11, v9, s[16:19], s32 offen
  s_mov_b64 exec, -1
  s_waitcnt vmcnt(2)
  s_barrier
  s_add_u32 m0, s29, 65536
  s_mov_b32 s30, 256
  buffer_load_dwordx4 v206, s[12:15], s30 offen offset:0  lds
  buffer_load_dwordx4 v207, s[12:15], s30 offen offset:1024  lds
  buffer_load_dwordx4 v208, s[12:15], s30 offen offset:2048  lds
  buffer_load_dwordx4 v209, s[12:15], s30 offen offset:3072  lds
  s_add_u32 m0, s29, 81920
  s_mov_b32 s31, 491520
  buffer_load_dwordx4 v210, s[16:19], s31 offen offset:0  lds
  buffer_load_dwordx4 v211, s[16:19], s31 offen offset:1024  lds
  buffer_load_dwordx4 v212, s[16:19], s31 offen offset:2048  lds
  buffer_load_dwordx4 v213, s[16:19], s31 offen offset:3072  lds
  s_mov_b64 exec, 0xfff
  s_movk_i32 s32, 896
  buffer_load_dword v10, v8, s[12:15], s32 offen
  s_mov_b64 exec, 0xffffff
  s_mov_b32 s32, 1720320
  buffer_load_dword v11, v9, s[16:19], s32 offen
  s_mov_b64 exec, -1
  s_waitcnt vmcnt(2)
  s_barrier
  s_add_u32 m0, s29, 98304
  s_mov_b32 s30, 384
  buffer_load_dwordx4 v206, s[12:15], s30 offen offset:0  lds
  buffer_load_dwordx4 v207, s[12:15], s30 offen offset:1024  lds
  buffer_load_dwordx4 v208, s[12:15], s30 offen offset:2048  lds
  buffer_load_dwordx4 v209, s[12:15], s30 offen offset:3072  lds
  s_add_u32 m0, s29, 114688
  s_mov_b32 s31, 737280
  buffer_load_dwordx4 v210, s[16:19], s31 offen offset:0  lds
  buffer_load_dwordx4 v211, s[16:19], s31 offen offset:1024  lds
  buffer_load_dwordx4 v212, s[16:19], s31 offen offset:2048  lds
  buffer_load_dwordx4 v213, s[16:19], s31 offen offset:3072  lds
  s_add_u32 m0, s29, 131072
  s_mov_b32 s30, 512
  buffer_load_dwordx4 v206, s[12:15], s30 offen offset:0  lds
  buffer_load_dwordx4 v207, s[12:15], s30 offen offset:1024  lds
  buffer_load_dwordx4 v208, s[12:15], s30 offen offset:2048  lds
  buffer_load_dwordx4 v209, s[12:15], s30 offen offset:3072  lds
  s_add_u32 m0, s29, 147456
  s_mov_b32 s31, 983040
  buffer_load_dwordx4 v210, s[16:19], s31 offen offset:0  lds
  buffer_load_dwordx4 v211, s[16:19], s31 offen offset:1024  lds
  buffer_load_dwordx4 v212, s[16:19], s31 offen offset:2048  lds
  buffer_load_dwordx4 v213, s[16:19], s31 offen offset:3072  lds
  s_waitcnt vmcnt(8)
  s_barrier
  s_add_u32 m0, s29, 0
  s_mov_b32 s30, 640
  buffer_load_dwordx4 v206, s[12:15], s30 offen offset:0  lds
  buffer_load_dwordx4 v207, s[12:15], s30 offen offset:1024  lds
  buffer_load_dwordx4 v208, s[12:15], s30 offen offset:2048  lds
  buffer_load_dwordx4 v209, s[12:15], s30 offen offset:3072  lds
  s_add_u32 m0, s29, 16384
  s_mov_b32 s31, 1228800
  buffer_load_dwordx4 v210, s[16:19], s31 offen offset:0  lds
  buffer_load_dwordx4 v211, s[16:19], s31 offen offset:1024  lds
  buffer_load_dwordx4 v212, s[16:19], s31 offen offset:2048  lds
  buffer_load_dwordx4 v213, s[16:19], s31 offen offset:3072  lds
  s_waitcnt vmcnt(8)
  s_barrier
  s_add_u32 m0, s29, 32768
  s_mov_b32 s30, 768
  buffer_load_dwordx4 v206, s[12:15], s30 offen offset:0  lds
  buffer_load_dwordx4 v207, s[12:15], s30 offen offset:1024  lds
  buffer_load_dwordx4 v208, s[12:15], s30 offen offset:2048  lds
  buffer_load_dwordx4 v209, s[12:15], s30 offen offset:3072  lds
  s_add_u32 m0, s29, 49152
  s_mov_b32 s31, 1474560
  buffer_load_dwordx4 v210, s[16:19], s31 offen offset:0  lds
  buffer_load_dwordx4 v211, s[16:19], s31 offen offset:1024  lds
  buffer_load_dwordx4 v212, s[16:19], s31 offen offset:2048  lds
  buffer_load_dwordx4 v213, s[16:19], s31 offen offset:3072  lds
  s_waitcnt vmcnt(8)
  s_barrier
  s_add_u32 m0, s29, 65536
  s_mov_b32 s30, 896
  buffer_load_dwordx4 v206, s[12:15], s30 offen offset:0  lds
  buffer_load_dwordx4 v207, s[12:15], s30 offen offset:1024  lds
  buffer_load_dwordx4 v208, s[12:15], s30 offen offset:2048  lds
  buffer_load_dwordx4 v209, s[12:15], s30 offen offset:3072  lds
  s_add_u32 m0, s29, 81920
  s_mov_b32 s31, 1720320
  buffer_load_dwordx4 v210, s[16:19], s31 offen offset:0  lds
  buffer_load_dwordx4 v211, s[16:19], s31 offen offset:1024  lds
  buffer_load_dwordx4 v212, s[16:19], s31 offen offset:2048  lds
  buffer_load_dwordx4 v213, s[16:19], s31 offen offset:3072  lds
  s_waitcnt vmcnt(8)
  s_barrier
  s_add_u32 m0, s29, 98304
  s_mov_b32 s30, 1024
  buffer_load_dwordx4 v206, s[12:15], s30 offen offset:0  lds
  buffer_load_dwordx4 v207, s[12:15], s30 offen offset:1024  lds
  buffer_load_dwordx4 v208, s[12:15], s30 offen offset:2048  lds
  buffer_load_dwordx4 v209, s[12:15], s30 offen offset:3072  lds
  s_add_u32 m0, s29, 114688
  s_mov_b32 s31, 1966080
  buffer_load_dwordx4 v210, s[16:19], s31 offen offset:0  lds
  buffer_load_dwordx4 v211, s[16:19], s31 offen offset:1024  lds
  buffer_load_dwordx4 v212, s[16:19], s31 offen offset:2048  lds
  buffer_load_dwordx4 v213, s[16:19], s31 offen offset:3072  lds
  s_waitcnt vmcnt(8)
  s_barrier
  s_add_u32 m0, s29, 131072
  s_mov_b32 s30, 1152
  buffer_load_dwordx4 v206, s[12:15], s30 offen offset:0  lds
  buffer_load_dwordx4 v207, s[12:15], s30 offen offset:1024  lds
  buffer_load_dwordx4 v208, s[12:15], s30 offen offset:2048  lds
  buffer_load_dwordx4 v209, s[12:15], s30 offen offset:3072  lds
  s_add_u32 m0, s29, 147456
  s_mov_b32 s31, 2211840
  buffer_load_dwordx4 v210, s[16:19], s31 offen offset:0  lds
  buffer_load_dwordx4 v211, s[16:19], s31 offen offset:1024  lds
  buffer_load_dwordx4 v212, s[16:19], s31 offen offset:2048  lds
  buffer_load_dwordx4 v213, s[16:19], s31 offen offset:3072  lds
  s_waitcnt vmcnt(8)
  s_barrier
  s_waitcnt vmcnt(0)
  s_barrier
  s_barrier
  s_endpgm
s1_qkv_v_4:
  s_lshl_b32 s3, s24, 1
  s_add_u32 s3, s3, s27
  s_mul_i32 s37, s3, 5120
  s_add_u32 s37, s37, 0x280a00
  s_sub_u32 s48, s25, 10
  s_lshl_b32 s48, s48, 7
  s_mov_b32 s36, 163840
  s_mul_i32 s38, s28, 1280
  s_sub_u32 s39, 1280, s38
  v_mul_u32_u24 v16, 320, v9
  s_lshl_b32 s3, s34, 5
  s_add_u32 s3, s3, s48
  v_add_u32 v13, s3, v8
  v_mul_u32_u24 v14, 3277, v13
  v_lshrrev_b32 v14, 16, v14
  v_mul_u32_u24 v15, 20, v14
  v_sub_u32 v15, v13, v15
  v_lshrrev_b32 v16, 2, v15
  v_lshrrev_b32 v17, 3, v15
  v_xor_b32 v17, v17, v16
  v_xor_b32 v17, v17, v9
  v_and_b32 v17, 1, v17
  v_lshl_add_u32 v16, v16, 1, v17
  v_and_b32 v15, 3, v15
  v_lshlrev_b32 v15, 4, v15
  v_lshl_add_u32 v15, v16, 6, v15
  v_mul_lo_u32 v14, v14, s36
  v_add3_u32 v15, v15, v14, s37
  v_add_u32 v214, s38, v15
  v_add_u32 v216, s39, v15
  s_lshl_b32 s3, s35, 5
  s_add_u32 s3, s3, s48
  v_add_u32 v13, s3, v8
  v_mul_u32_u24 v14, 3277, v13
  v_lshrrev_b32 v14, 16, v14
  v_mul_u32_u24 v15, 20, v14
  v_sub_u32 v15, v13, v15
  v_lshrrev_b32 v16, 2, v15
  v_lshrrev_b32 v17, 3, v15
  v_xor_b32 v17, v17, v16
  v_xor_b32 v17, v17, v9
  v_and_b32 v17, 1, v17
  v_lshl_add_u32 v16, v16, 1, v17
  v_and_b32 v15, 3, v15
  v_lshlrev_b32 v15, 4, v15
  v_lshl_add_u32 v15, v16, 6, v15
  v_mul_lo_u32 v14, v14, s36
  v_add3_u32 v15, v15, v14, s37
  v_add_u32 v215, s38, v15
  v_add_u32 v217, s39, v15
  s_barrier
  ds_read_b128 v[144:147], v176 offset:0
  ds_read_b64_tr_b16 v[152:153], v200 offset:0
  ds_read_b64_tr_b16 v[154:155], v200 offset:1024
  ds_read_b64_tr_b16 v[156:157], v201 offset:0
  ds_read_b64_tr_b16 v[158:159], v201 offset:1024
  ds_read_b128 v[148:151], v180 offset:0
  s_waitcnt lgkmcnt(3)
  v_mfma_f32_32x32x16_bf16 v[64:79], v[144:147], v[152:155], v[64:79]
  ds_read_b128 v[160:163], v177 offset:0
  ds_read_b64_tr_b16 v[168:169], v200 offset:4096
  ds_read_b64_tr_b16 v[170:171], v200 offset:5120
  s_waitcnt lgkmcnt(4)
  v_mfma_f32_32x32x16_bf16 v[80:95], v[144:147], v[156:159], v[80:95]
  ds_read_b64_tr_b16 v[172:173], v201 offset:4096
  ds_read_b64_tr_b16 v[174:175], v201 offset:5120
  ds_read_b128 v[164:167], v181 offset:0
  s_waitcnt lgkmcnt(6)
  v_mfma_f32_32x32x16_bf16 v[96:111], v[148:151], v[152:155], v[96:111]
  v_mfma_f32_32x32x16_bf16 v[112:127], v[148:151], v[156:159], v[112:127]
  v_mfma_f32_4x4x4_16b_bf16 v[132:135], v[144:145], v[144:145], v[132:135]
  v_mfma_f32_16x16x32_bf16 v[128:131], v[140:143], v[144:147], v[128:131]
  v_mfma_f32_16x16x32_bf16 v[136:139], v[140:143], v[152:155], v[136:139]
  v_mfma_f32_4x4x4_16b_bf16 v[132:135], v[146:147], v[146:147], v[132:135]
  s_waitcnt lgkmcnt(3)
  v_mfma_f32_32x32x16_bf16 v[64:79], v[160:163], v[168:171], v[64:79]
  ds_read_b128 v[144:147], v178 offset:0
  ds_read_b64_tr_b16 v[152:153], v200 offset:8192
  ds_read_b64_tr_b16 v[154:155], v200 offset:9216
  s_waitcnt lgkmcnt(4)
  v_mfma_f32_32x32x16_bf16 v[80:95], v[160:163], v[172:175], v[80:95]
  ds_read_b64_tr_b16 v[156:157], v201 offset:8192
  ds_read_b64_tr_b16 v[158:159], v201 offset:9216
  ds_read_b128 v[148:151], v182 offset:0
  s_waitcnt lgkmcnt(6)
  v_mfma_f32_32x32x16_bf16 v[96:111], v[164:167], v[168:171], v[96:111]
  v_mfma_f32_32x32x16_bf16 v[112:127], v[164:167], v[172:175], v[112:127]
  v_mfma_f32_4x4x4_16b_bf16 v[132:135], v[160:161], v[160:161], v[132:135]
  v_mfma_f32_16x16x32_bf16 v[128:131], v[140:143], v[160:163], v[128:131]
  v_mfma_f32_16x16x32_bf16 v[136:139], v[140:143], v[168:171], v[136:139]
  v_mfma_f32_4x4x4_16b_bf16 v[132:135], v[162:163], v[162:163], v[132:135]
  s_waitcnt lgkmcnt(3)
  v_mfma_f32_32x32x16_bf16 v[64:79], v[144:147], v[152:155], v[64:79]
  ds_read_b128 v[160:163], v179 offset:0
  ds_read_b64_tr_b16 v[168:169], v200 offset:12288
  ds_read_b64_tr_b16 v[170:171], v200 offset:13312
  s_waitcnt lgkmcnt(4)
  v_mfma_f32_32x32x16_bf16 v[80:95], v[144:147], v[156:159], v[80:95]
  ds_read_b64_tr_b16 v[172:173], v201 offset:12288
  ds_read_b64_tr_b16 v[174:175], v201 offset:13312
  ds_read_b128 v[164:167], v183 offset:0
  s_waitcnt lgkmcnt(6)
  v_mfma_f32_32x32x16_bf16 v[96:111], v[148:151], v[152:155], v[96:111]
  v_mfma_f32_32x32x16_bf16 v[112:127], v[148:151], v[156:159], v[112:127]
  v_mfma_f32_4x4x4_16b_bf16 v[132:135], v[144:145], v[144:145], v[132:135]
  v_mfma_f32_16x16x32_bf16 v[128:131], v[140:143], v[144:147], v[128:131]
  v_mfma_f32_16x16x32_bf16 v[136:139], v[140:143], v[152:155], v[136:139]
  v_mfma_f32_4x4x4_16b_bf16 v[132:135], v[146:147], v[146:147], v[132:135]
  s_waitcnt lgkmcnt(0)
  v_mfma_f32_32x32x16_bf16 v[64:79], v[160:163], v[168:171], v[64:79]
  v_mfma_f32_32x32x16_bf16 v[80:95], v[160:163], v[172:175], v[80:95]
  s_barrier
  v_mfma_f32_32x32x16_bf16 v[96:111], v[164:167], v[168:171], v[96:111]
  ds_read_b128 v[144:147], v176 offset:32768
  ds_read_b64_tr_b16 v[152:153], v200 offset:32768
  ds_read_b64_tr_b16 v[154:155], v200 offset:33792
  ds_read_b64_tr_b16 v[156:157], v201 offset:32768
  ds_read_b64_tr_b16 v[158:159], v201 offset:33792
  ds_read_b128 v[148:151], v180 offset:32768
  v_mfma_f32_32x32x16_bf16 v[112:127], v[164:167], v[172:175], v[112:127]
  v_mfma_f32_4x4x4_16b_bf16 v[132:135], v[160:161], v[160:161], v[132:135]
  v_mfma_f32_16x16x32_bf16 v[128:131], v[140:143], v[160:163], v[128:131]
  v_mfma_f32_16x16x32_bf16 v[136:139], v[140:143], v[168:171], v[136:139]
  v_mfma_f32_4x4x4_16b_bf16 v[132:135], v[162:163], v[162:163], v[132:135]
  s_waitcnt lgkmcnt(3)
  v_mfma_f32_32x32x16_bf16 v[64:79], v[144:147], v[152:155], v[64:79]
  ds_read_b128 v[160:163], v177 offset:32768
  ds_read_b64_tr_b16 v[168:169], v200 offset:36864
  ds_read_b64_tr_b16 v[170:171], v200 offset:37888
  s_waitcnt lgkmcnt(4)
  v_mfma_f32_32x32x16_bf16 v[80:95], v[144:147], v[156:159], v[80:95]
  ds_read_b64_tr_b16 v[172:173], v201 offset:36864
  ds_read_b64_tr_b16 v[174:175], v201 offset:37888
  ds_read_b128 v[164:167], v181 offset:32768
  s_waitcnt lgkmcnt(6)
  v_mfma_f32_32x32x16_bf16 v[96:111], v[148:151], v[152:155], v[96:111]
  v_mfma_f32_32x32x16_bf16 v[112:127], v[148:151], v[156:159], v[112:127]
  v_mfma_f32_4x4x4_16b_bf16 v[132:135], v[144:145], v[144:145], v[132:135]
  v_mfma_f32_16x16x32_bf16 v[128:131], v[140:143], v[144:147], v[128:131]
  v_mfma_f32_16x16x32_bf16 v[136:139], v[140:143], v[152:155], v[136:139]
  v_mfma_f32_4x4x4_16b_bf16 v[132:135], v[146:147], v[146:147], v[132:135]
  s_waitcnt lgkmcnt(3)
  v_mfma_f32_32x32x16_bf16 v[64:79], v[160:163], v[168:171], v[64:79]
  ds_read_b128 v[144:147], v178 offset:32768
  ds_read_b64_tr_b16 v[152:153], v200 offset:40960
  ds_read_b64_tr_b16 v[154:155], v200 offset:41984
  s_waitcnt lgkmcnt(4)
  v_mfma_f32_32x32x16_bf16 v[80:95], v[160:163], v[172:175], v[80:95]
  ds_read_b64_tr_b16 v[156:157], v201 offset:40960
  ds_read_b64_tr_b16 v[158:159], v201 offset:41984
  ds_read_b128 v[148:151], v182 offset:32768
  s_waitcnt lgkmcnt(6)
  v_mfma_f32_32x32x16_bf16 v[96:111], v[164:167], v[168:171], v[96:111]
  v_mfma_f32_32x32x16_bf16 v[112:127], v[164:167], v[172:175], v[112:127]
  v_mfma_f32_4x4x4_16b_bf16 v[132:135], v[160:161], v[160:161], v[132:135]
  v_mfma_f32_16x16x32_bf16 v[128:131], v[140:143], v[160:163], v[128:131]
  v_mfma_f32_16x16x32_bf16 v[136:139], v[140:143], v[168:171], v[136:139]
  v_mfma_f32_4x4x4_16b_bf16 v[132:135], v[162:163], v[162:163], v[132:135]
  s_waitcnt lgkmcnt(3)
  v_mfma_f32_32x32x16_bf16 v[64:79], v[144:147], v[152:155], v[64:79]
  ds_read_b128 v[160:163], v179 offset:32768
  ds_read_b64_tr_b16 v[168:169], v200 offset:45056
  ds_read_b64_tr_b16 v[170:171], v200 offset:46080
  s_waitcnt lgkmcnt(4)
  v_mfma_f32_32x32x16_bf16 v[80:95], v[144:147], v[156:159], v[80:95]
  ds_read_b64_tr_b16 v[172:173], v201 offset:45056
  ds_read_b64_tr_b16 v[174:175], v201 offset:46080
  ds_read_b128 v[164:167], v183 offset:32768
  s_waitcnt lgkmcnt(6)
  v_mfma_f32_32x32x16_bf16 v[96:111], v[148:151], v[152:155], v[96:111]
  v_mfma_f32_32x32x16_bf16 v[112:127], v[148:151], v[156:159], v[112:127]
  v_mfma_f32_4x4x4_16b_bf16 v[132:135], v[144:145], v[144:145], v[132:135]
  v_mfma_f32_16x16x32_bf16 v[128:131], v[140:143], v[144:147], v[128:131]
  v_mfma_f32_16x16x32_bf16 v[136:139], v[140:143], v[152:155], v[136:139]
  v_mfma_f32_4x4x4_16b_bf16 v[132:135], v[146:147], v[146:147], v[132:135]
  s_waitcnt lgkmcnt(0)
  v_mfma_f32_32x32x16_bf16 v[64:79], v[160:163], v[168:171], v[64:79]
  v_mfma_f32_32x32x16_bf16 v[80:95], v[160:163], v[172:175], v[80:95]
  s_barrier
  v_mfma_f32_32x32x16_bf16 v[96:111], v[164:167], v[168:171], v[96:111]
  ds_read_b128 v[144:147], v184 offset:0
  ds_read_b64_tr_b16 v[152:153], v202 offset:0
  ds_read_b64_tr_b16 v[154:155], v202 offset:1024
  ds_read_b64_tr_b16 v[156:157], v203 offset:0
  ds_read_b64_tr_b16 v[158:159], v203 offset:1024
  ds_read_b128 v[148:151], v188 offset:0
  v_mfma_f32_32x32x16_bf16 v[112:127], v[164:167], v[172:175], v[112:127]
  v_mfma_f32_4x4x4_16b_bf16 v[132:135], v[160:161], v[160:161], v[132:135]
  v_mfma_f32_16x16x32_bf16 v[128:131], v[140:143], v[160:163], v[128:131]
  v_mfma_f32_16x16x32_bf16 v[136:139], v[140:143], v[168:171], v[136:139]
  v_mfma_f32_4x4x4_16b_bf16 v[132:135], v[162:163], v[162:163], v[132:135]
  s_waitcnt lgkmcnt(3)
  v_mfma_f32_32x32x16_bf16 v[64:79], v[144:147], v[152:155], v[64:79]
  ds_read_b128 v[160:163], v185 offset:0
  ds_read_b64_tr_b16 v[168:169], v202 offset:4096
  ds_read_b64_tr_b16 v[170:171], v202 offset:5120
  s_waitcnt lgkmcnt(4)
  v_mfma_f32_32x32x16_bf16 v[80:95], v[144:147], v[156:159], v[80:95]
  ds_read_b64_tr_b16 v[172:173], v203 offset:4096
  ds_read_b64_tr_b16 v[174:175], v203 offset:5120
  ds_read_b128 v[164:167], v189 offset:0
  s_waitcnt lgkmcnt(6)
  v_mfma_f32_32x32x16_bf16 v[96:111], v[148:151], v[152:155], v[96:111]
  v_mfma_f32_32x32x16_bf16 v[112:127], v[148:151], v[156:159], v[112:127]
  v_mfma_f32_4x4x4_16b_bf16 v[132:135], v[144:145], v[144:145], v[132:135]
  v_mfma_f32_16x16x32_bf16 v[128:131], v[140:143], v[144:147], v[128:131]
  v_mfma_f32_16x16x32_bf16 v[136:139], v[140:143], v[152:155], v[136:139]
  v_mfma_f32_4x4x4_16b_bf16 v[132:135], v[146:147], v[146:147], v[132:135]
  s_waitcnt lgkmcnt(3)
  v_mfma_f32_32x32x16_bf16 v[64:79], v[160:163], v[168:171], v[64:79]
  ds_read_b128 v[144:147], v186 offset:0
  ds_read_b64_tr_b16 v[152:153], v202 offset:8192
  ds_read_b64_tr_b16 v[154:155], v202 offset:9216
  s_waitcnt lgkmcnt(4)
  v_mfma_f32_32x32x16_bf16 v[80:95], v[160:163], v[172:175], v[80:95]
  ds_read_b64_tr_b16 v[156:157], v203 offset:8192
  ds_read_b64_tr_b16 v[158:159], v203 offset:9216
  ds_read_b128 v[148:151], v190 offset:0
  s_waitcnt lgkmcnt(6)
  v_mfma_f32_32x32x16_bf16 v[96:111], v[164:167], v[168:171], v[96:111]
  v_mfma_f32_32x32x16_bf16 v[112:127], v[164:167], v[172:175], v[112:127]
  v_mfma_f32_4x4x4_16b_bf16 v[132:135], v[160:161], v[160:161], v[132:135]
  v_mfma_f32_16x16x32_bf16 v[128:131], v[140:143], v[160:163], v[128:131]
  v_mfma_f32_16x16x32_bf16 v[136:139], v[140:143], v[168:171], v[136:139]
  v_mfma_f32_4x4x4_16b_bf16 v[132:135], v[162:163], v[162:163], v[132:135]
  s_waitcnt lgkmcnt(3)
  v_mfma_f32_32x32x16_bf16 v[64:79], v[144:147], v[152:155], v[64:79]
  ds_read_b128 v[160:163], v187 offset:0
  ds_read_b64_tr_b16 v[168:169], v202 offset:12288
  ds_read_b64_tr_b16 v[170:171], v202 offset:13312
  s_waitcnt lgkmcnt(4)
  v_mfma_f32_32x32x16_bf16 v[80:95], v[144:147], v[156:159], v[80:95]
  ds_read_b64_tr_b16 v[172:173], v203 offset:12288
  ds_read_b64_tr_b16 v[174:175], v203 offset:13312
  ds_read_b128 v[164:167], v191 offset:0
  s_waitcnt lgkmcnt(6)
  v_mfma_f32_32x32x16_bf16 v[96:111], v[148:151], v[152:155], v[96:111]
  v_mfma_f32_32x32x16_bf16 v[112:127], v[148:151], v[156:159], v[112:127]
  v_mfma_f32_4x4x4_16b_bf16 v[132:135], v[144:145], v[144:145], v[132:135]
  v_mfma_f32_16x16x32_bf16 v[128:131], v[140:143], v[144:147], v[128:131]
  v_mfma_f32_16x16x32_bf16 v[136:139], v[140:143], v[152:155], v[136:139]
  v_mfma_f32_4x4x4_16b_bf16 v[132:135], v[146:147], v[146:147], v[132:135]
  s_waitcnt lgkmcnt(0)
  v_mfma_f32_32x32x16_bf16 v[64:79], v[160:163], v[168:171], v[64:79]
  v_mfma_f32_32x32x16_bf16 v[80:95], v[160:163], v[172:175], v[80:95]
  s_barrier
  v_mfma_f32_32x32x16_bf16 v[96:111], v[164:167], v[168:171], v[96:111]
  ds_read_b128 v[144:147], v184 offset:32768
  ds_read_b64_tr_b16 v[152:153], v202 offset:32768
  ds_read_b64_tr_b16 v[154:155], v202 offset:33792
  ds_read_b64_tr_b16 v[156:157], v203 offset:32768
  ds_read_b64_tr_b16 v[158:159], v203 offset:33792
  ds_read_b128 v[148:151], v188 offset:32768
  v_mfma_f32_32x32x16_bf16 v[112:127], v[164:167], v[172:175], v[112:127]
  v_mfma_f32_4x4x4_16b_bf16 v[132:135], v[160:161], v[160:161], v[132:135]
  v_mfma_f32_16x16x32_bf16 v[128:131], v[140:143], v[160:163], v[128:131]
  v_mfma_f32_16x16x32_bf16 v[136:139], v[140:143], v[168:171], v[136:139]
  v_mfma_f32_4x4x4_16b_bf16 v[132:135], v[162:163], v[162:163], v[132:135]
  s_waitcnt lgkmcnt(3)
  v_mfma_f32_32x32x16_bf16 v[64:79], v[144:147], v[152:155], v[64:79]
  ds_read_b128 v[160:163], v185 offset:32768
  ds_read_b64_tr_b16 v[168:169], v202 offset:36864
  ds_read_b64_tr_b16 v[170:171], v202 offset:37888
  s_waitcnt lgkmcnt(4)
  v_mfma_f32_32x32x16_bf16 v[80:95], v[144:147], v[156:159], v[80:95]
  ds_read_b64_tr_b16 v[172:173], v203 offset:36864
  ds_read_b64_tr_b16 v[174:175], v203 offset:37888
  ds_read_b128 v[164:167], v189 offset:32768
  s_waitcnt lgkmcnt(6)
  v_mfma_f32_32x32x16_bf16 v[96:111], v[148:151], v[152:155], v[96:111]
  v_mfma_f32_32x32x16_bf16 v[112:127], v[148:151], v[156:159], v[112:127]
  v_mfma_f32_4x4x4_16b_bf16 v[132:135], v[144:145], v[144:145], v[132:135]
  v_mfma_f32_16x16x32_bf16 v[128:131], v[140:143], v[144:147], v[128:131]
  v_mfma_f32_16x16x32_bf16 v[136:139], v[140:143], v[152:155], v[136:139]
  v_mfma_f32_4x4x4_16b_bf16 v[132:135], v[146:147], v[146:147], v[132:135]
  s_waitcnt lgkmcnt(3)
  v_mfma_f32_32x32x16_bf16 v[64:79], v[160:163], v[168:171], v[64:79]
  ds_read_b128 v[144:147], v186 offset:32768
  ds_read_b64_tr_b16 v[152:153], v202 offset:40960
  ds_read_b64_tr_b16 v[154:155], v202 offset:41984
  s_waitcnt lgkmcnt(4)
  v_mfma_f32_32x32x16_bf16 v[80:95], v[160:163], v[172:175], v[80:95]
  ds_read_b64_tr_b16 v[156:157], v203 offset:40960
  ds_read_b64_tr_b16 v[158:159], v203 offset:41984
  ds_read_b128 v[148:151], v190 offset:32768
  s_waitcnt lgkmcnt(6)
  v_mfma_f32_32x32x16_bf16 v[96:111], v[164:167], v[168:171], v[96:111]
  v_mfma_f32_32x32x16_bf16 v[112:127], v[164:167], v[172:175], v[112:127]
  v_mfma_f32_4x4x4_16b_bf16 v[132:135], v[160:161], v[160:161], v[132:135]
  v_mfma_f32_16x16x32_bf16 v[128:131], v[140:143], v[160:163], v[128:131]
  v_mfma_f32_16x16x32_bf16 v[136:139], v[140:143], v[168:171], v[136:139]
  v_mfma_f32_4x4x4_16b_bf16 v[132:135], v[162:163], v[162:163], v[132:135]
  s_waitcnt lgkmcnt(3)
  v_mfma_f32_32x32x16_bf16 v[64:79], v[144:147], v[152:155], v[64:79]
  ds_read_b128 v[160:163], v187 offset:32768
  ds_read_b64_tr_b16 v[168:169], v202 offset:45056
  ds_read_b64_tr_b16 v[170:171], v202 offset:46080
  s_waitcnt lgkmcnt(4)
  v_mfma_f32_32x32x16_bf16 v[80:95], v[144:147], v[156:159], v[80:95]
  ds_read_b64_tr_b16 v[172:173], v203 offset:45056
  ds_read_b64_tr_b16 v[174:175], v203 offset:46080
  ds_read_b128 v[164:167], v191 offset:32768
  s_waitcnt lgkmcnt(6)
  v_mfma_f32_32x32x16_bf16 v[96:111], v[148:151], v[152:155], v[96:111]
  v_mfma_f32_32x32x16_bf16 v[112:127], v[148:151], v[156:159], v[112:127]
  v_mfma_f32_4x4x4_16b_bf16 v[132:135], v[144:145], v[144:145], v[132:135]
  v_mfma_f32_16x16x32_bf16 v[128:131], v[140:143], v[144:147], v[128:131]
  v_mfma_f32_16x16x32_bf16 v[136:139], v[140:143], v[152:155], v[136:139]
  v_mfma_f32_4x4x4_16b_bf16 v[132:135], v[146:147], v[146:147], v[132:135]
  s_waitcnt lgkmcnt(0)
  v_mfma_f32_32x32x16_bf16 v[64:79], v[160:163], v[168:171], v[64:79]
  v_mfma_f32_32x32x16_bf16 v[80:95], v[160:163], v[172:175], v[80:95]
  s_barrier
  v_mfma_f32_32x32x16_bf16 v[96:111], v[164:167], v[168:171], v[96:111]
  ds_read_b128 v[144:147], v192 offset:0
  ds_read_b64_tr_b16 v[152:153], v204 offset:0
  ds_read_b64_tr_b16 v[154:155], v204 offset:1024
  ds_read_b64_tr_b16 v[156:157], v205 offset:0
  ds_read_b64_tr_b16 v[158:159], v205 offset:1024
  ds_read_b128 v[148:151], v196 offset:0
  v_mfma_f32_32x32x16_bf16 v[112:127], v[164:167], v[172:175], v[112:127]
  v_mfma_f32_4x4x4_16b_bf16 v[132:135], v[160:161], v[160:161], v[132:135]
  v_mfma_f32_16x16x32_bf16 v[128:131], v[140:143], v[160:163], v[128:131]
  v_mfma_f32_16x16x32_bf16 v[136:139], v[140:143], v[168:171], v[136:139]
  v_mfma_f32_4x4x4_16b_bf16 v[132:135], v[162:163], v[162:163], v[132:135]
  s_waitcnt lgkmcnt(3)
  v_mfma_f32_32x32x16_bf16 v[64:79], v[144:147], v[152:155], v[64:79]
  ds_read_b128 v[160:163], v193 offset:0
  ds_read_b64_tr_b16 v[168:169], v204 offset:4096
  ds_read_b64_tr_b16 v[170:171], v204 offset:5120
  s_waitcnt lgkmcnt(4)
  v_mfma_f32_32x32x16_bf16 v[80:95], v[144:147], v[156:159], v[80:95]
  ds_read_b64_tr_b16 v[172:173], v205 offset:4096
  ds_read_b64_tr_b16 v[174:175], v205 offset:5120
  ds_read_b128 v[164:167], v197 offset:0
  s_waitcnt lgkmcnt(6)
  v_mfma_f32_32x32x16_bf16 v[96:111], v[148:151], v[152:155], v[96:111]
  v_mfma_f32_32x32x16_bf16 v[112:127], v[148:151], v[156:159], v[112:127]
  v_mfma_f32_4x4x4_16b_bf16 v[132:135], v[144:145], v[144:145], v[132:135]
  v_mfma_f32_16x16x32_bf16 v[128:131], v[140:143], v[144:147], v[128:131]
  v_mfma_f32_16x16x32_bf16 v[136:139], v[140:143], v[152:155], v[136:139]
  v_mfma_f32_4x4x4_16b_bf16 v[132:135], v[146:147], v[146:147], v[132:135]
  s_waitcnt lgkmcnt(3)
  v_mfma_f32_32x32x16_bf16 v[64:79], v[160:163], v[168:171], v[64:79]
  ds_read_b128 v[144:147], v194 offset:0
  ds_read_b64_tr_b16 v[152:153], v204 offset:8192
  ds_read_b64_tr_b16 v[154:155], v204 offset:9216
  s_waitcnt lgkmcnt(4)
  v_mfma_f32_32x32x16_bf16 v[80:95], v[160:163], v[172:175], v[80:95]
  ds_read_b64_tr_b16 v[156:157], v205 offset:8192
  ds_read_b64_tr_b16 v[158:159], v205 offset:9216
  ds_read_b128 v[148:151], v198 offset:0
  s_waitcnt lgkmcnt(6)
  v_mfma_f32_32x32x16_bf16 v[96:111], v[164:167], v[168:171], v[96:111]
  v_mfma_f32_32x32x16_bf16 v[112:127], v[164:167], v[172:175], v[112:127]
  v_mfma_f32_4x4x4_16b_bf16 v[132:135], v[160:161], v[160:161], v[132:135]
  v_mfma_f32_16x16x32_bf16 v[128:131], v[140:143], v[160:163], v[128:131]
  v_mfma_f32_16x16x32_bf16 v[136:139], v[140:143], v[168:171], v[136:139]
  v_mfma_f32_4x4x4_16b_bf16 v[132:135], v[162:163], v[162:163], v[132:135]
  s_waitcnt lgkmcnt(3)
  v_mfma_f32_32x32x16_bf16 v[64:79], v[144:147], v[152:155], v[64:79]
  ds_read_b128 v[160:163], v195 offset:0
  ds_read_b64_tr_b16 v[168:169], v204 offset:12288
  ds_read_b64_tr_b16 v[170:171], v204 offset:13312
  s_waitcnt lgkmcnt(4)
  v_mfma_f32_32x32x16_bf16 v[80:95], v[144:147], v[156:159], v[80:95]
  ds_read_b64_tr_b16 v[172:173], v205 offset:12288
  ds_read_b64_tr_b16 v[174:175], v205 offset:13312
  ds_read_b128 v[164:167], v199 offset:0
  s_waitcnt lgkmcnt(6)
  v_mfma_f32_32x32x16_bf16 v[96:111], v[148:151], v[152:155], v[96:111]
  v_mfma_f32_32x32x16_bf16 v[112:127], v[148:151], v[156:159], v[112:127]
  v_mfma_f32_4x4x4_16b_bf16 v[132:135], v[144:145], v[144:145], v[132:135]
  v_mfma_f32_16x16x32_bf16 v[128:131], v[140:143], v[144:147], v[128:131]
  v_mfma_f32_16x16x32_bf16 v[136:139], v[140:143], v[152:155], v[136:139]
  v_mfma_f32_4x4x4_16b_bf16 v[132:135], v[146:147], v[146:147], v[132:135]
  s_waitcnt lgkmcnt(0)
  v_mfma_f32_32x32x16_bf16 v[64:79], v[160:163], v[168:171], v[64:79]
  v_mfma_f32_32x32x16_bf16 v[80:95], v[160:163], v[172:175], v[80:95]
  s_barrier
  v_mfma_f32_32x32x16_bf16 v[96:111], v[164:167], v[168:171], v[96:111]
  ds_read_b128 v[144:147], v176 offset:0
  ds_read_b64_tr_b16 v[152:153], v200 offset:0
  ds_read_b64_tr_b16 v[154:155], v200 offset:1024
  ds_read_b64_tr_b16 v[156:157], v201 offset:0
  ds_read_b64_tr_b16 v[158:159], v201 offset:1024
  ds_read_b128 v[148:151], v180 offset:0
  v_mfma_f32_32x32x16_bf16 v[112:127], v[164:167], v[172:175], v[112:127]
  v_mfma_f32_4x4x4_16b_bf16 v[132:135], v[160:161], v[160:161], v[132:135]
  v_mfma_f32_16x16x32_bf16 v[128:131], v[140:143], v[160:163], v[128:131]
  v_mfma_f32_16x16x32_bf16 v[136:139], v[140:143], v[168:171], v[136:139]
  v_mfma_f32_4x4x4_16b_bf16 v[132:135], v[162:163], v[162:163], v[132:135]
  s_waitcnt lgkmcnt(3)
  v_mfma_f32_32x32x16_bf16 v[64:79], v[144:147], v[152:155], v[64:79]
  ds_read_b128 v[160:163], v177 offset:0
  ds_read_b64_tr_b16 v[168:169], v200 offset:4096
  ds_read_b64_tr_b16 v[170:171], v200 offset:5120
  s_waitcnt lgkmcnt(4)
  v_mfma_f32_32x32x16_bf16 v[80:95], v[144:147], v[156:159], v[80:95]
  ds_read_b64_tr_b16 v[172:173], v201 offset:4096
  ds_read_b64_tr_b16 v[174:175], v201 offset:5120
  ds_read_b128 v[164:167], v181 offset:0
  s_waitcnt lgkmcnt(6)
  v_mfma_f32_32x32x16_bf16 v[96:111], v[148:151], v[152:155], v[96:111]
  v_mfma_f32_32x32x16_bf16 v[112:127], v[148:151], v[156:159], v[112:127]
  v_mfma_f32_4x4x4_16b_bf16 v[132:135], v[144:145], v[144:145], v[132:135]
  v_mfma_f32_16x16x32_bf16 v[128:131], v[140:143], v[144:147], v[128:131]
  v_mfma_f32_16x16x32_bf16 v[136:139], v[140:143], v[152:155], v[136:139]
  v_mfma_f32_4x4x4_16b_bf16 v[132:135], v[146:147], v[146:147], v[132:135]
  s_waitcnt lgkmcnt(3)
  v_mfma_f32_32x32x16_bf16 v[64:79], v[160:163], v[168:171], v[64:79]
  ds_read_b128 v[144:147], v178 offset:0
  ds_read_b64_tr_b16 v[152:153], v200 offset:8192
  ds_read_b64_tr_b16 v[154:155], v200 offset:9216
  s_waitcnt lgkmcnt(4)
  v_mfma_f32_32x32x16_bf16 v[80:95], v[160:163], v[172:175], v[80:95]
  ds_read_b64_tr_b16 v[156:157], v201 offset:8192
  ds_read_b64_tr_b16 v[158:159], v201 offset:9216
  ds_read_b128 v[148:151], v182 offset:0
  s_waitcnt lgkmcnt(6)
  v_mfma_f32_32x32x16_bf16 v[96:111], v[164:167], v[168:171], v[96:111]
  v_mfma_f32_32x32x16_bf16 v[112:127], v[164:167], v[172:175], v[112:127]
  v_mfma_f32_4x4x4_16b_bf16 v[132:135], v[160:161], v[160:161], v[132:135]
  v_mfma_f32_16x16x32_bf16 v[128:131], v[140:143], v[160:163], v[128:131]
  v_mfma_f32_16x16x32_bf16 v[136:139], v[140:143], v[168:171], v[136:139]
  v_mfma_f32_4x4x4_16b_bf16 v[132:135], v[162:163], v[162:163], v[132:135]
  s_waitcnt lgkmcnt(3)
  v_mfma_f32_32x32x16_bf16 v[64:79], v[144:147], v[152:155], v[64:79]
  ds_read_b128 v[160:163], v179 offset:0
  ds_read_b64_tr_b16 v[168:169], v200 offset:12288
  ds_read_b64_tr_b16 v[170:171], v200 offset:13312
  s_waitcnt lgkmcnt(4)
  v_mfma_f32_32x32x16_bf16 v[80:95], v[144:147], v[156:159], v[80:95]
  ds_read_b64_tr_b16 v[172:173], v201 offset:12288
  ds_read_b64_tr_b16 v[174:175], v201 offset:13312
  ds_read_b128 v[164:167], v183 offset:0
  s_waitcnt lgkmcnt(6)
  v_mfma_f32_32x32x16_bf16 v[96:111], v[148:151], v[152:155], v[96:111]
  v_mfma_f32_32x32x16_bf16 v[112:127], v[148:151], v[156:159], v[112:127]
  v_mfma_f32_4x4x4_16b_bf16 v[132:135], v[144:145], v[144:145], v[132:135]
  v_mfma_f32_16x16x32_bf16 v[128:131], v[140:143], v[144:147], v[128:131]
  v_mfma_f32_16x16x32_bf16 v[136:139], v[140:143], v[152:155], v[136:139]
  v_mfma_f32_4x4x4_16b_bf16 v[132:135], v[146:147], v[146:147], v[132:135]
  s_waitcnt lgkmcnt(0)
  v_mfma_f32_32x32x16_bf16 v[64:79], v[160:163], v[168:171], v[64:79]
  v_mfma_f32_32x32x16_bf16 v[80:95], v[160:163], v[172:175], v[80:95]
  s_barrier
  v_mfma_f32_32x32x16_bf16 v[96:111], v[164:167], v[168:171], v[96:111]
  ds_read_b128 v[144:147], v176 offset:32768
  ds_read_b64_tr_b16 v[152:153], v200 offset:32768
  ds_read_b64_tr_b16 v[154:155], v200 offset:33792
  ds_read_b64_tr_b16 v[156:157], v201 offset:32768
  ds_read_b64_tr_b16 v[158:159], v201 offset:33792
  ds_read_b128 v[148:151], v180 offset:32768
  v_mfma_f32_32x32x16_bf16 v[112:127], v[164:167], v[172:175], v[112:127]
  v_mfma_f32_4x4x4_16b_bf16 v[132:135], v[160:161], v[160:161], v[132:135]
  v_mfma_f32_16x16x32_bf16 v[128:131], v[140:143], v[160:163], v[128:131]
  v_mfma_f32_16x16x32_bf16 v[136:139], v[140:143], v[168:171], v[136:139]
  v_mfma_f32_4x4x4_16b_bf16 v[132:135], v[162:163], v[162:163], v[132:135]
  s_waitcnt lgkmcnt(3)
  v_mfma_f32_32x32x16_bf16 v[64:79], v[144:147], v[152:155], v[64:79]
  ds_read_b128 v[160:163], v177 offset:32768
  ds_read_b64_tr_b16 v[168:169], v200 offset:36864
  ds_read_b64_tr_b16 v[170:171], v200 offset:37888
  s_waitcnt lgkmcnt(4)
  v_mfma_f32_32x32x16_bf16 v[80:95], v[144:147], v[156:159], v[80:95]
  ds_read_b64_tr_b16 v[172:173], v201 offset:36864
  ds_read_b64_tr_b16 v[174:175], v201 offset:37888
  ds_read_b128 v[164:167], v181 offset:32768
  s_waitcnt lgkmcnt(6)
  v_mfma_f32_32x32x16_bf16 v[96:111], v[148:151], v[152:155], v[96:111]
  v_mfma_f32_32x32x16_bf16 v[112:127], v[148:151], v[156:159], v[112:127]
  v_mfma_f32_4x4x4_16b_bf16 v[132:135], v[144:145], v[144:145], v[132:135]
  v_mfma_f32_16x16x32_bf16 v[128:131], v[140:143], v[144:147], v[128:131]
  v_mfma_f32_16x16x32_bf16 v[136:139], v[140:143], v[152:155], v[136:139]
  v_mfma_f32_4x4x4_16b_bf16 v[132:135], v[146:147], v[146:147], v[132:135]
  s_waitcnt lgkmcnt(3)
  v_mfma_f32_32x32x16_bf16 v[64:79], v[160:163], v[168:171], v[64:79]
  ds_read_b128 v[144:147], v178 offset:32768
  ds_read_b64_tr_b16 v[152:153], v200 offset:40960
  ds_read_b64_tr_b16 v[154:155], v200 offset:41984
  s_waitcnt lgkmcnt(4)
  v_mfma_f32_32x32x16_bf16 v[80:95], v[160:163], v[172:175], v[80:95]
  ds_read_b64_tr_b16 v[156:157], v201 offset:40960
  ds_read_b64_tr_b16 v[158:159], v201 offset:41984
  ds_read_b128 v[148:151], v182 offset:32768
  s_waitcnt lgkmcnt(6)
  v_mfma_f32_32x32x16_bf16 v[96:111], v[164:167], v[168:171], v[96:111]
  v_mfma_f32_32x32x16_bf16 v[112:127], v[164:167], v[172:175], v[112:127]
  v_mfma_f32_4x4x4_16b_bf16 v[132:135], v[160:161], v[160:161], v[132:135]
  v_mfma_f32_16x16x32_bf16 v[128:131], v[140:143], v[160:163], v[128:131]
  v_mfma_f32_16x16x32_bf16 v[136:139], v[140:143], v[168:171], v[136:139]
  v_mfma_f32_4x4x4_16b_bf16 v[132:135], v[162:163], v[162:163], v[132:135]
  s_waitcnt lgkmcnt(3)
  v_mfma_f32_32x32x16_bf16 v[64:79], v[144:147], v[152:155], v[64:79]
  ds_read_b128 v[160:163], v179 offset:32768
  ds_read_b64_tr_b16 v[168:169], v200 offset:45056
  ds_read_b64_tr_b16 v[170:171], v200 offset:46080
  s_waitcnt lgkmcnt(4)
  v_mfma_f32_32x32x16_bf16 v[80:95], v[144:147], v[156:159], v[80:95]
  ds_read_b64_tr_b16 v[172:173], v201 offset:45056
  ds_read_b64_tr_b16 v[174:175], v201 offset:46080
  ds_read_b128 v[164:167], v183 offset:32768
  s_waitcnt lgkmcnt(6)
  v_mfma_f32_32x32x16_bf16 v[96:111], v[148:151], v[152:155], v[96:111]
  v_mfma_f32_32x32x16_bf16 v[112:127], v[148:151], v[156:159], v[112:127]
  v_mfma_f32_4x4x4_16b_bf16 v[132:135], v[144:145], v[144:145], v[132:135]
  v_mfma_f32_16x16x32_bf16 v[128:131], v[140:143], v[144:147], v[128:131]
  v_mfma_f32_16x16x32_bf16 v[136:139], v[140:143], v[152:155], v[136:139]
  v_mfma_f32_4x4x4_16b_bf16 v[132:135], v[146:147], v[146:147], v[132:135]
  s_waitcnt lgkmcnt(0)
  v_mfma_f32_32x32x16_bf16 v[64:79], v[160:163], v[168:171], v[64:79]
  v_mfma_f32_32x32x16_bf16 v[80:95], v[160:163], v[172:175], v[80:95]
  s_barrier
  v_mfma_f32_32x32x16_bf16 v[96:111], v[164:167], v[168:171], v[96:111]
  ds_read_b128 v[144:147], v184 offset:0
  ds_read_b64_tr_b16 v[152:153], v202 offset:0
  ds_read_b64_tr_b16 v[154:155], v202 offset:1024
  ds_read_b64_tr_b16 v[156:157], v203 offset:0
  ds_read_b64_tr_b16 v[158:159], v203 offset:1024
  ds_read_b128 v[148:151], v188 offset:0
  v_mfma_f32_32x32x16_bf16 v[112:127], v[164:167], v[172:175], v[112:127]
  v_mfma_f32_4x4x4_16b_bf16 v[132:135], v[160:161], v[160:161], v[132:135]
  v_mfma_f32_16x16x32_bf16 v[128:131], v[140:143], v[160:163], v[128:131]
  v_mfma_f32_16x16x32_bf16 v[136:139], v[140:143], v[168:171], v[136:139]
  v_mfma_f32_4x4x4_16b_bf16 v[132:135], v[162:163], v[162:163], v[132:135]
  s_waitcnt lgkmcnt(3)
  v_mfma_f32_32x32x16_bf16 v[64:79], v[144:147], v[152:155], v[64:79]
  ds_read_b128 v[160:163], v185 offset:0
  ds_read_b64_tr_b16 v[168:169], v202 offset:4096
  ds_read_b64_tr_b16 v[170:171], v202 offset:5120
  s_waitcnt lgkmcnt(4)
  v_mfma_f32_32x32x16_bf16 v[80:95], v[144:147], v[156:159], v[80:95]
  ds_read_b64_tr_b16 v[172:173], v203 offset:4096
  ds_read_b64_tr_b16 v[174:175], v203 offset:5120
  ds_read_b128 v[164:167], v189 offset:0
  s_waitcnt lgkmcnt(6)
  v_mfma_f32_32x32x16_bf16 v[96:111], v[148:151], v[152:155], v[96:111]
  v_mfma_f32_32x32x16_bf16 v[112:127], v[148:151], v[156:159], v[112:127]
  v_mfma_f32_4x4x4_16b_bf16 v[132:135], v[144:145], v[144:145], v[132:135]
  v_mfma_f32_16x16x32_bf16 v[128:131], v[140:143], v[144:147], v[128:131]
  v_mfma_f32_16x16x32_bf16 v[136:139], v[140:143], v[152:155], v[136:139]
  v_mfma_f32_4x4x4_16b_bf16 v[132:135], v[146:147], v[146:147], v[132:135]
  s_waitcnt lgkmcnt(3)
  v_mfma_f32_32x32x16_bf16 v[64:79], v[160:163], v[168:171], v[64:79]
  ds_read_b128 v[144:147], v186 offset:0
  ds_read_b64_tr_b16 v[152:153], v202 offset:8192
  ds_read_b64_tr_b16 v[154:155], v202 offset:9216
  s_waitcnt lgkmcnt(4)
  v_mfma_f32_32x32x16_bf16 v[80:95], v[160:163], v[172:175], v[80:95]
  ds_read_b64_tr_b16 v[156:157], v203 offset:8192
  ds_read_b64_tr_b16 v[158:159], v203 offset:9216
  ds_read_b128 v[148:151], v190 offset:0
  s_waitcnt lgkmcnt(6)
  v_mfma_f32_32x32x16_bf16 v[96:111], v[164:167], v[168:171], v[96:111]
  v_mfma_f32_32x32x16_bf16 v[112:127], v[164:167], v[172:175], v[112:127]
  v_mfma_f32_4x4x4_16b_bf16 v[132:135], v[160:161], v[160:161], v[132:135]
  v_mfma_f32_16x16x32_bf16 v[128:131], v[140:143], v[160:163], v[128:131]
  v_mfma_f32_16x16x32_bf16 v[136:139], v[140:143], v[168:171], v[136:139]
  v_mfma_f32_4x4x4_16b_bf16 v[132:135], v[162:163], v[162:163], v[132:135]
  s_waitcnt lgkmcnt(3)
  v_mfma_f32_32x32x16_bf16 v[64:79], v[144:147], v[152:155], v[64:79]
  ds_read_b128 v[160:163], v187 offset:0
  ds_read_b64_tr_b16 v[168:169], v202 offset:12288
  ds_read_b64_tr_b16 v[170:171], v202 offset:13312
  s_waitcnt lgkmcnt(4)
  v_mfma_f32_32x32x16_bf16 v[80:95], v[144:147], v[156:159], v[80:95]
  ds_read_b64_tr_b16 v[172:173], v203 offset:12288
  ds_read_b64_tr_b16 v[174:175], v203 offset:13312
  ds_read_b128 v[164:167], v191 offset:0
  s_waitcnt lgkmcnt(6)
  v_mfma_f32_32x32x16_bf16 v[96:111], v[148:151], v[152:155], v[96:111]
  v_mfma_f32_32x32x16_bf16 v[112:127], v[148:151], v[156:159], v[112:127]
  v_mfma_f32_4x4x4_16b_bf16 v[132:135], v[144:145], v[144:145], v[132:135]
  v_mfma_f32_16x16x32_bf16 v[128:131], v[140:143], v[144:147], v[128:131]
  v_mfma_f32_16x16x32_bf16 v[136:139], v[140:143], v[152:155], v[136:139]
  v_mfma_f32_4x4x4_16b_bf16 v[132:135], v[146:147], v[146:147], v[132:135]
  s_waitcnt lgkmcnt(0)
  v_mfma_f32_32x32x16_bf16 v[64:79], v[160:163], v[168:171], v[64:79]
  v_mfma_f32_32x32x16_bf16 v[80:95], v[160:163], v[172:175], v[80:95]
  s_barrier
  v_mfma_f32_32x32x16_bf16 v[96:111], v[164:167], v[168:171], v[96:111]
  ds_read_b128 v[144:147], v184 offset:32768
  ds_read_b64_tr_b16 v[152:153], v202 offset:32768
  ds_read_b64_tr_b16 v[154:155], v202 offset:33792
  ds_read_b64_tr_b16 v[156:157], v203 offset:32768
  ds_read_b64_tr_b16 v[158:159], v203 offset:33792
  ds_read_b128 v[148:151], v188 offset:32768
  v_mfma_f32_32x32x16_bf16 v[112:127], v[164:167], v[172:175], v[112:127]
  v_mfma_f32_4x4x4_16b_bf16 v[132:135], v[160:161], v[160:161], v[132:135]
  v_mfma_f32_16x16x32_bf16 v[128:131], v[140:143], v[160:163], v[128:131]
  v_mfma_f32_16x16x32_bf16 v[136:139], v[140:143], v[168:171], v[136:139]
  v_mfma_f32_4x4x4_16b_bf16 v[132:135], v[162:163], v[162:163], v[132:135]
  s_waitcnt lgkmcnt(3)
  v_mfma_f32_32x32x16_bf16 v[64:79], v[144:147], v[152:155], v[64:79]
  ds_read_b128 v[160:163], v185 offset:32768
  ds_read_b64_tr_b16 v[168:169], v202 offset:36864
  ds_read_b64_tr_b16 v[170:171], v202 offset:37888
  s_waitcnt lgkmcnt(4)
  v_mfma_f32_32x32x16_bf16 v[80:95], v[144:147], v[156:159], v[80:95]
  ds_read_b64_tr_b16 v[172:173], v203 offset:36864
  ds_read_b64_tr_b16 v[174:175], v203 offset:37888
  ds_read_b128 v[164:167], v189 offset:32768
  s_waitcnt lgkmcnt(6)
  v_mfma_f32_32x32x16_bf16 v[96:111], v[148:151], v[152:155], v[96:111]
  v_mfma_f32_32x32x16_bf16 v[112:127], v[148:151], v[156:159], v[112:127]
  v_mfma_f32_4x4x4_16b_bf16 v[132:135], v[144:145], v[144:145], v[132:135]
  v_mfma_f32_16x16x32_bf16 v[128:131], v[140:143], v[144:147], v[128:131]
  v_mfma_f32_16x16x32_bf16 v[136:139], v[140:143], v[152:155], v[136:139]
  v_mfma_f32_4x4x4_16b_bf16 v[132:135], v[146:147], v[146:147], v[132:135]
  s_waitcnt lgkmcnt(3)
  v_mfma_f32_32x32x16_bf16 v[64:79], v[160:163], v[168:171], v[64:79]
  ds_read_b128 v[144:147], v186 offset:32768
  ds_read_b64_tr_b16 v[152:153], v202 offset:40960
  ds_read_b64_tr_b16 v[154:155], v202 offset:41984
  s_waitcnt lgkmcnt(4)
  v_mfma_f32_32x32x16_bf16 v[80:95], v[160:163], v[172:175], v[80:95]
  ds_read_b64_tr_b16 v[156:157], v203 offset:40960
  ds_read_b64_tr_b16 v[158:159], v203 offset:41984
  ds_read_b128 v[148:151], v190 offset:32768
  s_waitcnt lgkmcnt(6)
  v_mfma_f32_32x32x16_bf16 v[96:111], v[164:167], v[168:171], v[96:111]
  v_mfma_f32_32x32x16_bf16 v[112:127], v[164:167], v[172:175], v[112:127]
  v_mfma_f32_4x4x4_16b_bf16 v[132:135], v[160:161], v[160:161], v[132:135]
  v_mfma_f32_16x16x32_bf16 v[128:131], v[140:143], v[160:163], v[128:131]
  v_mfma_f32_16x16x32_bf16 v[136:139], v[140:143], v[168:171], v[136:139]
  v_mfma_f32_4x4x4_16b_bf16 v[132:135], v[162:163], v[162:163], v[132:135]
  s_waitcnt lgkmcnt(3)
  v_mfma_f32_32x32x16_bf16 v[64:79], v[144:147], v[152:155], v[64:79]
  ds_read_b128 v[160:163], v187 offset:32768
  ds_read_b64_tr_b16 v[168:169], v202 offset:45056
  ds_read_b64_tr_b16 v[170:171], v202 offset:46080
  s_waitcnt lgkmcnt(4)
  v_mfma_f32_32x32x16_bf16 v[80:95], v[144:147], v[156:159], v[80:95]
  ds_read_b64_tr_b16 v[172:173], v203 offset:45056
  ds_read_b64_tr_b16 v[174:175], v203 offset:46080
  ds_read_b128 v[164:167], v191 offset:32768
  s_waitcnt lgkmcnt(6)
  v_mfma_f32_32x32x16_bf16 v[96:111], v[148:151], v[152:155], v[96:111]
  v_mfma_f32_32x32x16_bf16 v[112:127], v[148:151], v[156:159], v[112:127]
  v_mfma_f32_4x4x4_16b_bf16 v[132:135], v[144:145], v[144:145], v[132:135]
  v_mfma_f32_16x16x32_bf16 v[128:131], v[140:143], v[144:147], v[128:131]
  v_mfma_f32_16x16x32_bf16 v[136:139], v[140:143], v[152:155], v[136:139]
  v_mfma_f32_4x4x4_16b_bf16 v[132:135], v[146:147], v[146:147], v[132:135]
  s_waitcnt lgkmcnt(0)
  v_mfma_f32_32x32x16_bf16 v[64:79], v[160:163], v[168:171], v[64:79]
  v_mfma_f32_32x32x16_bf16 v[80:95], v[160:163], v[172:175], v[80:95]
  s_barrier
  v_mfma_f32_32x32x16_bf16 v[96:111], v[164:167], v[168:171], v[96:111]
  ds_read_b128 v[144:147], v192 offset:0
  ds_read_b64_tr_b16 v[152:153], v204 offset:0
  ds_read_b64_tr_b16 v[154:155], v204 offset:1024
  ds_read_b64_tr_b16 v[156:157], v205 offset:0
  ds_read_b64_tr_b16 v[158:159], v205 offset:1024
  ds_read_b128 v[148:151], v196 offset:0
  v_mfma_f32_32x32x16_bf16 v[112:127], v[164:167], v[172:175], v[112:127]
  v_mfma_f32_4x4x4_16b_bf16 v[132:135], v[160:161], v[160:161], v[132:135]
  v_mfma_f32_16x16x32_bf16 v[128:131], v[140:143], v[160:163], v[128:131]
  v_mfma_f32_16x16x32_bf16 v[136:139], v[140:143], v[168:171], v[136:139]
  v_mfma_f32_4x4x4_16b_bf16 v[132:135], v[162:163], v[162:163], v[132:135]
  s_waitcnt lgkmcnt(3)
  v_mfma_f32_32x32x16_bf16 v[64:79], v[144:147], v[152:155], v[64:79]
  ds_read_b128 v[160:163], v193 offset:0
  ds_read_b64_tr_b16 v[168:169], v204 offset:4096
  ds_read_b64_tr_b16 v[170:171], v204 offset:5120
  s_waitcnt lgkmcnt(4)
  v_mfma_f32_32x32x16_bf16 v[80:95], v[144:147], v[156:159], v[80:95]
  ds_read_b64_tr_b16 v[172:173], v205 offset:4096
  ds_read_b64_tr_b16 v[174:175], v205 offset:5120
  ds_read_b128 v[164:167], v197 offset:0
  s_waitcnt lgkmcnt(6)
  v_mfma_f32_32x32x16_bf16 v[96:111], v[148:151], v[152:155], v[96:111]
  v_mfma_f32_32x32x16_bf16 v[112:127], v[148:151], v[156:159], v[112:127]
  v_mfma_f32_4x4x4_16b_bf16 v[132:135], v[144:145], v[144:145], v[132:135]
  v_mfma_f32_16x16x32_bf16 v[128:131], v[140:143], v[144:147], v[128:131]
  v_mfma_f32_16x16x32_bf16 v[136:139], v[140:143], v[152:155], v[136:139]
  v_mfma_f32_4x4x4_16b_bf16 v[132:135], v[146:147], v[146:147], v[132:135]
  s_waitcnt lgkmcnt(3)
  v_mfma_f32_32x32x16_bf16 v[64:79], v[160:163], v[168:171], v[64:79]
  ds_read_b128 v[144:147], v194 offset:0
  ds_read_b64_tr_b16 v[152:153], v204 offset:8192
  ds_read_b64_tr_b16 v[154:155], v204 offset:9216
  s_waitcnt lgkmcnt(4)
  v_mfma_f32_32x32x16_bf16 v[80:95], v[160:163], v[172:175], v[80:95]
  ds_read_b64_tr_b16 v[156:157], v205 offset:8192
  ds_read_b64_tr_b16 v[158:159], v205 offset:9216
  ds_read_b128 v[148:151], v198 offset:0
  s_waitcnt lgkmcnt(6)
  v_mfma_f32_32x32x16_bf16 v[96:111], v[164:167], v[168:171], v[96:111]
  v_mfma_f32_32x32x16_bf16 v[112:127], v[164:167], v[172:175], v[112:127]
  v_mfma_f32_4x4x4_16b_bf16 v[132:135], v[160:161], v[160:161], v[132:135]
  v_mfma_f32_16x16x32_bf16 v[128:131], v[140:143], v[160:163], v[128:131]
  v_mfma_f32_16x16x32_bf16 v[136:139], v[140:143], v[168:171], v[136:139]
  v_mfma_f32_4x4x4_16b_bf16 v[132:135], v[162:163], v[162:163], v[132:135]
  s_waitcnt lgkmcnt(3)
  v_mfma_f32_32x32x16_bf16 v[64:79], v[144:147], v[152:155], v[64:79]
  ds_read_b128 v[160:163], v195 offset:0
  ds_read_b64_tr_b16 v[168:169], v204 offset:12288
  ds_read_b64_tr_b16 v[170:171], v204 offset:13312
  s_waitcnt lgkmcnt(4)
  v_mfma_f32_32x32x16_bf16 v[80:95], v[144:147], v[156:159], v[80:95]
  ds_read_b64_tr_b16 v[172:173], v205 offset:12288
  ds_read_b64_tr_b16 v[174:175], v205 offset:13312
  ds_read_b128 v[164:167], v199 offset:0
  s_waitcnt lgkmcnt(6)
  v_mfma_f32_32x32x16_bf16 v[96:111], v[148:151], v[152:155], v[96:111]
  v_mfma_f32_32x32x16_bf16 v[112:127], v[148:151], v[156:159], v[112:127]
  v_mfma_f32_4x4x4_16b_bf16 v[132:135], v[144:145], v[144:145], v[132:135]
  v_mfma_f32_16x16x32_bf16 v[128:131], v[140:143], v[144:147], v[128:131]
  v_mfma_f32_16x16x32_bf16 v[136:139], v[140:143], v[152:155], v[136:139]
  v_mfma_f32_4x4x4_16b_bf16 v[132:135], v[146:147], v[146:147], v[132:135]
  s_waitcnt lgkmcnt(0)
  v_mfma_f32_32x32x16_bf16 v[64:79], v[160:163], v[168:171], v[64:79]
  v_mfma_f32_32x32x16_bf16 v[80:95], v[160:163], v[172:175], v[80:95]
  v_mfma_f32_32x32x16_bf16 v[96:111], v[164:167], v[168:171], v[96:111]
  v_mfma_f32_32x32x16_bf16 v[112:127], v[164:167], v[172:175], v[112:127]
  v_mfma_f32_4x4x4_16b_bf16 v[132:135], v[160:161], v[160:161], v[132:135]
  v_mfma_f32_16x16x32_bf16 v[128:131], v[140:143], v[160:163], v[128:131]
  v_mfma_f32_16x16x32_bf16 v[136:139], v[140:143], v[168:171], v[136:139]
  v_mfma_f32_4x4x4_16b_bf16 v[132:135], v[162:163], v[162:163], v[132:135]
  s_nop 15
  v_and_b32 v13, 3, v0
  v_cmp_eq_u32 vcc, 1, v13
  v_cmp_eq_u32 s[42:43], 2, v13
  v_cmp_eq_u32 s[44:45], 3, v13
  v_and_b32 v14, 16, v0
  v_cmp_ne_u32 s[46:47], 0, v14
  v_cndmask_b32 v15, v132, v133, vcc
  v_cndmask_b32 v15, v15, v134, s[42:43]
  v_cndmask_b32 v15, v15, v135, s[44:45]
  v_cndmask_b32 v16, v128, v129, s[46:47]
  v_cndmask_b32 v17, v136, v137, s[46:47]
  v_mov_b32 v18, v15
  s_nop 1
  v_permlane32_swap_b32 v15, v18
  s_nop 1
  v_add_f32 v15, v15, v18
  v_mul_f32 v16, 0x3acccccd, v16
  v_mul_f32 v15, 0x3acccccd, v15
  v_fma_f32 v15, -v16, v16, v15
  v_max_f32 v15, 0, v15
  v_add_f32 v15, 0x3727c5ac, v15
  v_rsq_f32 v15, v15
  s_lshl_b32 s3, s32, 7
  v_lshl_add_u32 v18, v8, 2, s3
  v_mul_f32 v15, s40, v15
  s_lshl_b32 s3, s34, 7
  v_lshl_add_u32 v19, v8, 2, s3
  ds_write_b32 v18, v16
  ds_write_b32 v18, v15 offset:512
  ds_write_b32 v19, v17 offset:1024
  s_waitcnt lgkmcnt(0)
  s_barrier
  s_lshl_b32 s3, s34, 7
  v_lshl_add_u32 v13, v8, 2, s3
  ds_read_b32 v20, v13 offset:1024
  s_lshl_b32 s3, s35, 7
  v_lshl_add_u32 v13, v8, 2, s3
  ds_read_b32 v22, v13 offset:1024
  s_lshl_b32 s3, s32, 7
  v_lshl_add_u32 v13, v9, 4, s3
  ds_read_b128 v[24:27], v13 offset:0
  ds_read_b128 v[40:43], v13 offset:512
  ds_read_b128 v[28:31], v13 offset:32
  ds_read_b128 v[44:47], v13 offset:544
  ds_read_b128 v[32:35], v13 offset:64
  ds_read_b128 v[48:51], v13 offset:576
  ds_read_b128 v[36:39], v13 offset:96
  ds_read_b128 v[52:55], v13 offset:608
  s_waitcnt lgkmcnt(4)
  s_lshl_b32 s3, s33, 7
  v_lshl_add_u32 v13, v9, 4, s3
  ds_read_b128 v[144:147], v13 offset:0
  ds_read_b128 v[160:163], v13 offset:512
  ds_read_b128 v[148:151], v13 offset:32
  ds_read_b128 v[164:167], v13 offset:544
  ds_read_b128 v[152:155], v13 offset:64
  ds_read_b128 v[168:171], v13 offset:576
  ds_read_b128 v[156:159], v13 offset:96
  ds_read_b128 v[172:175], v13 offset:608
  s_waitcnt lgkmcnt(0)
  v_pk_fma_f32 v[64:65], v[24:25], v[20:21], v[64:65] op_sel:[0,0,0] op_sel_hi:[1,0,1] neg_lo:[0,1,0] neg_hi:[0,1,0]
  v_pk_fma_f32 v[66:67], v[26:27], v[20:21], v[66:67] op_sel:[0,0,0] op_sel_hi:[1,0,1] neg_lo:[0,1,0] neg_hi:[0,1,0]
  v_pk_fma_f32 v[68:69], v[28:29], v[20:21], v[68:69] op_sel:[0,0,0] op_sel_hi:[1,0,1] neg_lo:[0,1,0] neg_hi:[0,1,0]
  v_pk_fma_f32 v[70:71], v[30:31], v[20:21], v[70:71] op_sel:[0,0,0] op_sel_hi:[1,0,1] neg_lo:[0,1,0] neg_hi:[0,1,0]
  v_pk_mul_f32 v[64:65], v[64:65], v[40:41]
  v_pk_mul_f32 v[66:67], v[66:67], v[42:43]
  v_pk_mul_f32 v[68:69], v[68:69], v[44:45]
  v_pk_mul_f32 v[70:71], v[70:71], v[46:47]
  v_cvt_pk_bf16_f32 v64, v64, v65
  v_cvt_pk_bf16_f32 v65, v66, v67
  v_cvt_pk_bf16_f32 v66, v68, v69
  v_cvt_pk_bf16_f32 v67, v70, v71
  buffer_store_dwordx4 v[64:67], v214, s[20:23], 0 offen offset:0 sc0 sc1
  v_pk_fma_f32 v[72:73], v[32:33], v[20:21], v[72:73] op_sel:[0,0,0] op_sel_hi:[1,0,1] neg_lo:[0,1,0] neg_hi:[0,1,0]
  v_pk_fma_f32 v[74:75], v[34:35], v[20:21], v[74:75] op_sel:[0,0,0] op_sel_hi:[1,0,1] neg_lo:[0,1,0] neg_hi:[0,1,0]
  v_pk_fma_f32 v[76:77], v[36:37], v[20:21], v[76:77] op_sel:[0,0,0] op_sel_hi:[1,0,1] neg_lo:[0,1,0] neg_hi:[0,1,0]
  v_pk_fma_f32 v[78:79], v[38:39], v[20:21], v[78:79] op_sel:[0,0,0] op_sel_hi:[1,0,1] neg_lo:[0,1,0] neg_hi:[0,1,0]
  v_pk_mul_f32 v[72:73], v[72:73], v[48:49]
  v_pk_mul_f32 v[74:75], v[74:75], v[50:51]
  v_pk_mul_f32 v[76:77], v[76:77], v[52:53]
  v_pk_mul_f32 v[78:79], v[78:79], v[54:55]
  v_cvt_pk_bf16_f32 v72, v72, v73
  v_cvt_pk_bf16_f32 v73, v74, v75
  v_cvt_pk_bf16_f32 v74, v76, v77
  v_cvt_pk_bf16_f32 v75, v78, v79
  buffer_store_dwordx4 v[72:75], v214, s[20:23], 0 offen offset:640 sc0 sc1
  v_pk_fma_f32 v[80:81], v[24:25], v[22:23], v[80:81] op_sel:[0,0,0] op_sel_hi:[1,0,1] neg_lo:[0,1,0] neg_hi:[0,1,0]
  v_pk_fma_f32 v[82:83], v[26:27], v[22:23], v[82:83] op_sel:[0,0,0] op_sel_hi:[1,0,1] neg_lo:[0,1,0] neg_hi:[0,1,0]
  v_pk_fma_f32 v[84:85], v[28:29], v[22:23], v[84:85] op_sel:[0,0,0] op_sel_hi:[1,0,1] neg_lo:[0,1,0] neg_hi:[0,1,0]
  v_pk_fma_f32 v[86:87], v[30:31], v[22:23], v[86:87] op_sel:[0,0,0] op_sel_hi:[1,0,1] neg_lo:[0,1,0] neg_hi:[0,1,0]
  v_pk_mul_f32 v[80:81], v[80:81], v[40:41]
  v_pk_mul_f32 v[82:83], v[82:83], v[42:43]
  v_pk_mul_f32 v[84:85], v[84:85], v[44:45]
  v_pk_mul_f32 v[86:87], v[86:87], v[46:47]
  v_cvt_pk_bf16_f32 v80, v80, v81
  v_cvt_pk_bf16_f32 v81, v82, v83
  v_cvt_pk_bf16_f32 v82, v84, v85
  v_cvt_pk_bf16_f32 v83, v86, v87
  buffer_store_dwordx4 v[80:83], v215, s[20:23], 0 offen offset:0 sc0 sc1
  v_pk_fma_f32 v[88:89], v[32:33], v[22:23], v[88:89] op_sel:[0,0,0] op_sel_hi:[1,0,1] neg_lo:[0,1,0] neg_hi:[0,1,0]
  v_pk_fma_f32 v[90:91], v[34:35], v[22:23], v[90:91] op_sel:[0,0,0] op_sel_hi:[1,0,1] neg_lo:[0,1,0] neg_hi:[0,1,0]
  v_pk_fma_f32 v[92:93], v[36:37], v[22:23], v[92:93] op_sel:[0,0,0] op_sel_hi:[1,0,1] neg_lo:[0,1,0] neg_hi:[0,1,0]
  v_pk_fma_f32 v[94:95], v[38:39], v[22:23], v[94:95] op_sel:[0,0,0] op_sel_hi:[1,0,1] neg_lo:[0,1,0] neg_hi:[0,1,0]
  v_pk_mul_f32 v[88:89], v[88:89], v[48:49]
  v_pk_mul_f32 v[90:91], v[90:91], v[50:51]
  v_pk_mul_f32 v[92:93], v[92:93], v[52:53]
  v_pk_mul_f32 v[94:95], v[94:95], v[54:55]
  v_cvt_pk_bf16_f32 v88, v88, v89
  v_cvt_pk_bf16_f32 v89, v90, v91
  v_cvt_pk_bf16_f32 v90, v92, v93
  v_cvt_pk_bf16_f32 v91, v94, v95
  buffer_store_dwordx4 v[88:91], v215, s[20:23], 0 offen offset:640 sc0 sc1
  v_pk_fma_f32 v[96:97], v[144:145], v[20:21], v[96:97] op_sel:[0,0,0] op_sel_hi:[1,0,1] neg_lo:[0,1,0] neg_hi:[0,1,0]
  v_pk_fma_f32 v[98:99], v[146:147], v[20:21], v[98:99] op_sel:[0,0,0] op_sel_hi:[1,0,1] neg_lo:[0,1,0] neg_hi:[0,1,0]
  v_pk_fma_f32 v[100:101], v[148:149], v[20:21], v[100:101] op_sel:[0,0,0] op_sel_hi:[1,0,1] neg_lo:[0,1,0] neg_hi:[0,1,0]
  v_pk_fma_f32 v[102:103], v[150:151], v[20:21], v[102:103] op_sel:[0,0,0] op_sel_hi:[1,0,1] neg_lo:[0,1,0] neg_hi:[0,1,0]
  v_pk_mul_f32 v[96:97], v[96:97], v[160:161]
  v_pk_mul_f32 v[98:99], v[98:99], v[162:163]
  v_pk_mul_f32 v[100:101], v[100:101], v[164:165]
  v_pk_mul_f32 v[102:103], v[102:103], v[166:167]
  v_cvt_pk_bf16_f32 v96, v96, v97
  v_cvt_pk_bf16_f32 v97, v98, v99
  v_cvt_pk_bf16_f32 v98, v100, v101
  v_cvt_pk_bf16_f32 v99, v102, v103
  buffer_store_dwordx4 v[96:99], v216, s[20:23], 0 offen offset:0 sc0 sc1
  v_pk_fma_f32 v[104:105], v[152:153], v[20:21], v[104:105] op_sel:[0,0,0] op_sel_hi:[1,0,1] neg_lo:[0,1,0] neg_hi:[0,1,0]
  v_pk_fma_f32 v[106:107], v[154:155], v[20:21], v[106:107] op_sel:[0,0,0] op_sel_hi:[1,0,1] neg_lo:[0,1,0] neg_hi:[0,1,0]
  v_pk_fma_f32 v[108:109], v[156:157], v[20:21], v[108:109] op_sel:[0,0,0] op_sel_hi:[1,0,1] neg_lo:[0,1,0] neg_hi:[0,1,0]
  v_pk_fma_f32 v[110:111], v[158:159], v[20:21], v[110:111] op_sel:[0,0,0] op_sel_hi:[1,0,1] neg_lo:[0,1,0] neg_hi:[0,1,0]
  v_pk_mul_f32 v[104:105], v[104:105], v[168:169]
  v_pk_mul_f32 v[106:107], v[106:107], v[170:171]
  v_pk_mul_f32 v[108:109], v[108:109], v[172:173]
  v_pk_mul_f32 v[110:111], v[110:111], v[174:175]
  v_cvt_pk_bf16_f32 v104, v104, v105
  v_cvt_pk_bf16_f32 v105, v106, v107
  v_cvt_pk_bf16_f32 v106, v108, v109
  v_cvt_pk_bf16_f32 v107, v110, v111
  buffer_store_dwordx4 v[104:107], v216, s[20:23], 0 offen offset:640 sc0 sc1
  v_pk_fma_f32 v[112:113], v[144:145], v[22:23], v[112:113] op_sel:[0,0,0] op_sel_hi:[1,0,1] neg_lo:[0,1,0] neg_hi:[0,1,0]
  v_pk_fma_f32 v[114:115], v[146:147], v[22:23], v[114:115] op_sel:[0,0,0] op_sel_hi:[1,0,1] neg_lo:[0,1,0] neg_hi:[0,1,0]
  v_pk_fma_f32 v[116:117], v[148:149], v[22:23], v[116:117] op_sel:[0,0,0] op_sel_hi:[1,0,1] neg_lo:[0,1,0] neg_hi:[0,1,0]
  v_pk_fma_f32 v[118:119], v[150:151], v[22:23], v[118:119] op_sel:[0,0,0] op_sel_hi:[1,0,1] neg_lo:[0,1,0] neg_hi:[0,1,0]
  v_pk_mul_f32 v[112:113], v[112:113], v[160:161]
  v_pk_mul_f32 v[114:115], v[114:115], v[162:163]
  v_pk_mul_f32 v[116:117], v[116:117], v[164:165]
  v_pk_mul_f32 v[118:119], v[118:119], v[166:167]
  v_cvt_pk_bf16_f32 v112, v112, v113
  v_cvt_pk_bf16_f32 v113, v114, v115
  v_cvt_pk_bf16_f32 v114, v116, v117
  v_cvt_pk_bf16_f32 v115, v118, v119
  buffer_store_dwordx4 v[112:115], v217, s[20:23], 0 offen offset:0 sc0 sc1
  v_pk_fma_f32 v[120:121], v[152:153], v[22:23], v[120:121] op_sel:[0,0,0] op_sel_hi:[1,0,1] neg_lo:[0,1,0] neg_hi:[0,1,0]
  v_pk_fma_f32 v[122:123], v[154:155], v[22:23], v[122:123] op_sel:[0,0,0] op_sel_hi:[1,0,1] neg_lo:[0,1,0] neg_hi:[0,1,0]
  v_pk_fma_f32 v[124:125], v[156:157], v[22:23], v[124:125] op_sel:[0,0,0] op_sel_hi:[1,0,1] neg_lo:[0,1,0] neg_hi:[0,1,0]
  v_pk_fma_f32 v[126:127], v[158:159], v[22:23], v[126:127] op_sel:[0,0,0] op_sel_hi:[1,0,1] neg_lo:[0,1,0] neg_hi:[0,1,0]
  v_pk_mul_f32 v[120:121], v[120:121], v[168:169]
  v_pk_mul_f32 v[122:123], v[122:123], v[170:171]
  v_pk_mul_f32 v[124:125], v[124:125], v[172:173]
  v_pk_mul_f32 v[126:127], v[126:127], v[174:175]
  v_cvt_pk_bf16_f32 v120, v120, v121
  v_cvt_pk_bf16_f32 v121, v122, v123
  v_cvt_pk_bf16_f32 v122, v124, v125
  v_cvt_pk_bf16_f32 v123, v126, v127
  buffer_store_dwordx4 v[120:123], v217, s[20:23], 0 offen offset:640 sc0 sc1
s1_qkv_end_1:
  s_endpgm
s1_qkv_woj_2:
  s_load_dwordx2 s[44:45], s[0:1], 16
  v_lshrrev_b32 v1, 6, v0
  v_and_b32 v0, 63, v0
  v_readfirstlane_b32 s26, v1
  s_lshl_b32 s27, s24, 3
  s_add_u32 s27, s27, s26
  s_add_u32 s50, s27, 0
  v_lshrrev_b32 v10, 4, v0
  v_and_b32 v11, 15, v0
  s_mul_i32 s51, s50, 6554
  s_lshr_b32 s51, s51, 16
  s_mul_i32 s52, s51, 10
  s_sub_u32 s52, s50, s52
  s_movk_i32 s53, 1280
  s_lshl_b32 s3, s51, 2
  v_add_u32 v12, s3, v10
  v_mul_u32_u24 v13, 205, v12
  v_lshrrev_b32 v13, 10, v13
  v_mul_u32_u24 v14, 5, v13
  v_sub_u32 v12, v12, v14
  v_mul_u32_u24 v13, 40, v13
  v_cmp_eq_u32 vcc, 4, v12
  v_lshrrev_b32 v14, 1, v12
  v_mul_u32_u24 v14, 20, v14
  v_and_b32 v12, 1, v12
  v_lshl_add_u32 v14, v12, 2, v14
  v_cndmask_b32 v14, v14, 16, vcc
  v_add_u32 v12, v13, v14
  v_mov_b32 v13, 8
  v_cndmask_b32 v13, v13, 20, vcc
  v_add_u32 v13, v12, v13
  s_movk_i32 s54, 100
  s_mov_b32 s55, 0x1340000
  s_cmp_ge_u32 s50, 200
  s_cselect_b32 s55, 0x40000000, s55
  s_lshl_b32 s3, s52, 2
  v_lshrrev_b32 v14, 2, v11
  v_add_u32 v14, s3, v14
  v_mul_u32_u24 v15, 205, v14
  v_lshrrev_b32 v15, 10, v15
  v_mul_u32_u24 v20, 5, v15
  v_sub_u32 v14, v14, v20
  v_mul_u32_u24 v15, s54, v15
  s_mul_i32 s3, s51, 5
  v_add3_u32 v14, v14, v15, s3
  v_and_b32 v15, 3, v11
  v_lshlrev_b32 v15, 6, v15
  v_lshl_add_u32 v15, v10, 8, v15
  v_lshl_add_u32 v14, v14, 10, v15
  v_add_u32 v20, s55, v14
  s_lshl_b32 s3, s52, 7
  v_lshl_add_u32 v11, v11, 3, s3
  v_mad_u32_u24 v24, v12, s53, v11
  v_mad_u32_u24 v25, v13, s53, v11
  s_add_u32 s50, s27, 128
  v_lshrrev_b32 v10, 4, v0
  v_and_b32 v11, 15, v0
  s_mul_i32 s51, s50, 6554
  s_lshr_b32 s51, s51, 16
  s_mul_i32 s52, s51, 10
  s_sub_u32 s52, s50, s52
  s_movk_i32 s53, 1280
  s_lshl_b32 s3, s51, 2
  v_add_u32 v12, s3, v10
  v_mul_u32_u24 v13, 205, v12
  v_lshrrev_b32 v13, 10, v13
  v_mul_u32_u24 v14, 5, v13
  v_sub_u32 v12, v12, v14
  v_mul_u32_u24 v13, 40, v13
  v_cmp_eq_u32 vcc, 4, v12
  v_lshrrev_b32 v14, 1, v12
  v_mul_u32_u24 v14, 20, v14
  v_and_b32 v12, 1, v12
  v_lshl_add_u32 v14, v12, 2, v14
  v_cndmask_b32 v14, v14, 16, vcc
  v_add_u32 v12, v13, v14
  v_mov_b32 v13, 8
  v_cndmask_b32 v13, v13, 20, vcc
  v_add_u32 v13, v12, v13
  s_movk_i32 s54, 100
  s_mov_b32 s55, 0x1340000
  s_cmp_ge_u32 s50, 200
  s_cselect_b32 s55, 0x40000000, s55
  s_lshl_b32 s3, s52, 2
  v_lshrrev_b32 v14, 2, v11
  v_add_u32 v14, s3, v14
  v_mul_u32_u24 v15, 205, v14
  v_lshrrev_b32 v15, 10, v15
  v_mul_u32_u24 v21, 5, v15
  v_sub_u32 v14, v14, v21
  v_mul_u32_u24 v15, s54, v15
  s_mul_i32 s3, s51, 5
  v_add3_u32 v14, v14, v15, s3
  v_and_b32 v15, 3, v11
  v_lshlrev_b32 v15, 6, v15
  v_lshl_add_u32 v15, v10, 8, v15
  v_lshl_add_u32 v14, v14, 10, v15
  v_add_u32 v21, s55, v14
  s_lshl_b32 s3, s52, 7
  v_lshl_add_u32 v11, v11, 3, s3
  v_mad_u32_u24 v26, v12, s53, v11
  v_mad_u32_u24 v27, v13, s53, v11
  s_waitcnt lgkmcnt(0)
  s_mov_b32 s36, s44
  s_and_b32 s37, s45, 0xffff
  s_mov_b32 s38, 0xc8000
  s_mov_b32 s39, 0x00020000
  s_mov_b32 s16, s8
  s_and_b32 s17, s9, 0xffff
  s_mov_b32 s18, 0x1b00000
  s_mov_b32 s19, 0x00020000
  s_mov_b32 s57, 0
  buffer_load_dwordx2 v[32:33], v24, s[36:39], s57 offen
  buffer_load_dwordx2 v[40:41], v25, s[36:39], s57 offen
  s_add_u32 s57, s57, s53
  buffer_load_dwordx2 v[34:35], v24, s[36:39], s57 offen
  buffer_load_dwordx2 v[42:43], v25, s[36:39], s57 offen
  s_add_u32 s57, s57, s53
  buffer_load_dwordx2 v[36:37], v24, s[36:39], s57 offen
  buffer_load_dwordx2 v[44:45], v25, s[36:39], s57 offen
  s_add_u32 s57, s57, s53
  buffer_load_dwordx2 v[38:39], v24, s[36:39], s57 offen
  buffer_load_dwordx2 v[46:47], v25, s[36:39], s57 offen
  s_mov_b32 s57, 0
  buffer_load_dwordx2 v[48:49], v26, s[36:39], s57 offen
  buffer_load_dwordx2 v[56:57], v27, s[36:39], s57 offen
  s_add_u32 s57, s57, s53
  buffer_load_dwordx2 v[50:51], v26, s[36:39], s57 offen
  buffer_load_dwordx2 v[58:59], v27, s[36:39], s57 offen
  s_add_u32 s57, s57, s53
  buffer_load_dwordx2 v[52:53], v26, s[36:39], s57 offen
  buffer_load_dwordx2 v[60:61], v27, s[36:39], s57 offen
  s_add_u32 s57, s57, s53
  buffer_load_dwordx2 v[54:55], v26, s[36:39], s57 offen
  buffer_load_dwordx2 v[62:63], v27, s[36:39], s57 offen
  s_waitcnt vmcnt(8)
  s_mov_b32 s50, 0x05040100
  s_mov_b32 s51, 0x07060302
  v_perm_b32 v96, v34, v32, s50
  v_perm_b32 v97, v38, v36, s50
  v_perm_b32 v98, v42, v40, s50
  v_perm_b32 v99, v46, v44, s50
  buffer_store_dwordx4 v[96:99], v20, s[16:19], 0 offen offset:0
  v_perm_b32 v100, v34, v32, s51
  v_perm_b32 v101, v38, v36, s51
  v_perm_b32 v102, v42, v40, s51
  v_perm_b32 v103, v46, v44, s51
  buffer_store_dwordx4 v[100:103], v20, s[16:19], 0 offen offset:16
  v_perm_b32 v104, v35, v33, s50
  v_perm_b32 v105, v39, v37, s50
  v_perm_b32 v106, v43, v41, s50
  v_perm_b32 v107, v47, v45, s50
  buffer_store_dwordx4 v[104:107], v20, s[16:19], 0 offen offset:32
  v_perm_b32 v108, v35, v33, s51
  v_perm_b32 v109, v39, v37, s51
  v_perm_b32 v110, v43, v41, s51
  v_perm_b32 v111, v47, v45, s51
  buffer_store_dwordx4 v[108:111], v20, s[16:19], 0 offen offset:48
  s_waitcnt vmcnt(4)
  s_mov_b32 s50, 0x05040100
  s_mov_b32 s51, 0x07060302
  v_perm_b32 v112, v50, v48, s50
  v_perm_b32 v113, v54, v52, s50
  v_perm_b32 v114, v58, v56, s50
  v_perm_b32 v115, v62, v60, s50
  buffer_store_dwordx4 v[112:115], v21, s[16:19], 0 offen offset:0
  v_perm_b32 v116, v50, v48, s51
  v_perm_b32 v117, v54, v52, s51
  v_perm_b32 v118, v58, v56, s51
  v_perm_b32 v119, v62, v60, s51
  buffer_store_dwordx4 v[116:119], v21, s[16:19], 0 offen offset:16
  v_perm_b32 v120, v51, v49, s50
  v_perm_b32 v121, v55, v53, s50
  v_perm_b32 v122, v59, v57, s50
  v_perm_b32 v123, v63, v61, s50
  buffer_store_dwordx4 v[120:123], v21, s[16:19], 0 offen offset:32
  v_perm_b32 v124, v51, v49, s51
  v_perm_b32 v125, v55, v53, s51
  v_perm_b32 v126, v59, v57, s51
  v_perm_b32 v127, v63, v61, s51
  buffer_store_dwordx4 v[124:127], v21, s[16:19], 0 offen offset:48
  s_endpgm
s1_qkv_c_3:
  s_lshr_b32 s27, s26, 1
  s_and_b32 s28, s26, 1
  s_waitcnt lgkmcnt(0)
  s_mov_b32 s20, s8
  s_and_b32 s21, s9, 0xffff
  s_mov_b32 s22, 0x780000
  s_mov_b32 s23, 0x00020000
  v_and_b32 v8, 31, v0
  v_lshrrev_b32 v9, 5, v0
  v_lshrrev_b32 v10, 1, v8
  v_and_b32 v10, 7, v10
  s_lshl_b32 s3, s27, 1
  s_add_u32 s32, s3, s28
  s_xor_b32 s33, s32, 1
  s_lshl_b32 s3, s28, 1
  s_add_u32 s34, s3, s27
  s_xor_b32 s35, s34, 1
  s_lshl_b32 s3, s32, 12
  v_lshl_add_u32 v11, v8, 7, s3
  v_add_u32 v12, 0, v9
  v_xor_b32 v12, v12, v10
  v_lshl_add_u32 v176, v12, 4, v11
  v_add_u32 v184, 0x10000, v176
  v_add_u32 v192, 0x20000, v176
  v_add_u32 v12, 2, v9
  v_xor_b32 v12, v12, v10
  v_lshl_add_u32 v177, v12, 4, v11
  v_add_u32 v185, 0x10000, v177
  v_add_u32 v193, 0x20000, v177
  v_add_u32 v12, 4, v9
  v_xor_b32 v12, v12, v10
  v_lshl_add_u32 v178, v12, 4, v11
  v_add_u32 v186, 0x10000, v178
  v_add_u32 v194, 0x20000, v178
  v_add_u32 v12, 6, v9
  v_xor_b32 v12, v12, v10
  v_lshl_add_u32 v179, v12, 4, v11
  v_add_u32 v187, 0x10000, v179
  v_add_u32 v195, 0x20000, v179
  s_lshl_b32 s3, s33, 12
  v_lshl_add_u32 v11, v8, 7, s3
  v_add_u32 v12, 0, v9
  v_xor_b32 v12, v12, v10
  v_lshl_add_u32 v180, v12, 4, v11
  v_add_u32 v188, 0x10000, v180
  v_add_u32 v196, 0x20000, v180
  v_add_u32 v12, 2, v9
  v_xor_b32 v12, v12, v10
  v_lshl_add_u32 v181, v12, 4, v11
  v_add_u32 v189, 0x10000, v181
  v_add_u32 v197, 0x20000, v181
  v_add_u32 v12, 4, v9
  v_xor_b32 v12, v12, v10
  v_lshl_add_u32 v182, v12, 4, v11
  v_add_u32 v190, 0x10000, v182
  v_add_u32 v198, 0x20000, v182
  v_add_u32 v12, 6, v9
  v_xor_b32 v12, v12, v10
  v_lshl_add_u32 v183, v12, 4, v11
  v_add_u32 v191, 0x10000, v183
  v_add_u32 v199, 0x20000, v183
  v_lshrrev_b32 v11, 2, v0
  v_and_b32 v11, 3, v11
  v_lshl_add_u32 v12, v9, 3, v11
  v_lshlrev_b32 v12, 8, v12
  v_and_b32 v13, 1, v3
  v_lshlrev_b32 v13, 1, v13
  s_cmp_ge_u32 s25, 10
  s_cselect_b32 s3, 1, 0
  s_xor_b32 s36, s3, 1
  v_bfe_u32 v14, v0, s3, 1
  v_or_b32 v13, v13, v14
  v_bfe_u32 v14, v0, s36, 1
  v_lshl_add_u32 v12, v14, 3, v12
  v_lshl_add_u32 v12, v13, 4, v12
  v_add_u32 v12, 0x4000, v12
  v_xor_b32 v13, s34, v11
  v_lshl_add_u32 v200, v13, 6, v12
  v_add_u32 v202, 0x10000, v200
  v_add_u32 v204, 0x20000, v200
  v_xor_b32 v13, s35, v11
  v_lshl_add_u32 v201, v13, 6, v12
  v_add_u32 v203, 0x10000, v201
  v_add_u32 v205, 0x20000, v201
  v_xor_b32 v13, v0, v3
  v_and_b32 v13, 1, v13
  v_cmp_eq_u32 vcc, 0, v13
  v_mov_b32 v14, 0x3f803f80
  s_nop 0
  v_cndmask_b32 v140, 0, v14, vcc
  v_mov_b32 v141, v140
  v_mov_b32 v142, v140
  v_mov_b32 v143, v140
  v_mov_b32 v64, 0
  v_mov_b32 v65, 0
  v_mov_b32 v66, 0
  v_mov_b32 v67, 0
  v_mov_b32 v68, 0
  v_mov_b32 v69, 0
  v_mov_b32 v70, 0
  v_mov_b32 v71, 0
  v_mov_b32 v72, 0
  v_mov_b32 v73, 0
  v_mov_b32 v74, 0
  v_mov_b32 v75, 0
  v_mov_b32 v76, 0
  v_mov_b32 v77, 0
  v_mov_b32 v78, 0
  v_mov_b32 v79, 0
  v_mov_b32 v80, 0
  v_mov_b32 v81, 0
  v_mov_b32 v82, 0
  v_mov_b32 v83, 0
  v_mov_b32 v84, 0
  v_mov_b32 v85, 0
  v_mov_b32 v86, 0
  v_mov_b32 v87, 0
  v_mov_b32 v88, 0
  v_mov_b32 v89, 0
  v_mov_b32 v90, 0
  v_mov_b32 v91, 0
  v_mov_b32 v92, 0
  v_mov_b32 v93, 0
  v_mov_b32 v94, 0
  v_mov_b32 v95, 0
  v_mov_b32 v96, 0
  v_mov_b32 v97, 0
  v_mov_b32 v98, 0
  v_mov_b32 v99, 0
  v_mov_b32 v100, 0
  v_mov_b32 v101, 0
  v_mov_b32 v102, 0
  v_mov_b32 v103, 0
  v_mov_b32 v104, 0
  v_mov_b32 v105, 0
  v_mov_b32 v106, 0
  v_mov_b32 v107, 0
  v_mov_b32 v108, 0
  v_mov_b32 v109, 0
  v_mov_b32 v110, 0
  v_mov_b32 v111, 0
  v_mov_b32 v112, 0
  v_mov_b32 v113, 0
  v_mov_b32 v114, 0
  v_mov_b32 v115, 0
  v_mov_b32 v116, 0
  v_mov_b32 v117, 0
  v_mov_b32 v118, 0
  v_mov_b32 v119, 0
  v_mov_b32 v120, 0
  v_mov_b32 v121, 0
  v_mov_b32 v122, 0
  v_mov_b32 v123, 0
  v_mov_b32 v124, 0
  v_mov_b32 v125, 0
  v_mov_b32 v126, 0
  v_mov_b32 v127, 0
  v_mov_b32 v128, 0
  v_mov_b32 v129, 0
  v_mov_b32 v130, 0
  v_mov_b32 v131, 0
  v_mov_b32 v132, 0
  v_mov_b32 v133, 0
  v_mov_b32 v134, 0
  v_mov_b32 v135, 0
  v_mov_b32 v136, 0
  v_mov_b32 v137, 0
  v_mov_b32 v138, 0
  v_mov_b32 v139, 0
  s_mov_b32 s40, 1.0
  s_cmp_ge_u32 s25, 10
  s_cbranch_scc1 s1_qkv_v_4
  s_cmp_ge_u32 s25, 5
  s_cbranch_scc1 s1_qkv_k_6
  s_mov_b32 s40, 0x3ea52b5c
  s_mov_b32 s36, 81920
  s_lshl_b32 s3, s24, 1
  s_add_u32 s3, s3, s27
  s_mul_i32 s37, s3, 2560
  s_add_u32 s37, s37, 0x0
  s_movk_i32 s38, 1280
  s_movk_i32 s39, 1024
  s_movk_i32 s41, 1280
  s_lshl_b32 s48, s25, 5
  s_branch s1_qkv_adr_7
s1_qkv_k_6:
  s_mov_b32 s36, 163840
  s_lshl_b32 s3, s24, 1
  s_add_u32 s3, s3, s27
  s_mul_i32 s37, s3, 5120
  s_add_u32 s37, s37, 0x280000
  s_movk_i32 s38, 1024
  s_movk_i32 s39, 2048
  s_movk_i32 s41, 256
  s_sub_u32 s48, s25, 5
  s_lshl_b32 s48, s48, 5
s1_qkv_adr_7:
  s_lshr_b32 s48, s48, 1
  s_lshl_b32 s39, s28, 10
  s_lshl_b32 s38, s28, 11
  s_sub_u32 s38, 1024, s38
  v_mov_b32 v20, s38
  v_mov_b32 v21, s36
  v_lshl_add_u32 v22, v8, 4, s37
  v_mov_b32 v23, 2048
  s_lshl_b32 s3, s34, 2
  s_add_u32 s3, s3, s48
  v_add_u32 v13, s3, v9
  v_mul_u32_u24 v14, 205, v13
  v_lshrrev_b32 v14, 10, v14
  v_mul_u32_u24 v15, 5, v14
  v_sub_u32 v15, v13, v15
  v_cmp_eq_u32 s[52:53], 2, v15
  v_mul_u32_u24 v16, 43, v15
  v_lshrrev_b32 v16, 7, v16
  v_lshl_add_u32 v14, v14, 1, v16
  v_mul_u32_u24 v16, 3, v16
  v_sub_u32 v15, v15, v16
  v_lshl_add_u32 v15, v15, 9, s39
  v_cndmask_b32 v15, v15, v23, s[52:53]
  v_cndmask_b32 v16, v20, v21, s[52:53]
  v_mul_lo_u32 v14, v14, s36
  v_add3_u32 v214, v14, v15, v22
  v_add_u32 v215, v214, v16
  s_add_u32 s3, s3, 2
  v_add_u32 v13, s3, v9
  v_mul_u32_u24 v14, 205, v13
  v_lshrrev_b32 v14, 10, v14
  v_mul_u32_u24 v15, 5, v14
  v_sub_u32 v15, v13, v15
  v_cmp_eq_u32 s[54:55], 2, v15
  v_mul_u32_u24 v16, 43, v15
  v_lshrrev_b32 v16, 7, v16
  v_lshl_add_u32 v14, v14, 1, v16
  v_mul_u32_u24 v16, 3, v16
  v_sub_u32 v15, v15, v16
  v_lshl_add_u32 v15, v15, 9, s39
  v_cndmask_b32 v15, v15, v23, s[54:55]
  v_cndmask_b32 v16, v20, v21, s[54:55]
  v_mul_lo_u32 v14, v14, s36
  v_add3_u32 v216, v14, v15, v22
  v_add_u32 v217, v216, v16
  s_lshl_b32 s3, s35, 2
  s_add_u32 s3, s3, s48
  v_add_u32 v13, s3, v9
  v_mul_u32_u24 v14, 205, v13
  v_lshrrev_b32 v14, 10, v14
  v_mul_u32_u24 v15, 5, v14
  v_sub_u32 v15, v13, v15
  v_cmp_eq_u32 s[56:57], 2, v15
  v_mul_u32_u24 v16, 43, v15
  v_lshrrev_b32 v16, 7, v16
  v_lshl_add_u32 v14, v14, 1, v16
  v_mul_u32_u24 v16, 3, v16
  v_sub_u32 v15, v15, v16
  v_lshl_add_u32 v15, v15, 9, s39
  v_cndmask_b32 v15, v15, v23, s[56:57]
  v_cndmask_b32 v16, v20, v21, s[56:57]
  v_mul_lo_u32 v14, v14, s36
  v_add3_u32 v218, v14, v15, v22
  v_add_u32 v219, v218, v16
  s_add_u32 s3, s3, 2
  v_add_u32 v13, s3, v9
  v_mul_u32_u24 v14, 205, v13
  v_lshrrev_b32 v14, 10, v14
  v_mul_u32_u24 v15, 5, v14
  v_sub_u32 v15, v13, v15
  v_cmp_eq_u32 s[58:59], 2, v15
  v_mul_u32_u24 v16, 43, v15
  v_lshrrev_b32 v16, 7, v16
  v_lshl_add_u32 v14, v14, 1, v16
  v_mul_u32_u24 v16, 3, v16
  v_sub_u32 v15, v15, v16
  v_lshl_add_u32 v15, v15, 9, s39
  v_cndmask_b32 v15, v15, v23, s[58:59]
  v_cndmask_b32 v16, v20, v21, s[58:59]
  v_mul_lo_u32 v14, v14, s36
  v_add3_u32 v220, v14, v15, v22
  v_add_u32 v221, v220, v16
  s_barrier
  ds_read_b128 v[144:147], v176 offset:0
  ds_read_b64_tr_b16 v[152:153], v200 offset:0
  ds_read_b64_tr_b16 v[154:155], v200 offset:1024
  ds_read_b64_tr_b16 v[156:157], v201 offset:0
  ds_read_b64_tr_b16 v[158:159], v201 offset:1024
  ds_read_b128 v[148:151], v180 offset:0
  s_waitcnt lgkmcnt(3)
  v_mfma_f32_32x32x16_bf16 v[64:79], v[152:155], v[144:147], v[64:79]
  ds_read_b128 v[160:163], v177 offset:0
  ds_read_b64_tr_b16 v[168:169], v200 offset:4096
  ds_read_b64_tr_b16 v[170:171], v200 offset:5120
  s_waitcnt lgkmcnt(4)
  v_mfma_f32_32x32x16_bf16 v[80:95], v[156:159], v[144:147], v[80:95]
  ds_read_b64_tr_b16 v[172:173], v201 offset:4096
  ds_read_b64_tr_b16 v[174:175], v201 offset:5120
  ds_read_b128 v[164:167], v181 offset:0
  s_waitcnt lgkmcnt(6)
  v_mfma_f32_32x32x16_bf16 v[96:111], v[152:155], v[148:151], v[96:111]
  v_mfma_f32_32x32x16_bf16 v[112:127], v[156:159], v[148:151], v[112:127]
  v_mfma_f32_4x4x4_16b_bf16 v[132:135], v[144:145], v[144:145], v[132:135]
  v_mfma_f32_16x16x32_bf16 v[128:131], v[140:143], v[144:147], v[128:131]
  v_mfma_f32_16x16x32_bf16 v[136:139], v[140:143], v[152:155], v[136:139]
  v_mfma_f32_4x4x4_16b_bf16 v[132:135], v[146:147], v[146:147], v[132:135]
  s_waitcnt lgkmcnt(3)
  v_mfma_f32_32x32x16_bf16 v[64:79], v[168:171], v[160:163], v[64:79]
  ds_read_b128 v[144:147], v178 offset:0
  ds_read_b64_tr_b16 v[152:153], v200 offset:8192
  ds_read_b64_tr_b16 v[154:155], v200 offset:9216
  s_waitcnt lgkmcnt(4)
  v_mfma_f32_32x32x16_bf16 v[80:95], v[172:175], v[160:163], v[80:95]
  ds_read_b64_tr_b16 v[156:157], v201 offset:8192
  ds_read_b64_tr_b16 v[158:159], v201 offset:9216
  ds_read_b128 v[148:151], v182 offset:0
  s_waitcnt lgkmcnt(6)
  v_mfma_f32_32x32x16_bf16 v[96:111], v[168:171], v[164:167], v[96:111]
  v_mfma_f32_32x32x16_bf16 v[112:127], v[172:175], v[164:167], v[112:127]
  v_mfma_f32_4x4x4_16b_bf16 v[132:135], v[160:161], v[160:161], v[132:135]
  v_mfma_f32_16x16x32_bf16 v[128:131], v[140:143], v[160:163], v[128:131]
  v_mfma_f32_16x16x32_bf16 v[136:139], v[140:143], v[168:171], v[136:139]
  v_mfma_f32_4x4x4_16b_bf16 v[132:135], v[162:163], v[162:163], v[132:135]
  s_waitcnt lgkmcnt(3)
  v_mfma_f32_32x32x16_bf16 v[64:79], v[152:155], v[144:147], v[64:79]
  ds_read_b128 v[160:163], v179 offset:0
  ds_read_b64_tr_b16 v[168:169], v200 offset:12288
  ds_read_b64_tr_b16 v[170:171], v200 offset:13312
  s_waitcnt lgkmcnt(4)
  v_mfma_f32_32x32x16_bf16 v[80:95], v[156:159], v[144:147], v[80:95]
  ds_read_b64_tr_b16 v[172:173], v201 offset:12288
  ds_read_b64_tr_b16 v[174:175], v201 offset:13312
  ds_read_b128 v[164:167], v183 offset:0
  s_waitcnt lgkmcnt(6)
  v_mfma_f32_32x32x16_bf16 v[96:111], v[152:155], v[148:151], v[96:111]
  v_mfma_f32_32x32x16_bf16 v[112:127], v[156:159], v[148:151], v[112:127]
  v_mfma_f32_4x4x4_16b_bf16 v[132:135], v[144:145], v[144:145], v[132:135]
  v_mfma_f32_16x16x32_bf16 v[128:131], v[140:143], v[144:147], v[128:131]
  v_mfma_f32_16x16x32_bf16 v[136:139], v[140:143], v[152:155], v[136:139]
  v_mfma_f32_4x4x4_16b_bf16 v[132:135], v[146:147], v[146:147], v[132:135]
  s_waitcnt lgkmcnt(0)
  v_mfma_f32_32x32x16_bf16 v[64:79], v[168:171], v[160:163], v[64:79]
  v_mfma_f32_32x32x16_bf16 v[80:95], v[172:175], v[160:163], v[80:95]
  s_barrier
  v_mfma_f32_32x32x16_bf16 v[96:111], v[168:171], v[164:167], v[96:111]
  ds_read_b128 v[144:147], v176 offset:32768
  ds_read_b64_tr_b16 v[152:153], v200 offset:32768
  ds_read_b64_tr_b16 v[154:155], v200 offset:33792
  ds_read_b64_tr_b16 v[156:157], v201 offset:32768
  ds_read_b64_tr_b16 v[158:159], v201 offset:33792
  ds_read_b128 v[148:151], v180 offset:32768
  v_mfma_f32_32x32x16_bf16 v[112:127], v[172:175], v[164:167], v[112:127]
  v_mfma_f32_4x4x4_16b_bf16 v[132:135], v[160:161], v[160:161], v[132:135]
  v_mfma_f32_16x16x32_bf16 v[128:131], v[140:143], v[160:163], v[128:131]
  v_mfma_f32_16x16x32_bf16 v[136:139], v[140:143], v[168:171], v[136:139]
  v_mfma_f32_4x4x4_16b_bf16 v[132:135], v[162:163], v[162:163], v[132:135]
  s_waitcnt lgkmcnt(3)
  v_mfma_f32_32x32x16_bf16 v[64:79], v[152:155], v[144:147], v[64:79]
  ds_read_b128 v[160:163], v177 offset:32768
  ds_read_b64_tr_b16 v[168:169], v200 offset:36864
  ds_read_b64_tr_b16 v[170:171], v200 offset:37888
  s_waitcnt lgkmcnt(4)
  v_mfma_f32_32x32x16_bf16 v[80:95], v[156:159], v[144:147], v[80:95]
  ds_read_b64_tr_b16 v[172:173], v201 offset:36864
  ds_read_b64_tr_b16 v[174:175], v201 offset:37888
  ds_read_b128 v[164:167], v181 offset:32768
  s_waitcnt lgkmcnt(6)
  v_mfma_f32_32x32x16_bf16 v[96:111], v[152:155], v[148:151], v[96:111]
  v_mfma_f32_32x32x16_bf16 v[112:127], v[156:159], v[148:151], v[112:127]
  v_mfma_f32_4x4x4_16b_bf16 v[132:135], v[144:145], v[144:145], v[132:135]
  v_mfma_f32_16x16x32_bf16 v[128:131], v[140:143], v[144:147], v[128:131]
  v_mfma_f32_16x16x32_bf16 v[136:139], v[140:143], v[152:155], v[136:139]
  v_mfma_f32_4x4x4_16b_bf16 v[132:135], v[146:147], v[146:147], v[132:135]
  s_waitcnt lgkmcnt(3)
  v_mfma_f32_32x32x16_bf16 v[64:79], v[168:171], v[160:163], v[64:79]
  ds_read_b128 v[144:147], v178 offset:32768
  ds_read_b64_tr_b16 v[152:153], v200 offset:40960
  ds_read_b64_tr_b16 v[154:155], v200 offset:41984
  s_waitcnt lgkmcnt(4)
  v_mfma_f32_32x32x16_bf16 v[80:95], v[172:175], v[160:163], v[80:95]
  ds_read_b64_tr_b16 v[156:157], v201 offset:40960
  ds_read_b64_tr_b16 v[158:159], v201 offset:41984
  ds_read_b128 v[148:151], v182 offset:32768
  s_waitcnt lgkmcnt(6)
  v_mfma_f32_32x32x16_bf16 v[96:111], v[168:171], v[164:167], v[96:111]
  v_mfma_f32_32x32x16_bf16 v[112:127], v[172:175], v[164:167], v[112:127]
  v_mfma_f32_4x4x4_16b_bf16 v[132:135], v[160:161], v[160:161], v[132:135]
  v_mfma_f32_16x16x32_bf16 v[128:131], v[140:143], v[160:163], v[128:131]
  v_mfma_f32_16x16x32_bf16 v[136:139], v[140:143], v[168:171], v[136:139]
  v_mfma_f32_4x4x4_16b_bf16 v[132:135], v[162:163], v[162:163], v[132:135]
  s_waitcnt lgkmcnt(3)
  v_mfma_f32_32x32x16_bf16 v[64:79], v[152:155], v[144:147], v[64:79]
  ds_read_b128 v[160:163], v179 offset:32768
  ds_read_b64_tr_b16 v[168:169], v200 offset:45056
  ds_read_b64_tr_b16 v[170:171], v200 offset:46080
  s_waitcnt lgkmcnt(4)
  v_mfma_f32_32x32x16_bf16 v[80:95], v[156:159], v[144:147], v[80:95]
  ds_read_b64_tr_b16 v[172:173], v201 offset:45056
  ds_read_b64_tr_b16 v[174:175], v201 offset:46080
  ds_read_b128 v[164:167], v183 offset:32768
  s_waitcnt lgkmcnt(6)
  v_mfma_f32_32x32x16_bf16 v[96:111], v[152:155], v[148:151], v[96:111]
  v_mfma_f32_32x32x16_bf16 v[112:127], v[156:159], v[148:151], v[112:127]
  v_mfma_f32_4x4x4_16b_bf16 v[132:135], v[144:145], v[144:145], v[132:135]
  v_mfma_f32_16x16x32_bf16 v[128:131], v[140:143], v[144:147], v[128:131]
  v_mfma_f32_16x16x32_bf16 v[136:139], v[140:143], v[152:155], v[136:139]
  v_mfma_f32_4x4x4_16b_bf16 v[132:135], v[146:147], v[146:147], v[132:135]
  s_waitcnt lgkmcnt(0)
  v_mfma_f32_32x32x16_bf16 v[64:79], v[168:171], v[160:163], v[64:79]
  v_mfma_f32_32x32x16_bf16 v[80:95], v[172:175], v[160:163], v[80:95]
  s_barrier
  v_mfma_f32_32x32x16_bf16 v[96:111], v[168:171], v[164:167], v[96:111]
  ds_read_b128 v[144:147], v184 offset:0
  ds_read_b64_tr_b16 v[152:153], v202 offset:0
  ds_read_b64_tr_b16 v[154:155], v202 offset:1024
  ds_read_b64_tr_b16 v[156:157], v203 offset:0
  ds_read_b64_tr_b16 v[158:159], v203 offset:1024
  ds_read_b128 v[148:151], v188 offset:0
  v_mfma_f32_32x32x16_bf16 v[112:127], v[172:175], v[164:167], v[112:127]
  v_mfma_f32_4x4x4_16b_bf16 v[132:135], v[160:161], v[160:161], v[132:135]
  v_mfma_f32_16x16x32_bf16 v[128:131], v[140:143], v[160:163], v[128:131]
  v_mfma_f32_16x16x32_bf16 v[136:139], v[140:143], v[168:171], v[136:139]
  v_mfma_f32_4x4x4_16b_bf16 v[132:135], v[162:163], v[162:163], v[132:135]
  s_waitcnt lgkmcnt(3)
  v_mfma_f32_32x32x16_bf16 v[64:79], v[152:155], v[144:147], v[64:79]
  ds_read_b128 v[160:163], v185 offset:0
  ds_read_b64_tr_b16 v[168:169], v202 offset:4096
  ds_read_b64_tr_b16 v[170:171], v202 offset:5120
  s_waitcnt lgkmcnt(4)
  v_mfma_f32_32x32x16_bf16 v[80:95], v[156:159], v[144:147], v[80:95]
  ds_read_b64_tr_b16 v[172:173], v203 offset:4096
  ds_read_b64_tr_b16 v[174:175], v203 offset:5120
  ds_read_b128 v[164:167], v189 offset:0
  s_waitcnt lgkmcnt(6)
  v_mfma_f32_32x32x16_bf16 v[96:111], v[152:155], v[148:151], v[96:111]
  v_mfma_f32_32x32x16_bf16 v[112:127], v[156:159], v[148:151], v[112:127]
  v_mfma_f32_4x4x4_16b_bf16 v[132:135], v[144:145], v[144:145], v[132:135]
  v_mfma_f32_16x16x32_bf16 v[128:131], v[140:143], v[144:147], v[128:131]
  v_mfma_f32_16x16x32_bf16 v[136:139], v[140:143], v[152:155], v[136:139]
  v_mfma_f32_4x4x4_16b_bf16 v[132:135], v[146:147], v[146:147], v[132:135]
  s_waitcnt lgkmcnt(3)
  v_mfma_f32_32x32x16_bf16 v[64:79], v[168:171], v[160:163], v[64:79]
  ds_read_b128 v[144:147], v186 offset:0
  ds_read_b64_tr_b16 v[152:153], v202 offset:8192
  ds_read_b64_tr_b16 v[154:155], v202 offset:9216
  s_waitcnt lgkmcnt(4)
  v_mfma_f32_32x32x16_bf16 v[80:95], v[172:175], v[160:163], v[80:95]
  ds_read_b64_tr_b16 v[156:157], v203 offset:8192
  ds_read_b64_tr_b16 v[158:159], v203 offset:9216
  ds_read_b128 v[148:151], v190 offset:0
  s_waitcnt lgkmcnt(6)
  v_mfma_f32_32x32x16_bf16 v[96:111], v[168:171], v[164:167], v[96:111]
  v_mfma_f32_32x32x16_bf16 v[112:127], v[172:175], v[164:167], v[112:127]
  v_mfma_f32_4x4x4_16b_bf16 v[132:135], v[160:161], v[160:161], v[132:135]
  v_mfma_f32_16x16x32_bf16 v[128:131], v[140:143], v[160:163], v[128:131]
  v_mfma_f32_16x16x32_bf16 v[136:139], v[140:143], v[168:171], v[136:139]
  v_mfma_f32_4x4x4_16b_bf16 v[132:135], v[162:163], v[162:163], v[132:135]
  s_waitcnt lgkmcnt(3)
  v_mfma_f32_32x32x16_bf16 v[64:79], v[152:155], v[144:147], v[64:79]
  ds_read_b128 v[160:163], v187 offset:0
  ds_read_b64_tr_b16 v[168:169], v202 offset:12288
  ds_read_b64_tr_b16 v[170:171], v202 offset:13312
  s_waitcnt lgkmcnt(4)
  v_mfma_f32_32x32x16_bf16 v[80:95], v[156:159], v[144:147], v[80:95]
  ds_read_b64_tr_b16 v[172:173], v203 offset:12288
  ds_read_b64_tr_b16 v[174:175], v203 offset:13312
  ds_read_b128 v[164:167], v191 offset:0
  s_waitcnt lgkmcnt(6)
  v_mfma_f32_32x32x16_bf16 v[96:111], v[152:155], v[148:151], v[96:111]
  v_mfma_f32_32x32x16_bf16 v[112:127], v[156:159], v[148:151], v[112:127]
  v_mfma_f32_4x4x4_16b_bf16 v[132:135], v[144:145], v[144:145], v[132:135]
  v_mfma_f32_16x16x32_bf16 v[128:131], v[140:143], v[144:147], v[128:131]
  v_mfma_f32_16x16x32_bf16 v[136:139], v[140:143], v[152:155], v[136:139]
  v_mfma_f32_4x4x4_16b_bf16 v[132:135], v[146:147], v[146:147], v[132:135]
  s_waitcnt lgkmcnt(0)
  v_mfma_f32_32x32x16_bf16 v[64:79], v[168:171], v[160:163], v[64:79]
  v_mfma_f32_32x32x16_bf16 v[80:95], v[172:175], v[160:163], v[80:95]
  s_barrier
  v_mfma_f32_32x32x16_bf16 v[96:111], v[168:171], v[164:167], v[96:111]
  ds_read_b128 v[144:147], v184 offset:32768
  ds_read_b64_tr_b16 v[152:153], v202 offset:32768
  ds_read_b64_tr_b16 v[154:155], v202 offset:33792
  ds_read_b64_tr_b16 v[156:157], v203 offset:32768
  ds_read_b64_tr_b16 v[158:159], v203 offset:33792
  ds_read_b128 v[148:151], v188 offset:32768
  v_mfma_f32_32x32x16_bf16 v[112:127], v[172:175], v[164:167], v[112:127]
  v_mfma_f32_4x4x4_16b_bf16 v[132:135], v[160:161], v[160:161], v[132:135]
  v_mfma_f32_16x16x32_bf16 v[128:131], v[140:143], v[160:163], v[128:131]
  v_mfma_f32_16x16x32_bf16 v[136:139], v[140:143], v[168:171], v[136:139]
  v_mfma_f32_4x4x4_16b_bf16 v[132:135], v[162:163], v[162:163], v[132:135]
  s_waitcnt lgkmcnt(3)
  v_mfma_f32_32x32x16_bf16 v[64:79], v[152:155], v[144:147], v[64:79]
  ds_read_b128 v[160:163], v185 offset:32768
  ds_read_b64_tr_b16 v[168:169], v202 offset:36864
  ds_read_b64_tr_b16 v[170:171], v202 offset:37888
  s_waitcnt lgkmcnt(4)
  v_mfma_f32_32x32x16_bf16 v[80:95], v[156:159], v[144:147], v[80:95]
  ds_read_b64_tr_b16 v[172:173], v203 offset:36864
  ds_read_b64_tr_b16 v[174:175], v203 offset:37888
  ds_read_b128 v[164:167], v189 offset:32768
  s_waitcnt lgkmcnt(6)
  v_mfma_f32_32x32x16_bf16 v[96:111], v[152:155], v[148:151], v[96:111]
  v_mfma_f32_32x32x16_bf16 v[112:127], v[156:159], v[148:151], v[112:127]
  v_mfma_f32_4x4x4_16b_bf16 v[132:135], v[144:145], v[144:145], v[132:135]
  v_mfma_f32_16x16x32_bf16 v[128:131], v[140:143], v[144:147], v[128:131]
  v_mfma_f32_16x16x32_bf16 v[136:139], v[140:143], v[152:155], v[136:139]
  v_mfma_f32_4x4x4_16b_bf16 v[132:135], v[146:147], v[146:147], v[132:135]
  s_waitcnt lgkmcnt(3)
  v_mfma_f32_32x32x16_bf16 v[64:79], v[168:171], v[160:163], v[64:79]
  ds_read_b128 v[144:147], v186 offset:32768
  ds_read_b64_tr_b16 v[152:153], v202 offset:40960
  ds_read_b64_tr_b16 v[154:155], v202 offset:41984
  s_waitcnt lgkmcnt(4)
  v_mfma_f32_32x32x16_bf16 v[80:95], v[172:175], v[160:163], v[80:95]
  ds_read_b64_tr_b16 v[156:157], v203 offset:40960
  ds_read_b64_tr_b16 v[158:159], v203 offset:41984
  ds_read_b128 v[148:151], v190 offset:32768
  s_waitcnt lgkmcnt(6)
  v_mfma_f32_32x32x16_bf16 v[96:111], v[168:171], v[164:167], v[96:111]
  v_mfma_f32_32x32x16_bf16 v[112:127], v[172:175], v[164:167], v[112:127]
  v_mfma_f32_4x4x4_16b_bf16 v[132:135], v[160:161], v[160:161], v[132:135]
  v_mfma_f32_16x16x32_bf16 v[128:131], v[140:143], v[160:163], v[128:131]
  v_mfma_f32_16x16x32_bf16 v[136:139], v[140:143], v[168:171], v[136:139]
  v_mfma_f32_4x4x4_16b_bf16 v[132:135], v[162:163], v[162:163], v[132:135]
  s_waitcnt lgkmcnt(3)
  v_mfma_f32_32x32x16_bf16 v[64:79], v[152:155], v[144:147], v[64:79]
  ds_read_b128 v[160:163], v187 offset:32768
  ds_read_b64_tr_b16 v[168:169], v202 offset:45056
  ds_read_b64_tr_b16 v[170:171], v202 offset:46080
  s_waitcnt lgkmcnt(4)
  v_mfma_f32_32x32x16_bf16 v[80:95], v[156:159], v[144:147], v[80:95]
  ds_read_b64_tr_b16 v[172:173], v203 offset:45056
  ds_read_b64_tr_b16 v[174:175], v203 offset:46080
  ds_read_b128 v[164:167], v191 offset:32768
  s_waitcnt lgkmcnt(6)
  v_mfma_f32_32x32x16_bf16 v[96:111], v[152:155], v[148:151], v[96:111]
  v_mfma_f32_32x32x16_bf16 v[112:127], v[156:159], v[148:151], v[112:127]
  v_mfma_f32_4x4x4_16b_bf16 v[132:135], v[144:145], v[144:145], v[132:135]
  v_mfma_f32_16x16x32_bf16 v[128:131], v[140:143], v[144:147], v[128:131]
  v_mfma_f32_16x16x32_bf16 v[136:139], v[140:143], v[152:155], v[136:139]
  v_mfma_f32_4x4x4_16b_bf16 v[132:135], v[146:147], v[146:147], v[132:135]
  s_waitcnt lgkmcnt(0)
  v_mfma_f32_32x32x16_bf16 v[64:79], v[168:171], v[160:163], v[64:79]
  v_mfma_f32_32x32x16_bf16 v[80:95], v[172:175], v[160:163], v[80:95]
  s_barrier
  v_mfma_f32_32x32x16_bf16 v[96:111], v[168:171], v[164:167], v[96:111]
  ds_read_b128 v[144:147], v192 offset:0
  ds_read_b64_tr_b16 v[152:153], v204 offset:0
  ds_read_b64_tr_b16 v[154:155], v204 offset:1024
  ds_read_b64_tr_b16 v[156:157], v205 offset:0
  ds_read_b64_tr_b16 v[158:159], v205 offset:1024
  ds_read_b128 v[148:151], v196 offset:0
  v_mfma_f32_32x32x16_bf16 v[112:127], v[172:175], v[164:167], v[112:127]
  v_mfma_f32_4x4x4_16b_bf16 v[132:135], v[160:161], v[160:161], v[132:135]
  v_mfma_f32_16x16x32_bf16 v[128:131], v[140:143], v[160:163], v[128:131]
  v_mfma_f32_16x16x32_bf16 v[136:139], v[140:143], v[168:171], v[136:139]
  v_mfma_f32_4x4x4_16b_bf16 v[132:135], v[162:163], v[162:163], v[132:135]
  s_waitcnt lgkmcnt(3)
  v_mfma_f32_32x32x16_bf16 v[64:79], v[152:155], v[144:147], v[64:79]
  ds_read_b128 v[160:163], v193 offset:0
  ds_read_b64_tr_b16 v[168:169], v204 offset:4096
  ds_read_b64_tr_b16 v[170:171], v204 offset:5120
  s_waitcnt lgkmcnt(4)
  v_mfma_f32_32x32x16_bf16 v[80:95], v[156:159], v[144:147], v[80:95]
  ds_read_b64_tr_b16 v[172:173], v205 offset:4096
  ds_read_b64_tr_b16 v[174:175], v205 offset:5120
  ds_read_b128 v[164:167], v197 offset:0
  s_waitcnt lgkmcnt(6)
  v_mfma_f32_32x32x16_bf16 v[96:111], v[152:155], v[148:151], v[96:111]
  v_mfma_f32_32x32x16_bf16 v[112:127], v[156:159], v[148:151], v[112:127]
  v_mfma_f32_4x4x4_16b_bf16 v[132:135], v[144:145], v[144:145], v[132:135]
  v_mfma_f32_16x16x32_bf16 v[128:131], v[140:143], v[144:147], v[128:131]
  v_mfma_f32_16x16x32_bf16 v[136:139], v[140:143], v[152:155], v[136:139]
  v_mfma_f32_4x4x4_16b_bf16 v[132:135], v[146:147], v[146:147], v[132:135]
  s_waitcnt lgkmcnt(3)
  v_mfma_f32_32x32x16_bf16 v[64:79], v[168:171], v[160:163], v[64:79]
  ds_read_b128 v[144:147], v194 offset:0
  ds_read_b64_tr_b16 v[152:153], v204 offset:8192
  ds_read_b64_tr_b16 v[154:155], v204 offset:9216
  s_waitcnt lgkmcnt(4)
  v_mfma_f32_32x32x16_bf16 v[80:95], v[172:175], v[160:163], v[80:95]
  ds_read_b64_tr_b16 v[156:157], v205 offset:8192
  ds_read_b64_tr_b16 v[158:159], v205 offset:9216
  ds_read_b128 v[148:151], v198 offset:0
  s_waitcnt lgkmcnt(6)
  v_mfma_f32_32x32x16_bf16 v[96:111], v[168:171], v[164:167], v[96:111]
  v_mfma_f32_32x32x16_bf16 v[112:127], v[172:175], v[164:167], v[112:127]
  v_mfma_f32_4x4x4_16b_bf16 v[132:135], v[160:161], v[160:161], v[132:135]
  v_mfma_f32_16x16x32_bf16 v[128:131], v[140:143], v[160:163], v[128:131]
  v_mfma_f32_16x16x32_bf16 v[136:139], v[140:143], v[168:171], v[136:139]
  v_mfma_f32_4x4x4_16b_bf16 v[132:135], v[162:163], v[162:163], v[132:135]
  s_waitcnt lgkmcnt(3)
  v_mfma_f32_32x32x16_bf16 v[64:79], v[152:155], v[144:147], v[64:79]
  ds_read_b128 v[160:163], v195 offset:0
  ds_read_b64_tr_b16 v[168:169], v204 offset:12288
  ds_read_b64_tr_b16 v[170:171], v204 offset:13312
  s_waitcnt lgkmcnt(4)
  v_mfma_f32_32x32x16_bf16 v[80:95], v[156:159], v[144:147], v[80:95]
  ds_read_b64_tr_b16 v[172:173], v205 offset:12288
  ds_read_b64_tr_b16 v[174:175], v205 offset:13312
  ds_read_b128 v[164:167], v199 offset:0
  s_waitcnt lgkmcnt(6)
  v_mfma_f32_32x32x16_bf16 v[96:111], v[152:155], v[148:151], v[96:111]
  v_mfma_f32_32x32x16_bf16 v[112:127], v[156:159], v[148:151], v[112:127]
  v_mfma_f32_4x4x4_16b_bf16 v[132:135], v[144:145], v[144:145], v[132:135]
  v_mfma_f32_16x16x32_bf16 v[128:131], v[140:143], v[144:147], v[128:131]
  v_mfma_f32_16x16x32_bf16 v[136:139], v[140:143], v[152:155], v[136:139]
  v_mfma_f32_4x4x4_16b_bf16 v[132:135], v[146:147], v[146:147], v[132:135]
  s_waitcnt lgkmcnt(0)
  v_mfma_f32_32x32x16_bf16 v[64:79], v[168:171], v[160:163], v[64:79]
  v_mfma_f32_32x32x16_bf16 v[80:95], v[172:175], v[160:163], v[80:95]
  s_barrier
  v_mfma_f32_32x32x16_bf16 v[96:111], v[168:171], v[164:167], v[96:111]
  ds_read_b128 v[144:147], v176 offset:0
  ds_read_b64_tr_b16 v[152:153], v200 offset:0
  ds_read_b64_tr_b16 v[154:155], v200 offset:1024
  ds_read_b64_tr_b16 v[156:157], v201 offset:0
  ds_read_b64_tr_b16 v[158:159], v201 offset:1024
  ds_read_b128 v[148:151], v180 offset:0
  v_mfma_f32_32x32x16_bf16 v[112:127], v[172:175], v[164:167], v[112:127]
  v_mfma_f32_4x4x4_16b_bf16 v[132:135], v[160:161], v[160:161], v[132:135]
  v_mfma_f32_16x16x32_bf16 v[128:131], v[140:143], v[160:163], v[128:131]
  v_mfma_f32_16x16x32_bf16 v[136:139], v[140:143], v[168:171], v[136:139]
  v_mfma_f32_4x4x4_16b_bf16 v[132:135], v[162:163], v[162:163], v[132:135]
  s_waitcnt lgkmcnt(3)
  v_mfma_f32_32x32x16_bf16 v[64:79], v[152:155], v[144:147], v[64:79]
  ds_read_b128 v[160:163], v177 offset:0
  ds_read_b64_tr_b16 v[168:169], v200 offset:4096
  ds_read_b64_tr_b16 v[170:171], v200 offset:5120
  s_waitcnt lgkmcnt(4)
  v_mfma_f32_32x32x16_bf16 v[80:95], v[156:159], v[144:147], v[80:95]
  ds_read_b64_tr_b16 v[172:173], v201 offset:4096
  ds_read_b64_tr_b16 v[174:175], v201 offset:5120
  ds_read_b128 v[164:167], v181 offset:0
  s_waitcnt lgkmcnt(6)
  v_mfma_f32_32x32x16_bf16 v[96:111], v[152:155], v[148:151], v[96:111]
  v_mfma_f32_32x32x16_bf16 v[112:127], v[156:159], v[148:151], v[112:127]
  v_mfma_f32_4x4x4_16b_bf16 v[132:135], v[144:145], v[144:145], v[132:135]
  v_mfma_f32_16x16x32_bf16 v[128:131], v[140:143], v[144:147], v[128:131]
  v_mfma_f32_16x16x32_bf16 v[136:139], v[140:143], v[152:155], v[136:139]
  v_mfma_f32_4x4x4_16b_bf16 v[132:135], v[146:147], v[146:147], v[132:135]
  s_waitcnt lgkmcnt(3)
  v_mfma_f32_32x32x16_bf16 v[64:79], v[168:171], v[160:163], v[64:79]
  ds_read_b128 v[144:147], v178 offset:0
  ds_read_b64_tr_b16 v[152:153], v200 offset:8192
  ds_read_b64_tr_b16 v[154:155], v200 offset:9216
  s_waitcnt lgkmcnt(4)
  v_mfma_f32_32x32x16_bf16 v[80:95], v[172:175], v[160:163], v[80:95]
  ds_read_b64_tr_b16 v[156:157], v201 offset:8192
  ds_read_b64_tr_b16 v[158:159], v201 offset:9216
  ds_read_b128 v[148:151], v182 offset:0
  s_waitcnt lgkmcnt(6)
  v_mfma_f32_32x32x16_bf16 v[96:111], v[168:171], v[164:167], v[96:111]
  v_mfma_f32_32x32x16_bf16 v[112:127], v[172:175], v[164:167], v[112:127]
  v_mfma_f32_4x4x4_16b_bf16 v[132:135], v[160:161], v[160:161], v[132:135]
  v_mfma_f32_16x16x32_bf16 v[128:131], v[140:143], v[160:163], v[128:131]
  v_mfma_f32_16x16x32_bf16 v[136:139], v[140:143], v[168:171], v[136:139]
  v_mfma_f32_4x4x4_16b_bf16 v[132:135], v[162:163], v[162:163], v[132:135]
  s_waitcnt lgkmcnt(3)
  v_mfma_f32_32x32x16_bf16 v[64:79], v[152:155], v[144:147], v[64:79]
  ds_read_b128 v[160:163], v179 offset:0
  ds_read_b64_tr_b16 v[168:169], v200 offset:12288
  ds_read_b64_tr_b16 v[170:171], v200 offset:13312
  s_waitcnt lgkmcnt(4)
  v_mfma_f32_32x32x16_bf16 v[80:95], v[156:159], v[144:147], v[80:95]
  ds_read_b64_tr_b16 v[172:173], v201 offset:12288
  ds_read_b64_tr_b16 v[174:175], v201 offset:13312
  ds_read_b128 v[164:167], v183 offset:0
  s_waitcnt lgkmcnt(6)
  v_mfma_f32_32x32x16_bf16 v[96:111], v[152:155], v[148:151], v[96:111]
  v_mfma_f32_32x32x16_bf16 v[112:127], v[156:159], v[148:151], v[112:127]
  v_mfma_f32_4x4x4_16b_bf16 v[132:135], v[144:145], v[144:145], v[132:135]
  v_mfma_f32_16x16x32_bf16 v[128:131], v[140:143], v[144:147], v[128:131]
  v_mfma_f32_16x16x32_bf16 v[136:139], v[140:143], v[152:155], v[136:139]
  v_mfma_f32_4x4x4_16b_bf16 v[132:135], v[146:147], v[146:147], v[132:135]
  s_waitcnt lgkmcnt(0)
  v_mfma_f32_32x32x16_bf16 v[64:79], v[168:171], v[160:163], v[64:79]
  v_mfma_f32_32x32x16_bf16 v[80:95], v[172:175], v[160:163], v[80:95]
  s_barrier
  v_mfma_f32_32x32x16_bf16 v[96:111], v[168:171], v[164:167], v[96:111]
  ds_read_b128 v[144:147], v176 offset:32768
  ds_read_b64_tr_b16 v[152:153], v200 offset:32768
  ds_read_b64_tr_b16 v[154:155], v200 offset:33792
  ds_read_b64_tr_b16 v[156:157], v201 offset:32768
  ds_read_b64_tr_b16 v[158:159], v201 offset:33792
  ds_read_b128 v[148:151], v180 offset:32768
  v_mfma_f32_32x32x16_bf16 v[112:127], v[172:175], v[164:167], v[112:127]
  v_mfma_f32_4x4x4_16b_bf16 v[132:135], v[160:161], v[160:161], v[132:135]
  v_mfma_f32_16x16x32_bf16 v[128:131], v[140:143], v[160:163], v[128:131]
  v_mfma_f32_16x16x32_bf16 v[136:139], v[140:143], v[168:171], v[136:139]
  v_mfma_f32_4x4x4_16b_bf16 v[132:135], v[162:163], v[162:163], v[132:135]
  s_waitcnt lgkmcnt(3)
  v_mfma_f32_32x32x16_bf16 v[64:79], v[152:155], v[144:147], v[64:79]
  ds_read_b128 v[160:163], v177 offset:32768
  ds_read_b64_tr_b16 v[168:169], v200 offset:36864
  ds_read_b64_tr_b16 v[170:171], v200 offset:37888
  s_waitcnt lgkmcnt(4)
  v_mfma_f32_32x32x16_bf16 v[80:95], v[156:159], v[144:147], v[80:95]
  ds_read_b64_tr_b16 v[172:173], v201 offset:36864
  ds_read_b64_tr_b16 v[174:175], v201 offset:37888
  ds_read_b128 v[164:167], v181 offset:32768
  s_waitcnt lgkmcnt(6)
  v_mfma_f32_32x32x16_bf16 v[96:111], v[152:155], v[148:151], v[96:111]
  v_mfma_f32_32x32x16_bf16 v[112:127], v[156:159], v[148:151], v[112:127]
  v_mfma_f32_4x4x4_16b_bf16 v[132:135], v[144:145], v[144:145], v[132:135]
  v_mfma_f32_16x16x32_bf16 v[128:131], v[140:143], v[144:147], v[128:131]
  v_mfma_f32_16x16x32_bf16 v[136:139], v[140:143], v[152:155], v[136:139]
  v_mfma_f32_4x4x4_16b_bf16 v[132:135], v[146:147], v[146:147], v[132:135]
  s_waitcnt lgkmcnt(3)
  v_mfma_f32_32x32x16_bf16 v[64:79], v[168:171], v[160:163], v[64:79]
  ds_read_b128 v[144:147], v178 offset:32768
  ds_read_b64_tr_b16 v[152:153], v200 offset:40960
  ds_read_b64_tr_b16 v[154:155], v200 offset:41984
  s_waitcnt lgkmcnt(4)
  v_mfma_f32_32x32x16_bf16 v[80:95], v[172:175], v[160:163], v[80:95]
  ds_read_b64_tr_b16 v[156:157], v201 offset:40960
  ds_read_b64_tr_b16 v[158:159], v201 offset:41984
  ds_read_b128 v[148:151], v182 offset:32768
  s_waitcnt lgkmcnt(6)
  v_mfma_f32_32x32x16_bf16 v[96:111], v[168:171], v[164:167], v[96:111]
  v_mfma_f32_32x32x16_bf16 v[112:127], v[172:175], v[164:167], v[112:127]
  v_mfma_f32_4x4x4_16b_bf16 v[132:135], v[160:161], v[160:161], v[132:135]
  v_mfma_f32_16x16x32_bf16 v[128:131], v[140:143], v[160:163], v[128:131]
  v_mfma_f32_16x16x32_bf16 v[136:139], v[140:143], v[168:171], v[136:139]
  v_mfma_f32_4x4x4_16b_bf16 v[132:135], v[162:163], v[162:163], v[132:135]
  s_waitcnt lgkmcnt(3)
  v_mfma_f32_32x32x16_bf16 v[64:79], v[152:155], v[144:147], v[64:79]
  ds_read_b128 v[160:163], v179 offset:32768
  ds_read_b64_tr_b16 v[168:169], v200 offset:45056
  ds_read_b64_tr_b16 v[170:171], v200 offset:46080
  s_waitcnt lgkmcnt(4)
  v_mfma_f32_32x32x16_bf16 v[80:95], v[156:159], v[144:147], v[80:95]
  ds_read_b64_tr_b16 v[172:173], v201 offset:45056
  ds_read_b64_tr_b16 v[174:175], v201 offset:46080
  ds_read_b128 v[164:167], v183 offset:32768
  s_waitcnt lgkmcnt(6)
  v_mfma_f32_32x32x16_bf16 v[96:111], v[152:155], v[148:151], v[96:111]
  v_mfma_f32_32x32x16_bf16 v[112:127], v[156:159], v[148:151], v[112:127]
  v_mfma_f32_4x4x4_16b_bf16 v[132:135], v[144:145], v[144:145], v[132:135]
  v_mfma_f32_16x16x32_bf16 v[128:131], v[140:143], v[144:147], v[128:131]
  v_mfma_f32_16x16x32_bf16 v[136:139], v[140:143], v[152:155], v[136:139]
  v_mfma_f32_4x4x4_16b_bf16 v[132:135], v[146:147], v[146:147], v[132:135]
  s_waitcnt lgkmcnt(0)
  v_mfma_f32_32x32x16_bf16 v[64:79], v[168:171], v[160:163], v[64:79]
  v_mfma_f32_32x32x16_bf16 v[80:95], v[172:175], v[160:163], v[80:95]
  s_barrier
  v_mfma_f32_32x32x16_bf16 v[96:111], v[168:171], v[164:167], v[96:111]
  ds_read_b128 v[144:147], v184 offset:0
  ds_read_b64_tr_b16 v[152:153], v202 offset:0
  ds_read_b64_tr_b16 v[154:155], v202 offset:1024
  ds_read_b64_tr_b16 v[156:157], v203 offset:0
  ds_read_b64_tr_b16 v[158:159], v203 offset:1024
  ds_read_b128 v[148:151], v188 offset:0
  v_mfma_f32_32x32x16_bf16 v[112:127], v[172:175], v[164:167], v[112:127]
  v_mfma_f32_4x4x4_16b_bf16 v[132:135], v[160:161], v[160:161], v[132:135]
  v_mfma_f32_16x16x32_bf16 v[128:131], v[140:143], v[160:163], v[128:131]
  v_mfma_f32_16x16x32_bf16 v[136:139], v[140:143], v[168:171], v[136:139]
  v_mfma_f32_4x4x4_16b_bf16 v[132:135], v[162:163], v[162:163], v[132:135]
  s_waitcnt lgkmcnt(3)
  v_mfma_f32_32x32x16_bf16 v[64:79], v[152:155], v[144:147], v[64:79]
  ds_read_b128 v[160:163], v185 offset:0
  ds_read_b64_tr_b16 v[168:169], v202 offset:4096
  ds_read_b64_tr_b16 v[170:171], v202 offset:5120
  s_waitcnt lgkmcnt(4)
  v_mfma_f32_32x32x16_bf16 v[80:95], v[156:159], v[144:147], v[80:95]
  ds_read_b64_tr_b16 v[172:173], v203 offset:4096
  ds_read_b64_tr_b16 v[174:175], v203 offset:5120
  ds_read_b128 v[164:167], v189 offset:0
  s_waitcnt lgkmcnt(6)
  v_mfma_f32_32x32x16_bf16 v[96:111], v[152:155], v[148:151], v[96:111]
  v_mfma_f32_32x32x16_bf16 v[112:127], v[156:159], v[148:151], v[112:127]
  v_mfma_f32_4x4x4_16b_bf16 v[132:135], v[144:145], v[144:145], v[132:135]
  v_mfma_f32_16x16x32_bf16 v[128:131], v[140:143], v[144:147], v[128:131]
  v_mfma_f32_16x16x32_bf16 v[136:139], v[140:143], v[152:155], v[136:139]
  v_mfma_f32_4x4x4_16b_bf16 v[132:135], v[146:147], v[146:147], v[132:135]
  s_waitcnt lgkmcnt(3)
  v_mfma_f32_32x32x16_bf16 v[64:79], v[168:171], v[160:163], v[64:79]
  ds_read_b128 v[144:147], v186 offset:0
  ds_read_b64_tr_b16 v[152:153], v202 offset:8192
  ds_read_b64_tr_b16 v[154:155], v202 offset:9216
  s_waitcnt lgkmcnt(4)
  v_mfma_f32_32x32x16_bf16 v[80:95], v[172:175], v[160:163], v[80:95]
  ds_read_b64_tr_b16 v[156:157], v203 offset:8192
  ds_read_b64_tr_b16 v[158:159], v203 offset:9216
  ds_read_b128 v[148:151], v190 offset:0
  s_waitcnt lgkmcnt(6)
  v_mfma_f32_32x32x16_bf16 v[96:111], v[168:171], v[164:167], v[96:111]
  v_mfma_f32_32x32x16_bf16 v[112:127], v[172:175], v[164:167], v[112:127]
  v_mfma_f32_4x4x4_16b_bf16 v[132:135], v[160:161], v[160:161], v[132:135]
  v_mfma_f32_16x16x32_bf16 v[128:131], v[140:143], v[160:163], v[128:131]
  v_mfma_f32_16x16x32_bf16 v[136:139], v[140:143], v[168:171], v[136:139]
  v_mfma_f32_4x4x4_16b_bf16 v[132:135], v[162:163], v[162:163], v[132:135]
  s_waitcnt lgkmcnt(3)
  v_mfma_f32_32x32x16_bf16 v[64:79], v[152:155], v[144:147], v[64:79]
  ds_read_b128 v[160:163], v187 offset:0
  ds_read_b64_tr_b16 v[168:169], v202 offset:12288
  ds_read_b64_tr_b16 v[170:171], v202 offset:13312
  s_waitcnt lgkmcnt(4)
  v_mfma_f32_32x32x16_bf16 v[80:95], v[156:159], v[144:147], v[80:95]
  ds_read_b64_tr_b16 v[172:173], v203 offset:12288
  ds_read_b64_tr_b16 v[174:175], v203 offset:13312
  ds_read_b128 v[164:167], v191 offset:0
  s_waitcnt lgkmcnt(6)
  v_mfma_f32_32x32x16_bf16 v[96:111], v[152:155], v[148:151], v[96:111]
  v_mfma_f32_32x32x16_bf16 v[112:127], v[156:159], v[148:151], v[112:127]
  v_mfma_f32_4x4x4_16b_bf16 v[132:135], v[144:145], v[144:145], v[132:135]
  v_mfma_f32_16x16x32_bf16 v[128:131], v[140:143], v[144:147], v[128:131]
  v_mfma_f32_16x16x32_bf16 v[136:139], v[140:143], v[152:155], v[136:139]
  v_mfma_f32_4x4x4_16b_bf16 v[132:135], v[146:147], v[146:147], v[132:135]
  s_waitcnt lgkmcnt(0)
  v_mfma_f32_32x32x16_bf16 v[64:79], v[168:171], v[160:163], v[64:79]
  v_mfma_f32_32x32x16_bf16 v[80:95], v[172:175], v[160:163], v[80:95]
  s_barrier
  v_mfma_f32_32x32x16_bf16 v[96:111], v[168:171], v[164:167], v[96:111]
  ds_read_b128 v[144:147], v184 offset:32768
  ds_read_b64_tr_b16 v[152:153], v202 offset:32768
  ds_read_b64_tr_b16 v[154:155], v202 offset:33792
  ds_read_b64_tr_b16 v[156:157], v203 offset:32768
  ds_read_b64_tr_b16 v[158:159], v203 offset:33792
  ds_read_b128 v[148:151], v188 offset:32768
  v_mfma_f32_32x32x16_bf16 v[112:127], v[172:175], v[164:167], v[112:127]
  v_mfma_f32_4x4x4_16b_bf16 v[132:135], v[160:161], v[160:161], v[132:135]
  v_mfma_f32_16x16x32_bf16 v[128:131], v[140:143], v[160:163], v[128:131]
  v_mfma_f32_16x16x32_bf16 v[136:139], v[140:143], v[168:171], v[136:139]
  v_mfma_f32_4x4x4_16b_bf16 v[132:135], v[162:163], v[162:163], v[132:135]
  s_waitcnt lgkmcnt(3)
  v_mfma_f32_32x32x16_bf16 v[64:79], v[152:155], v[144:147], v[64:79]
  ds_read_b128 v[160:163], v185 offset:32768
  ds_read_b64_tr_b16 v[168:169], v202 offset:36864
  ds_read_b64_tr_b16 v[170:171], v202 offset:37888
  s_waitcnt lgkmcnt(4)
  v_mfma_f32_32x32x16_bf16 v[80:95], v[156:159], v[144:147], v[80:95]
  ds_read_b64_tr_b16 v[172:173], v203 offset:36864
  ds_read_b64_tr_b16 v[174:175], v203 offset:37888
  ds_read_b128 v[164:167], v189 offset:32768
  s_waitcnt lgkmcnt(6)
  v_mfma_f32_32x32x16_bf16 v[96:111], v[152:155], v[148:151], v[96:111]
  v_mfma_f32_32x32x16_bf16 v[112:127], v[156:159], v[148:151], v[112:127]
  v_mfma_f32_4x4x4_16b_bf16 v[132:135], v[144:145], v[144:145], v[132:135]
  v_mfma_f32_16x16x32_bf16 v[128:131], v[140:143], v[144:147], v[128:131]
  v_mfma_f32_16x16x32_bf16 v[136:139], v[140:143], v[152:155], v[136:139]
  v_mfma_f32_4x4x4_16b_bf16 v[132:135], v[146:147], v[146:147], v[132:135]
  s_waitcnt lgkmcnt(3)
  v_mfma_f32_32x32x16_bf16 v[64:79], v[168:171], v[160:163], v[64:79]
  ds_read_b128 v[144:147], v186 offset:32768
  ds_read_b64_tr_b16 v[152:153], v202 offset:40960
  ds_read_b64_tr_b16 v[154:155], v202 offset:41984
  s_waitcnt lgkmcnt(4)
  v_mfma_f32_32x32x16_bf16 v[80:95], v[172:175], v[160:163], v[80:95]
  ds_read_b64_tr_b16 v[156:157], v203 offset:40960
  ds_read_b64_tr_b16 v[158:159], v203 offset:41984
  ds_read_b128 v[148:151], v190 offset:32768
  s_waitcnt lgkmcnt(6)
  v_mfma_f32_32x32x16_bf16 v[96:111], v[168:171], v[164:167], v[96:111]
  v_mfma_f32_32x32x16_bf16 v[112:127], v[172:175], v[164:167], v[112:127]
  v_mfma_f32_4x4x4_16b_bf16 v[132:135], v[160:161], v[160:161], v[132:135]
  v_mfma_f32_16x16x32_bf16 v[128:131], v[140:143], v[160:163], v[128:131]
  v_mfma_f32_16x16x32_bf16 v[136:139], v[140:143], v[168:171], v[136:139]
  v_mfma_f32_4x4x4_16b_bf16 v[132:135], v[162:163], v[162:163], v[132:135]
  s_waitcnt lgkmcnt(3)
  v_mfma_f32_32x32x16_bf16 v[64:79], v[152:155], v[144:147], v[64:79]
  ds_read_b128 v[160:163], v187 offset:32768
  ds_read_b64_tr_b16 v[168:169], v202 offset:45056
  ds_read_b64_tr_b16 v[170:171], v202 offset:46080
  s_waitcnt lgkmcnt(4)
  v_mfma_f32_32x32x16_bf16 v[80:95], v[156:159], v[144:147], v[80:95]
  ds_read_b64_tr_b16 v[172:173], v203 offset:45056
  ds_read_b64_tr_b16 v[174:175], v203 offset:46080
  ds_read_b128 v[164:167], v191 offset:32768
  s_waitcnt lgkmcnt(6)
  v_mfma_f32_32x32x16_bf16 v[96:111], v[152:155], v[148:151], v[96:111]
  v_mfma_f32_32x32x16_bf16 v[112:127], v[156:159], v[148:151], v[112:127]
  v_mfma_f32_4x4x4_16b_bf16 v[132:135], v[144:145], v[144:145], v[132:135]
  v_mfma_f32_16x16x32_bf16 v[128:131], v[140:143], v[144:147], v[128:131]
  v_mfma_f32_16x16x32_bf16 v[136:139], v[140:143], v[152:155], v[136:139]
  v_mfma_f32_4x4x4_16b_bf16 v[132:135], v[146:147], v[146:147], v[132:135]
  s_waitcnt lgkmcnt(0)
  v_mfma_f32_32x32x16_bf16 v[64:79], v[168:171], v[160:163], v[64:79]
  v_mfma_f32_32x32x16_bf16 v[80:95], v[172:175], v[160:163], v[80:95]
  s_barrier
  v_mfma_f32_32x32x16_bf16 v[96:111], v[168:171], v[164:167], v[96:111]
  ds_read_b128 v[144:147], v192 offset:0
  ds_read_b64_tr_b16 v[152:153], v204 offset:0
  ds_read_b64_tr_b16 v[154:155], v204 offset:1024
  ds_read_b64_tr_b16 v[156:157], v205 offset:0
  ds_read_b64_tr_b16 v[158:159], v205 offset:1024
  ds_read_b128 v[148:151], v196 offset:0
  v_mfma_f32_32x32x16_bf16 v[112:127], v[172:175], v[164:167], v[112:127]
  v_mfma_f32_4x4x4_16b_bf16 v[132:135], v[160:161], v[160:161], v[132:135]
  v_mfma_f32_16x16x32_bf16 v[128:131], v[140:143], v[160:163], v[128:131]
  v_mfma_f32_16x16x32_bf16 v[136:139], v[140:143], v[168:171], v[136:139]
  v_mfma_f32_4x4x4_16b_bf16 v[132:135], v[162:163], v[162:163], v[132:135]
  s_waitcnt lgkmcnt(3)
  v_mfma_f32_32x32x16_bf16 v[64:79], v[152:155], v[144:147], v[64:79]
  ds_read_b128 v[160:163], v193 offset:0
  ds_read_b64_tr_b16 v[168:169], v204 offset:4096
  ds_read_b64_tr_b16 v[170:171], v204 offset:5120
  s_waitcnt lgkmcnt(4)
  v_mfma_f32_32x32x16_bf16 v[80:95], v[156:159], v[144:147], v[80:95]
  ds_read_b64_tr_b16 v[172:173], v205 offset:4096
  ds_read_b64_tr_b16 v[174:175], v205 offset:5120
  ds_read_b128 v[164:167], v197 offset:0
  s_waitcnt lgkmcnt(6)
  v_mfma_f32_32x32x16_bf16 v[96:111], v[152:155], v[148:151], v[96:111]
  v_mfma_f32_32x32x16_bf16 v[112:127], v[156:159], v[148:151], v[112:127]
  v_mfma_f32_4x4x4_16b_bf16 v[132:135], v[144:145], v[144:145], v[132:135]
  v_mfma_f32_16x16x32_bf16 v[128:131], v[140:143], v[144:147], v[128:131]
  v_mfma_f32_16x16x32_bf16 v[136:139], v[140:143], v[152:155], v[136:139]
  v_mfma_f32_4x4x4_16b_bf16 v[132:135], v[146:147], v[146:147], v[132:135]
  s_waitcnt lgkmcnt(3)
  v_mfma_f32_32x32x16_bf16 v[64:79], v[168:171], v[160:163], v[64:79]
  ds_read_b128 v[144:147], v194 offset:0
  ds_read_b64_tr_b16 v[152:153], v204 offset:8192
  ds_read_b64_tr_b16 v[154:155], v204 offset:9216
  s_waitcnt lgkmcnt(4)
  v_mfma_f32_32x32x16_bf16 v[80:95], v[172:175], v[160:163], v[80:95]
  ds_read_b64_tr_b16 v[156:157], v205 offset:8192
  ds_read_b64_tr_b16 v[158:159], v205 offset:9216
  ds_read_b128 v[148:151], v198 offset:0
  s_waitcnt lgkmcnt(6)
  v_mfma_f32_32x32x16_bf16 v[96:111], v[168:171], v[164:167], v[96:111]
  v_mfma_f32_32x32x16_bf16 v[112:127], v[172:175], v[164:167], v[112:127]
  v_mfma_f32_4x4x4_16b_bf16 v[132:135], v[160:161], v[160:161], v[132:135]
  v_mfma_f32_16x16x32_bf16 v[128:131], v[140:143], v[160:163], v[128:131]
  v_mfma_f32_16x16x32_bf16 v[136:139], v[140:143], v[168:171], v[136:139]
  v_mfma_f32_4x4x4_16b_bf16 v[132:135], v[162:163], v[162:163], v[132:135]
  s_waitcnt lgkmcnt(3)
  v_mfma_f32_32x32x16_bf16 v[64:79], v[152:155], v[144:147], v[64:79]
  ds_read_b128 v[160:163], v195 offset:0
  ds_read_b64_tr_b16 v[168:169], v204 offset:12288
  ds_read_b64_tr_b16 v[170:171], v204 offset:13312
  s_waitcnt lgkmcnt(4)
  v_mfma_f32_32x32x16_bf16 v[80:95], v[156:159], v[144:147], v[80:95]
  ds_read_b64_tr_b16 v[172:173], v205 offset:12288
  ds_read_b64_tr_b16 v[174:175], v205 offset:13312
  ds_read_b128 v[164:167], v199 offset:0
  s_waitcnt lgkmcnt(6)
  v_mfma_f32_32x32x16_bf16 v[96:111], v[152:155], v[148:151], v[96:111]
  v_mfma_f32_32x32x16_bf16 v[112:127], v[156:159], v[148:151], v[112:127]
  v_mfma_f32_4x4x4_16b_bf16 v[132:135], v[144:145], v[144:145], v[132:135]
  v_mfma_f32_16x16x32_bf16 v[128:131], v[140:143], v[144:147], v[128:131]
  v_mfma_f32_16x16x32_bf16 v[136:139], v[140:143], v[152:155], v[136:139]
  v_mfma_f32_4x4x4_16b_bf16 v[132:135], v[146:147], v[146:147], v[132:135]
  s_waitcnt lgkmcnt(0)
  v_mfma_f32_32x32x16_bf16 v[64:79], v[168:171], v[160:163], v[64:79]
  v_mfma_f32_32x32x16_bf16 v[80:95], v[172:175], v[160:163], v[80:95]
  v_mfma_f32_32x32x16_bf16 v[96:111], v[168:171], v[164:167], v[96:111]
  v_mfma_f32_32x32x16_bf16 v[112:127], v[172:175], v[164:167], v[112:127]
  v_mfma_f32_4x4x4_16b_bf16 v[132:135], v[160:161], v[160:161], v[132:135]
  v_mfma_f32_16x16x32_bf16 v[128:131], v[140:143], v[160:163], v[128:131]
  v_mfma_f32_16x16x32_bf16 v[136:139], v[140:143], v[168:171], v[136:139]
  v_mfma_f32_4x4x4_16b_bf16 v[132:135], v[162:163], v[162:163], v[132:135]
  s_nop 15
  v_and_b32 v13, 3, v0
  v_cmp_eq_u32 vcc, 1, v13
  v_cmp_eq_u32 s[42:43], 2, v13
  v_cmp_eq_u32 s[44:45], 3, v13
  v_and_b32 v14, 16, v0
  v_cmp_ne_u32 s[46:47], 0, v14
  v_cndmask_b32 v15, v132, v133, vcc
  v_cndmask_b32 v15, v15, v134, s[42:43]
  v_cndmask_b32 v15, v15, v135, s[44:45]
  v_cndmask_b32 v16, v128, v129, s[46:47]
  v_cndmask_b32 v17, v136, v137, s[46:47]
  v_mov_b32 v18, v15
  s_nop 1
  v_permlane32_swap_b32 v15, v18
  s_nop 1
  v_add_f32 v15, v15, v18
  v_mul_f32 v16, 0x3acccccd, v16
  v_mul_f32 v15, 0x3acccccd, v15
  v_fma_f32 v15, -v16, v16, v15
  v_max_f32 v15, 0, v15
  v_add_f32 v15, 0x3727c5ac, v15
  v_rsq_f32 v15, v15
  s_lshl_b32 s3, s32, 7
  v_lshl_add_u32 v18, v8, 2, s3
  v_mul_f32 v15, s40, v15
  s_lshl_b32 s3, s34, 7
  v_lshl_add_u32 v19, v8, 2, s3
  ds_write_b32 v18, v16
  ds_write_b32 v18, v15 offset:512
  ds_write_b32 v19, v17 offset:1024
  s_waitcnt lgkmcnt(0)
  s_barrier
  s_lshl_b32 s3, s32, 7
  v_lshl_add_u32 v13, v8, 2, s3
  ds_read_b32 v20, v13
  ds_read_b32 v21, v13 offset:512
  s_lshl_b32 s3, s33, 7
  v_lshl_add_u32 v13, v8, 2, s3
  ds_read_b32 v22, v13
  ds_read_b32 v23, v13 offset:512
  s_lshl_b32 s3, s34, 7
  v_lshl_add_u32 v13, v9, 4, s3
  ds_read_b128 v[24:27], v13 offset:1024
  ds_read_b128 v[28:31], v13 offset:1056
  ds_read_b128 v[32:35], v13 offset:1088
  ds_read_b128 v[36:39], v13 offset:1120
  s_lshl_b32 s3, s35, 7
  v_lshl_add_u32 v13, v9, 4, s3
  ds_read_b128 v[40:43], v13 offset:1024
  ds_read_b128 v[44:47], v13 offset:1056
  ds_read_b128 v[48:51], v13 offset:1088
  ds_read_b128 v[52:55], v13 offset:1120
  s_waitcnt lgkmcnt(0)
  v_pk_fma_f32 v[64:65], v[24:25], v[20:21], v[64:65] op_sel:[0,0,0] op_sel_hi:[1,0,1] neg_lo:[0,1,0] neg_hi:[0,1,0]
  v_pk_fma_f32 v[66:67], v[26:27], v[20:21], v[66:67] op_sel:[0,0,0] op_sel_hi:[1,0,1] neg_lo:[0,1,0] neg_hi:[0,1,0]
  v_pk_mul_f32 v[64:65], v[64:65], v[20:21] op_sel:[0,1] op_sel_hi:[1,1]
  v_pk_mul_f32 v[66:67], v[66:67], v[20:21] op_sel:[0,1] op_sel_hi:[1,1]
  v_cvt_pk_bf16_f32 v64, v64, v65
  v_cvt_pk_bf16_f32 v65, v66, v67
  v_pk_fma_f32 v[68:69], v[28:29], v[20:21], v[68:69] op_sel:[0,0,0] op_sel_hi:[1,0,1] neg_lo:[0,1,0] neg_hi:[0,1,0]
  v_pk_fma_f32 v[70:71], v[30:31], v[20:21], v[70:71] op_sel:[0,0,0] op_sel_hi:[1,0,1] neg_lo:[0,1,0] neg_hi:[0,1,0]
  v_pk_mul_f32 v[68:69], v[68:69], v[20:21] op_sel:[0,1] op_sel_hi:[1,1]
  v_pk_mul_f32 v[70:71], v[70:71], v[20:21] op_sel:[0,1] op_sel_hi:[1,1]
  v_cvt_pk_bf16_f32 v66, v68, v69
  v_cvt_pk_bf16_f32 v67, v70, v71
  v_pk_fma_f32 v[96:97], v[24:25], v[22:23], v[96:97] op_sel:[0,0,0] op_sel_hi:[1,0,1] neg_lo:[0,1,0] neg_hi:[0,1,0]
  v_pk_fma_f32 v[98:99], v[26:27], v[22:23], v[98:99] op_sel:[0,0,0] op_sel_hi:[1,0,1] neg_lo:[0,1,0] neg_hi:[0,1,0]
  v_pk_mul_f32 v[96:97], v[96:97], v[22:23] op_sel:[0,1] op_sel_hi:[1,1]
  v_pk_mul_f32 v[98:99], v[98:99], v[22:23] op_sel:[0,1] op_sel_hi:[1,1]
  v_cvt_pk_bf16_f32 v96, v96, v97
  v_cvt_pk_bf16_f32 v97, v98, v99
  v_pk_fma_f32 v[100:101], v[28:29], v[22:23], v[100:101] op_sel:[0,0,0] op_sel_hi:[1,0,1] neg_lo:[0,1,0] neg_hi:[0,1,0]
  v_pk_fma_f32 v[102:103], v[30:31], v[22:23], v[102:103] op_sel:[0,0,0] op_sel_hi:[1,0,1] neg_lo:[0,1,0] neg_hi:[0,1,0]
  v_pk_mul_f32 v[100:101], v[100:101], v[22:23] op_sel:[0,1] op_sel_hi:[1,1]
  v_pk_mul_f32 v[102:103], v[102:103], v[22:23] op_sel:[0,1] op_sel_hi:[1,1]
  v_cvt_pk_bf16_f32 v98, v100, v101
  v_cvt_pk_bf16_f32 v99, v102, v103
  s_mov_b64 exec, s[52:53]
  v_swap_b32 v66, v96
  v_swap_b32 v67, v97
  s_mov_b64 exec, -1
  buffer_store_dwordx4 v[64:67], v214, s[20:23], 0 offen sc0 sc1
  buffer_store_dwordx4 v[96:99], v215, s[20:23], 0 offen sc0 sc1
  v_pk_fma_f32 v[72:73], v[32:33], v[20:21], v[72:73] op_sel:[0,0,0] op_sel_hi:[1,0,1] neg_lo:[0,1,0] neg_hi:[0,1,0]
  v_pk_fma_f32 v[74:75], v[34:35], v[20:21], v[74:75] op_sel:[0,0,0] op_sel_hi:[1,0,1] neg_lo:[0,1,0] neg_hi:[0,1,0]
  v_pk_mul_f32 v[72:73], v[72:73], v[20:21] op_sel:[0,1] op_sel_hi:[1,1]
  v_pk_mul_f32 v[74:75], v[74:75], v[20:21] op_sel:[0,1] op_sel_hi:[1,1]
  v_cvt_pk_bf16_f32 v72, v72, v73
  v_cvt_pk_bf16_f32 v73, v74, v75
  v_pk_fma_f32 v[76:77], v[36:37], v[20:21], v[76:77] op_sel:[0,0,0] op_sel_hi:[1,0,1] neg_lo:[0,1,0] neg_hi:[0,1,0]
  v_pk_fma_f32 v[78:79], v[38:39], v[20:21], v[78:79] op_sel:[0,0,0] op_sel_hi:[1,0,1] neg_lo:[0,1,0] neg_hi:[0,1,0]
  v_pk_mul_f32 v[76:77], v[76:77], v[20:21] op_sel:[0,1] op_sel_hi:[1,1]
  v_pk_mul_f32 v[78:79], v[78:79], v[20:21] op_sel:[0,1] op_sel_hi:[1,1]
  v_cvt_pk_bf16_f32 v74, v76, v77
  v_cvt_pk_bf16_f32 v75, v78, v79
  v_pk_fma_f32 v[104:105], v[32:33], v[22:23], v[104:105] op_sel:[0,0,0] op_sel_hi:[1,0,1] neg_lo:[0,1,0] neg_hi:[0,1,0]
  v_pk_fma_f32 v[106:107], v[34:35], v[22:23], v[106:107] op_sel:[0,0,0] op_sel_hi:[1,0,1] neg_lo:[0,1,0] neg_hi:[0,1,0]
  v_pk_mul_f32 v[104:105], v[104:105], v[22:23] op_sel:[0,1] op_sel_hi:[1,1]
  v_pk_mul_f32 v[106:107], v[106:107], v[22:23] op_sel:[0,1] op_sel_hi:[1,1]
  v_cvt_pk_bf16_f32 v104, v104, v105
  v_cvt_pk_bf16_f32 v105, v106, v107
  v_pk_fma_f32 v[108:109], v[36:37], v[22:23], v[108:109] op_sel:[0,0,0] op_sel_hi:[1,0,1] neg_lo:[0,1,0] neg_hi:[0,1,0]
  v_pk_fma_f32 v[110:111], v[38:39], v[22:23], v[110:111] op_sel:[0,0,0] op_sel_hi:[1,0,1] neg_lo:[0,1,0] neg_hi:[0,1,0]
  v_pk_mul_f32 v[108:109], v[108:109], v[22:23] op_sel:[0,1] op_sel_hi:[1,1]
  v_pk_mul_f32 v[110:111], v[110:111], v[22:23] op_sel:[0,1] op_sel_hi:[1,1]
  v_cvt_pk_bf16_f32 v106, v108, v109
  v_cvt_pk_bf16_f32 v107, v110, v111
  s_mov_b64 exec, s[54:55]
  v_swap_b32 v74, v104
  v_swap_b32 v75, v105
  s_mov_b64 exec, -1
  buffer_store_dwordx4 v[72:75], v216, s[20:23], 0 offen sc0 sc1
  buffer_store_dwordx4 v[104:107], v217, s[20:23], 0 offen sc0 sc1
  v_pk_fma_f32 v[80:81], v[40:41], v[20:21], v[80:81] op_sel:[0,0,0] op_sel_hi:[1,0,1] neg_lo:[0,1,0] neg_hi:[0,1,0]
  v_pk_fma_f32 v[82:83], v[42:43], v[20:21], v[82:83] op_sel:[0,0,0] op_sel_hi:[1,0,1] neg_lo:[0,1,0] neg_hi:[0,1,0]
  v_pk_mul_f32 v[80:81], v[80:81], v[20:21] op_sel:[0,1] op_sel_hi:[1,1]
  v_pk_mul_f32 v[82:83], v[82:83], v[20:21] op_sel:[0,1] op_sel_hi:[1,1]
  v_cvt_pk_bf16_f32 v80, v80, v81
  v_cvt_pk_bf16_f32 v81, v82, v83
  v_pk_fma_f32 v[84:85], v[44:45], v[20:21], v[84:85] op_sel:[0,0,0] op_sel_hi:[1,0,1] neg_lo:[0,1,0] neg_hi:[0,1,0]
  v_pk_fma_f32 v[86:87], v[46:47], v[20:21], v[86:87] op_sel:[0,0,0] op_sel_hi:[1,0,1] neg_lo:[0,1,0] neg_hi:[0,1,0]
  v_pk_mul_f32 v[84:85], v[84:85], v[20:21] op_sel:[0,1] op_sel_hi:[1,1]
  v_pk_mul_f32 v[86:87], v[86:87], v[20:21] op_sel:[0,1] op_sel_hi:[1,1]
  v_cvt_pk_bf16_f32 v82, v84, v85
  v_cvt_pk_bf16_f32 v83, v86, v87
  v_pk_fma_f32 v[112:113], v[40:41], v[22:23], v[112:113] op_sel:[0,0,0] op_sel_hi:[1,0,1] neg_lo:[0,1,0] neg_hi:[0,1,0]
  v_pk_fma_f32 v[114:115], v[42:43], v[22:23], v[114:115] op_sel:[0,0,0] op_sel_hi:[1,0,1] neg_lo:[0,1,0] neg_hi:[0,1,0]
  v_pk_mul_f32 v[112:113], v[112:113], v[22:23] op_sel:[0,1] op_sel_hi:[1,1]
  v_pk_mul_f32 v[114:115], v[114:115], v[22:23] op_sel:[0,1] op_sel_hi:[1,1]
  v_cvt_pk_bf16_f32 v112, v112, v113
  v_cvt_pk_bf16_f32 v113, v114, v115
  v_pk_fma_f32 v[116:117], v[44:45], v[22:23], v[116:117] op_sel:[0,0,0] op_sel_hi:[1,0,1] neg_lo:[0,1,0] neg_hi:[0,1,0]
  v_pk_fma_f32 v[118:119], v[46:47], v[22:23], v[118:119] op_sel:[0,0,0] op_sel_hi:[1,0,1] neg_lo:[0,1,0] neg_hi:[0,1,0]
  v_pk_mul_f32 v[116:117], v[116:117], v[22:23] op_sel:[0,1] op_sel_hi:[1,1]
  v_pk_mul_f32 v[118:119], v[118:119], v[22:23] op_sel:[0,1] op_sel_hi:[1,1]
  v_cvt_pk_bf16_f32 v114, v116, v117
  v_cvt_pk_bf16_f32 v115, v118, v119
  s_mov_b64 exec, s[56:57]
  v_swap_b32 v82, v112
  v_swap_b32 v83, v113
  s_mov_b64 exec, -1
  buffer_store_dwordx4 v[80:83], v218, s[20:23], 0 offen sc0 sc1
  buffer_store_dwordx4 v[112:115], v219, s[20:23], 0 offen sc0 sc1
  v_pk_fma_f32 v[88:89], v[48:49], v[20:21], v[88:89] op_sel:[0,0,0] op_sel_hi:[1,0,1] neg_lo:[0,1,0] neg_hi:[0,1,0]
  v_pk_fma_f32 v[90:91], v[50:51], v[20:21], v[90:91] op_sel:[0,0,0] op_sel_hi:[1,0,1] neg_lo:[0,1,0] neg_hi:[0,1,0]
  v_pk_mul_f32 v[88:89], v[88:89], v[20:21] op_sel:[0,1] op_sel_hi:[1,1]
  v_pk_mul_f32 v[90:91], v[90:91], v[20:21] op_sel:[0,1] op_sel_hi:[1,1]
  v_cvt_pk_bf16_f32 v88, v88, v89
  v_cvt_pk_bf16_f32 v89, v90, v91
  v_pk_fma_f32 v[92:93], v[52:53], v[20:21], v[92:93] op_sel:[0,0,0] op_sel_hi:[1,0,1] neg_lo:[0,1,0] neg_hi:[0,1,0]
  v_pk_fma_f32 v[94:95], v[54:55], v[20:21], v[94:95] op_sel:[0,0,0] op_sel_hi:[1,0,1] neg_lo:[0,1,0] neg_hi:[0,1,0]
  v_pk_mul_f32 v[92:93], v[92:93], v[20:21] op_sel:[0,1] op_sel_hi:[1,1]
  v_pk_mul_f32 v[94:95], v[94:95], v[20:21] op_sel:[0,1] op_sel_hi:[1,1]
  v_cvt_pk_bf16_f32 v90, v92, v93
  v_cvt_pk_bf16_f32 v91, v94, v95
  v_pk_fma_f32 v[120:121], v[48:49], v[22:23], v[120:121] op_sel:[0,0,0] op_sel_hi:[1,0,1] neg_lo:[0,1,0] neg_hi:[0,1,0]
  v_pk_fma_f32 v[122:123], v[50:51], v[22:23], v[122:123] op_sel:[0,0,0] op_sel_hi:[1,0,1] neg_lo:[0,1,0] neg_hi:[0,1,0]
  v_pk_mul_f32 v[120:121], v[120:121], v[22:23] op_sel:[0,1] op_sel_hi:[1,1]
  v_pk_mul_f32 v[122:123], v[122:123], v[22:23] op_sel:[0,1] op_sel_hi:[1,1]
  v_cvt_pk_bf16_f32 v120, v120, v121
  v_cvt_pk_bf16_f32 v121, v122, v123
  v_pk_fma_f32 v[124:125], v[52:53], v[22:23], v[124:125] op_sel:[0,0,0] op_sel_hi:[1,0,1] neg_lo:[0,1,0] neg_hi:[0,1,0]
  v_pk_fma_f32 v[126:127], v[54:55], v[22:23], v[126:127] op_sel:[0,0,0] op_sel_hi:[1,0,1] neg_lo:[0,1,0] neg_hi:[0,1,0]
  v_pk_mul_f32 v[124:125], v[124:125], v[22:23] op_sel:[0,1] op_sel_hi:[1,1]
  v_pk_mul_f32 v[126:127], v[126:127], v[22:23] op_sel:[0,1] op_sel_hi:[1,1]
  v_cvt_pk_bf16_f32 v122, v124, v125
  v_cvt_pk_bf16_f32 v123, v126, v127
  s_mov_b64 exec, s[58:59]
  v_swap_b32 v90, v120
  v_swap_b32 v91, v121
  s_mov_b64 exec, -1
  buffer_store_dwordx4 v[88:91], v220, s[20:23], 0 offen sc0 sc1
  buffer_store_dwordx4 v[120:123], v221, s[20:23], 0 offen sc0 sc1
  s_endpgm
.globl s2_att_kernel
.p2align 8
.type s2_att_kernel,@function
s2_att_kernel:
  s_cmp_ge_u32 s2, 256
  s_cbranch_scc1 s2_att_end_1
  s_load_dwordx2 s[8:9], s[0:1], 72
  s_load_dwordx2 s[4:5], s[0:1], 0
  s_load_dwordx4 s[44:47], s[0:1], 32
  s_load_dwordx2 s[48:49], s[0:1], 48
  v_lshrrev_b32 v1, 6, v0
  v_and_b32 v0, 63, v0
  v_readfirstlane_b32 s26, v1
  s_and_b32 s10, s2, 7
  s_lshr_b32 s11, s2, 3
  s_and_b32 s3, s11, 3
  s_lshl_b32 s24, s10, 2
  s_add_u32 s24, s24, s3
  s_lshr_b32 s25, s11, 2
  s_lshl_b32 s25, s25, 3
  s_add_u32 s25, s25, s26
  v_lshlrev_b32 v2, 4, v0
  v_and_b32 v8, 31, v0
  v_lshrrev_b32 v9, 5, v0
  v_lshlrev_b32 v3, 3, v8
  s_lshr_b32 s3, s24, 1
  s_mul_i32 s3, s3, 5
  s_add_u32 s3, s3, 2
  s_and_b32 s30, s3, 8
  s_lshl_b32 s3, s24, 5
  s_lshr_b32 s27, s25, 1
  s_add_u32 s3, s3, s27
  s_mul_i32 s27, s3, 2560
  s_and_b32 s3, s25, 1
  s_lshl_b32 s34, s3, 3
  s_xor_b32 s34, s34, s30
  s_add_u32 s34, s34, s27
  s_lshl_b32 s3, s3, 10
  s_add_u32 s27, s27, s3
  v_lshlrev_b32 v3, 4, v8
  s_mul_i32 s28, s24, 163840
  s_lshl_b32 s29, s26, 10
  s_add_u32 s28, s28, s29
  s_add_u32 s28, s28, 0x280000
  s_waitcnt lgkmcnt(0)
  s_mov_b32 s12, s8
  s_and_b32 s13, s9, 0xffff
  s_mov_b32 s14, 0x780000
  s_mov_b32 s15, 0x00020000
  s_add_u32 m0, s29, 0
  s_nop 0
  buffer_load_dwordx4 v2, s[12:15], s28 offen lds
  buffer_load_dwordx4 v[16:19], v2, s[12:15], s27 offen
  buffer_load_dwordx2 v[20:21], v3, s[12:15], s34 offen offset:2048
  s_add_u32 m0, s29, 8192
  s_add_u32 s28, s28, 8192
  buffer_load_dwordx4 v2, s[12:15], s28 offen lds
  s_add_u32 m0, s29, 16384
  s_add_u32 s28, s28, 8192
  buffer_load_dwordx4 v2, s[12:15], s28 offen lds
  s_add_u32 m0, s29, 24576
  s_add_u32 s28, s28, 8192
  buffer_load_dwordx4 v2, s[12:15], s28 offen lds
  s_add_u32 m0, s29, 32768
  s_add_u32 s28, s28, 8192
  buffer_load_dwordx4 v2, s[12:15], s28 offen lds
  s_mov_b32 s16, s8
  s_and_b32 s17, s9, 0xffff
  s_mov_b32 s18, 0x1b00000
  s_mov_b32 s19, 0x00020000
  v_mov_b32 v4, 0x3f803f80
  v_cmp_eq_u32 vcc, 20, v8
  v_cmp_gt_u32 s[22:23], 32, v0
  s_mov_b32 s20, 0xfffff
  s_mov_b32 s21, 0xfffff
  v_cndmask_b32 v108, 0, v4, vcc
  v_cndmask_b32 v109, 0, v4, vcc
  v_mov_b64 v[110:111], v[108:109]
  v_mov_b64 v[112:113], v[108:109]
  v_mov_b64 v[114:115], v[108:109]
  v_mov_b64 v[116:117], v[108:109]
  v_mov_b64 v[118:119], v[108:109]
  v_mov_b64 v[120:121], v[108:109]
  v_mov_b64 v[122:123], v[108:109]
  s_mov_b32 s31, 0
  s_lshr_b32 s3, s24, 1
  s_mul_i32 s3, s3, 5
  s_and_b32 s34, s24, 1
  s_lshl_b32 s35, s34, 1
  s_add_u32 s35, s35, s3
  s_add_u32 s3, s3, 4
  v_add_u32 v4, s35, v9
  v_bfe_u32 v5, v0, 4, 1
  s_lshl_b32 s33, s25, 1
  v_add_u32 v5, s33, v5
  v_mul_u32_u24 v5, 20, v5
  v_and_b32 v10, 15, v0
  v_lshrrev_b32 v11, 2, v4
  v_add_u32 v11, v11, v5
  v_and_b32 v4, 3, v4
  v_lshl_add_u32 v4, v4, 4, v10
  v_lshlrev_b32 v4, 4, v4
  v_lshl_add_u32 v161, v11, 10, v4
  s_lshr_b32 s35, s3, 2
  s_and_b32 s3, s3, 3
  s_lshl_b32 s3, s3, 8
  s_lshl_b32 s34, s34, 3
  s_add_u32 s3, s3, s34
  v_add_u32 v5, s35, v5
  v_lshl_add_u32 v10, v10, 4, s3
  v_lshl_add_u32 v162, v5, 10, v10
  s_mov_b32 s33, 0x780000
  s_lshl_b32 s50, s2, 3
  s_add_u32 s50, s50, s26
  v_lshrrev_b32 v10, 4, v0
  v_and_b32 v11, 15, v0
  s_movk_i32 s60, 2428
  s_movk_i32 s96, 147
  s_movk_i32 s97, 273
  s_cmpk_ge_u32 s50, 1620
  s_cselect_b32 s55, 0x40000000, 0x1870000
  s_cmpk_ge_u32 s50, 540
  s_cselect_b64 s[36:37], s[46:47], s[44:45]
  s_cselect_b32 s56, 7, 0
  s_cselect_b32 s3, 540, 0
  s_cmpk_ge_u32 s50, 1080
  s_cselect_b64 s[36:37], s[48:49], s[36:37]
  s_cmovk_i32 s3, 1080
  s_cselect_b32 s55, s55, 0x1410000
  s_cselect_b32 s59, 0x40000000, 0x1ab0000
  s_cselect_b32 s56, 0, s56
  s_cselect_b32 s51, 6554, s60
  s_cselect_b32 s60, 0, s60
  s_cselect_b32 s52, 10, 27
  s_cselect_b32 s54, 43, 64
  s_cselect_b32 s61, 2, 31
  s_cselect_b32 s62, 48, 16
  s_cselect_b32 s63, 7, 5
  s_cselect_b32 s34, 6, 0
  s_cmovk_i32 s96, 205
  s_cmovk_i32 s97, 265
  s_cselect_b32 s98, 5, 14
  s_and_b32 s37, s37, 0xffff
  s_mov_b32 s38, 0x21c000
  s_mov_b32 s39, 0x00020000
  s_sub_u32 s50, s50, s3
  s_mul_i32 s51, s50, s51
  s_lshr_b32 s51, s51, 16
  s_lshl_b32 s53, s52, 7
  s_mul_i32 s52, s51, s52
  s_sub_u32 s52, s50, s52
  s_mul_i32 s3, s51, s54
  s_lshr_b32 s3, s3, 7
  s_lshr_b32 s61, s3, s61
  s_sub_u32 s3, s3, s61
  s_lshl1_add_u32 s3, s51, s3
  s_sub_u32 s54, s51, s62
  s_lshl_b32 s54, s54, 1
  s_mul_i32 s61, s54, 43
  s_lshr_b32 s61, s61, 7
  s_mul_i32 s61, s61, s34
  s_add_u32 s54, s54, 1
  s_mul_i32 s35, s54, s63
  s_add_u32 s35, s35, s61
  s_mul_i32 s54, s54, 43
  s_lshr_b32 s54, s54, 7
  s_mul_i32 s54, s54, s34
  s_sub_u32 s54, s54, s61
  s_add_u32 s54, s54, s63
  s_lshl_b32 s54, s54, 4
  s_sub_u32 s35, s35, 1
  s_cmp_ge_u32 s51, s62
  s_cselect_b32 s3, s35, s3
  s_cselect_b32 s54, s54, 8
  s_cselect_b32 s61, 8, 4
  s_cselect_b32 s62, 4, 16
  s_lshl_b32 s3, s3, 4
  v_and_b32 v13, 1, v10
  v_mul_u32_u24 v12, s54, v9
  v_mul_u32_u24 v13, s61, v13
  v_add3_u32 v12, v12, v13, s3
  v_add_u32 v13, s62, v12
  s_lshl_b32 s3, s52, 2
  v_lshrrev_b32 v14, 2, v11
  v_add_u32 v14, s3, v14
  v_mul_u32_u24 v15, s60, v14
  v_lshrrev_b32 v15, 16, v15
  v_add_u32 v14, v14, v15
  v_mul_u32_u24 v15, s96, v14
  v_lshrrev_b32 v15, 10, v15
  v_mad_u32_u24 v14, v15, s97, v14
  s_mul_i32 s3, s51, s98
  s_add_u32 s3, s3, s56
  v_add_u32 v14, s3, v14
  v_and_b32 v15, 3, v11
  v_lshlrev_b32 v15, 4, v15
  v_lshl_add_u32 v15, v10, 2, v15
  v_lshl_add_u32 v15, v14, 6, v15
  v_add_u32 v4, s59, v15
  v_and_b32 v15, 3, v11
  v_lshlrev_b32 v15, 6, v15
  v_lshl_add_u32 v15, v10, 8, v15
  v_lshl_add_u32 v14, v14, 10, v15
  v_add_u32 v160, s55, v14
  s_lshl_b32 s3, s52, 7
  v_lshl_add_u32 v11, v11, 3, s3
  v_mad_u32_u24 v12, v12, s53, v11
  v_mad_u32_u24 v13, v13, s53, v11
  v_mov_b32 v164, 0x3f803f80
  v_mov_b32 v165, 0x3f803f80
  v_mov_b32 v166, 0x3f803f80
  v_mov_b32 v167, 0x3f803f80
  s_lshl_b32 s3, s11, 3
  s_add_u32 s3, s3, s26
  s_lshl_b32 s58, s3, 13
  v_lshlrev_b32 v163, 7, v0
  s_cmp_ge_u32 s3, 100
  s_cselect_b32 s40, s4, s8
  s_cselect_b32 s41, s5, s9
  s_and_b32 s41, s41, 0xffff
  s_mov_b32 s43, 0x00020000
  s_and_b32 s34, s10, 1
  s_lshl_b32 s34, s34, 2
  s_lshr_b32 s35, s10, 1
  s_add_u32 s34, s34, s35
  s_mul_i32 s34, s34, 327680
  s_add_u32 s35, s34, 327680
  s_sub_u32 s34, s34, 819200
  s_cmp_ge_u32 s3, 100
  s_cselect_b32 s34, s34, 0x1340000
  s_cselect_b32 s42, s35, 0x1408000
  s_add_u32 s58, s58, s34
  v_add_u32 v163, s58, v163
  v_mov_b32 v124, v2
  v_lshlrev_b32 v125, 3, v9
  v_xor_b32 v125, s30, v125
  v_add_u32 v125, v3, v125
  v_lshrrev_b32 v10, 2, v8
  v_lshrrev_b32 v11, 3, v8
  v_xor_b32 v11, v11, v10
  v_xor_b32 v11, v11, v9
  v_and_b32 v11, 1, v11
  v_lshl_add_u32 v10, v10, 1, v11
  v_and_b32 v11, 48, v3
  v_lshl_add_u32 v126, v10, 6, v11
  s_waitcnt vmcnt(2)
  s_barrier
  ds_read_b128 v[96:99], v124
  ds_read_b64 v[104:105], v125 offset:2048
  v_cndmask_b32 v22, v20, 0, s[22:23]
  v_cndmask_b32 v23, v21, 0, s[22:23]
  v_cndmask_b32 v20, 0, v20, s[22:23]
  v_cndmask_b32 v21, 0, v21, s[22:23]
  s_waitcnt lgkmcnt(0)
  v_mfma_f32_32x32x16_bf16 v[56:71], v[96:99], v[16:19], 0
  v_mfma_f32_32x32x8bf16_1k v[56:71], v[104:105], v[20:21], v[56:71]
  ds_read_b128 v[100:103], v124 offset:1024
  ds_read_b64 v[106:107], v125 offset:7168
  ds_read_b128 v[96:99], v124 offset:5120
  s_nop 13
  v_max3_f32 v6, v56, v57, v58
  v_max3_f32 v7, v59, v60, v61
  v_max3_f32 v6, v6, v62, v63
  v_max3_f32 v7, v7, v64, v65
  v_max3_f32 v6, v6, v66, v67
  v_max3_f32 v7, v7, v68, v69
  v_max3_f32 v6, v6, v70, v71
  v_max_f32 v6, v6, v7
  v_mov_b32 v7, v6
  s_mov_b32 s32, 0
  s_nop 0
  v_permlane32_swap_b32 v6, v7
  s_nop 1
  v_max_f32 v6, v6, v7
  v_sub_f32 v24, 0, v6
  v_sub_f32 v25, 0, v6
  v_mov_b64 v[26:27], v[24:25]
  v_mov_b64 v[28:29], v[24:25]
  v_mov_b64 v[30:31], v[24:25]
  v_mov_b64 v[32:33], v[24:25]
  v_mov_b64 v[34:35], v[24:25]
  v_mov_b64 v[36:37], v[24:25]
  v_mov_b64 v[38:39], v[24:25]
  v_pk_add_f32 v[56:57], v[56:57], v[24:25]
  v_pk_add_f32 v[58:59], v[58:59], v[24:25]
  v_pk_add_f32 v[60:61], v[60:61], v[24:25]
  v_pk_add_f32 v[62:63], v[62:63], v[24:25]
  v_pk_add_f32 v[64:65], v[64:65], v[24:25]
  v_pk_add_f32 v[66:67], v[66:67], v[24:25]
  v_pk_add_f32 v[68:69], v[68:69], v[24:25]
  v_pk_add_f32 v[70:71], v[70:71], v[24:25]
  s_waitcnt lgkmcnt(0)
  s_setprio 1
  v_mfma_f32_32x32x16_bf16 v[72:87], v[100:103], v[16:19], v[24:39]
  ds_read_b128 v[100:103], v124 offset:6144
  v_exp_f32 v56, v56
  v_exp_f32 v57, v57
  v_exp_f32 v58, v58
  v_exp_f32 v59, v59
  s_waitcnt lgkmcnt(1)
  s_mov_b64 exec, s[20:21]
  ds_read_b128 v[108:111], v126 offset:2560
  ds_read_b128 v[112:115], v126 offset:3200
  s_mov_b64 exec, -1
  v_exp_f32 v60, v60
  v_exp_f32 v61, v61
  v_exp_f32 v62, v62
  v_exp_f32 v63, v63
  v_mfma_f32_32x32x8bf16_1k v[72:87], v[104:105], v[22:23], v[72:87]
  v_exp_f32 v64, v64
  v_exp_f32 v65, v65
  v_exp_f32 v66, v66
  v_exp_f32 v67, v67
  v_exp_f32 v68, v68
  v_exp_f32 v69, v69
  v_exp_f32 v70, v70
  v_exp_f32 v71, v71
  s_setprio 0
  s_add_u32 m0, s29, 40960
  s_add_u32 s28, s28, 8192
  buffer_load_dwordx4 v2, s[12:15], s28 offen lds
  v_cvt_pk_bf16_f32 v88, v56, v57
  v_cvt_pk_bf16_f32 v89, v58, v59
  v_cvt_pk_bf16_f32 v90, v60, v61
  v_cvt_pk_bf16_f32 v91, v62, v63
  v_cvt_pk_bf16_f32 v92, v64, v65
  v_cvt_pk_bf16_f32 v93, v66, v67
  v_cvt_pk_bf16_f32 v94, v68, v69
  v_cvt_pk_bf16_f32 v95, v70, v71
  s_setprio 1
  v_mfma_f32_32x32x16_bf16 v[56:71], v[96:99], v[16:19], v[24:39]
  ds_read_b128 v[96:99], v124 offset:10240
  ds_read_b64 v[104:105], v125 offset:12288
  v_exp_f32 v72, v72
  v_exp_f32 v73, v73
  v_exp_f32 v74, v74
  v_exp_f32 v75, v75
  s_waitcnt lgkmcnt(2)
  v_mfma_f32_32x32x16_bf16 v[40:55], v[112:115], v[92:95], 0
  s_mov_b64 exec, s[20:21]
  ds_read_b128 v[116:119], v126 offset:3840
  ds_read_b128 v[120:123], v126 offset:4480
  s_mov_b64 exec, -1
  v_exp_f32 v76, v76
  v_exp_f32 v77, v77
  v_exp_f32 v78, v78
  v_exp_f32 v79, v79
  v_mfma_f32_32x32x8bf16_1k v[56:71], v[106:107], v[20:21], v[56:71]
  v_exp_f32 v80, v80
  v_exp_f32 v81, v81
  v_exp_f32 v82, v82
  v_exp_f32 v83, v83
  v_mfma_f32_32x32x16_bf16 v[40:55], v[108:111], v[88:91], v[40:55]
  v_exp_f32 v84, v84
  v_exp_f32 v85, v85
  v_exp_f32 v86, v86
  v_exp_f32 v87, v87
  s_setprio 0
  s_add_u32 m0, s29, 49152
  s_add_u32 s28, s28, 8192
  buffer_load_dwordx4 v2, s[12:15], s28 offen lds
  v_cvt_pk_bf16_f32 v88, v72, v73
  v_cvt_pk_bf16_f32 v89, v74, v75
  v_cvt_pk_bf16_f32 v90, v76, v77
  v_cvt_pk_bf16_f32 v91, v78, v79
  v_cvt_pk_bf16_f32 v92, v80, v81
  v_cvt_pk_bf16_f32 v93, v82, v83
  v_cvt_pk_bf16_f32 v94, v84, v85
  v_cvt_pk_bf16_f32 v95, v86, v87
  s_setprio 1
  v_mfma_f32_32x32x16_bf16 v[72:87], v[100:103], v[16:19], v[24:39]
  ds_read_b128 v[100:103], v124 offset:11264
  v_exp_f32 v56, v56
  v_exp_f32 v57, v57
  v_exp_f32 v58, v58
  v_exp_f32 v59, v59
  s_waitcnt lgkmcnt(1)
  v_mfma_f32_32x32x16_bf16 v[40:55], v[120:123], v[92:95], v[40:55]
  s_mov_b64 exec, s[20:21]
  ds_read_b128 v[108:111], v126 offset:7680
  ds_read_b128 v[112:115], v126 offset:8320
  s_mov_b64 exec, -1
  v_exp_f32 v60, v60
  v_exp_f32 v61, v61
  v_exp_f32 v62, v62
  v_exp_f32 v63, v63
  v_mfma_f32_32x32x8bf16_1k v[72:87], v[106:107], v[22:23], v[72:87]
  v_exp_f32 v64, v64
  v_exp_f32 v65, v65
  v_exp_f32 v66, v66
  v_exp_f32 v67, v67
  v_mfma_f32_32x32x16_bf16 v[40:55], v[116:119], v[88:91], v[40:55]
  v_exp_f32 v68, v68
  v_exp_f32 v69, v69
  v_exp_f32 v70, v70
  v_exp_f32 v71, v71
  s_setprio 0
  s_add_u32 m0, s29, 57344
  s_add_u32 s28, s28, 8192
  buffer_load_dwordx4 v2, s[12:15], s28 offen lds
  v_cvt_pk_bf16_f32 v88, v56, v57
  v_cvt_pk_bf16_f32 v89, v58, v59
  v_cvt_pk_bf16_f32 v90, v60, v61
  v_cvt_pk_bf16_f32 v91, v62, v63
  v_cvt_pk_bf16_f32 v92, v64, v65
  v_cvt_pk_bf16_f32 v93, v66, v67
  v_cvt_pk_bf16_f32 v94, v68, v69
  v_cvt_pk_bf16_f32 v95, v70, v71
  s_setprio 1
  v_mfma_f32_32x32x16_bf16 v[56:71], v[96:99], v[16:19], v[24:39]
  ds_read_b128 v[96:99], v124 offset:15360
  ds_read_b64 v[106:107], v125 offset:17408
  v_exp_f32 v72, v72
  v_exp_f32 v73, v73
  v_exp_f32 v74, v74
  v_exp_f32 v75, v75
  s_waitcnt lgkmcnt(2)
  v_mfma_f32_32x32x16_bf16 v[40:55], v[112:115], v[92:95], v[40:55]
  s_mov_b64 exec, s[20:21]
  ds_read_b128 v[116:119], v126 offset:8960
  ds_read_b128 v[120:123], v126 offset:9600
  s_mov_b64 exec, -1
  v_exp_f32 v76, v76
  v_exp_f32 v77, v77
  v_exp_f32 v78, v78
  v_exp_f32 v79, v79
  v_mfma_f32_32x32x8bf16_1k v[56:71], v[104:105], v[20:21], v[56:71]
  v_exp_f32 v80, v80
  v_exp_f32 v81, v81
  v_exp_f32 v82, v82
  v_exp_f32 v83, v83
  v_mfma_f32_32x32x16_bf16 v[40:55], v[108:111], v[88:91], v[40:55]
  v_exp_f32 v84, v84
  v_exp_f32 v85, v85
  v_exp_f32 v86, v86
  v_exp_f32 v87, v87
  s_setprio 0
  s_add_u32 m0, s29, 65536
  s_add_u32 s28, s28, 8192
  buffer_load_dwordx4 v2, s[12:15], s28 offen lds
  v_cvt_pk_bf16_f32 v88, v72, v73
  v_cvt_pk_bf16_f32 v89, v74, v75
  v_cvt_pk_bf16_f32 v90, v76, v77
  v_cvt_pk_bf16_f32 v91, v78, v79
  v_cvt_pk_bf16_f32 v92, v80, v81
  v_cvt_pk_bf16_f32 v93, v82, v83
  v_cvt_pk_bf16_f32 v94, v84, v85
  v_cvt_pk_bf16_f32 v95, v86, v87
  s_waitcnt vmcnt(4)
  s_barrier
  s_setprio 1
  v_mfma_f32_32x32x16_bf16 v[72:87], v[100:103], v[16:19], v[24:39]
  ds_read_b128 v[100:103], v124 offset:16384
  v_exp_f32 v56, v56
  v_exp_f32 v57, v57
  v_exp_f32 v58, v58
  v_exp_f32 v59, v59
  s_waitcnt lgkmcnt(1)
  v_mfma_f32_32x32x16_bf16 v[40:55], v[120:123], v[92:95], v[40:55]
  s_mov_b64 exec, s[20:21]
  ds_read_b128 v[108:111], v126 offset:12800
  ds_read_b128 v[112:115], v126 offset:13440
  s_mov_b64 exec, -1
  v_exp_f32 v60, v60
  v_exp_f32 v61, v61
  v_exp_f32 v62, v62
  v_exp_f32 v63, v63
  v_mfma_f32_32x32x8bf16_1k v[72:87], v[104:105], v[22:23], v[72:87]
  v_exp_f32 v64, v64
  v_exp_f32 v65, v65
  v_exp_f32 v66, v66
  v_exp_f32 v67, v67
  v_mfma_f32_32x32x16_bf16 v[40:55], v[116:119], v[88:91], v[40:55]
  v_exp_f32 v68, v68
  v_exp_f32 v69, v69
  v_exp_f32 v70, v70
  v_exp_f32 v71, v71
  s_setprio 0
  s_add_u32 m0, s29, 73728
  s_add_u32 s28, s28, 8192
  buffer_load_dwordx4 v2, s[12:15], s28 offen lds
  v_cvt_pk_bf16_f32 v88, v56, v57
  v_cvt_pk_bf16_f32 v89, v58, v59
  v_cvt_pk_bf16_f32 v90, v60, v61
  v_cvt_pk_bf16_f32 v91, v62, v63
  v_cvt_pk_bf16_f32 v92, v64, v65
  v_cvt_pk_bf16_f32 v93, v66, v67
  v_cvt_pk_bf16_f32 v94, v68, v69
  v_cvt_pk_bf16_f32 v95, v70, v71
  s_setprio 1
  v_mfma_f32_32x32x16_bf16 v[56:71], v[96:99], v[16:19], v[24:39]
  ds_read_b128 v[96:99], v124 offset:20480
  ds_read_b64 v[104:105], v125 offset:22528
  v_exp_f32 v72, v72
  v_exp_f32 v73, v73
  v_exp_f32 v74, v74
  v_exp_f32 v75, v75
  s_waitcnt lgkmcnt(2)
  v_mfma_f32_32x32x16_bf16 v[40:55], v[112:115], v[92:95], v[40:55]
  s_mov_b64 exec, s[20:21]
  ds_read_b128 v[116:119], v126 offset:14080
  ds_read_b128 v[120:123], v126 offset:14720
  s_mov_b64 exec, -1
  v_exp_f32 v76, v76
  v_exp_f32 v77, v77
  v_exp_f32 v78, v78
  v_exp_f32 v79, v79
  v_mfma_f32_32x32x8bf16_1k v[56:71], v[106:107], v[20:21], v[56:71]
  v_exp_f32 v80, v80
  v_exp_f32 v81, v81
  v_exp_f32 v82, v82
  v_exp_f32 v83, v83
  v_mfma_f32_32x32x16_bf16 v[40:55], v[108:111], v[88:91], v[40:55]
  v_exp_f32 v84, v84
  v_exp_f32 v85, v85
  v_exp_f32 v86, v86
  v_exp_f32 v87, v87
  s_setprio 0
  s_add_u32 m0, s29, 81920
  s_add_u32 s28, s28, 8192
  buffer_load_dwordx4 v2, s[12:15], s28 offen lds
  v_cvt_pk_bf16_f32 v88, v72, v73
  v_cvt_pk_bf16_f32 v89, v74, v75
  v_cvt_pk_bf16_f32 v90, v76, v77
  v_cvt_pk_bf16_f32 v91, v78, v79
  v_cvt_pk_bf16_f32 v92, v80, v81
  v_cvt_pk_bf16_f32 v93, v82, v83
  v_cvt_pk_bf16_f32 v94, v84, v85
  v_cvt_pk_bf16_f32 v95, v86, v87
  s_setprio 1
  v_mfma_f32_32x32x16_bf16 v[72:87], v[100:103], v[16:19], v[24:39]
  ds_read_b128 v[100:103], v124 offset:21504
  v_exp_f32 v56, v56
  v_exp_f32 v57, v57
  v_exp_f32 v58, v58
  v_exp_f32 v59, v59
  s_waitcnt lgkmcnt(1)
  v_mfma_f32_32x32x16_bf16 v[40:55], v[120:123], v[92:95], v[40:55]
  s_mov_b64 exec, s[20:21]
  ds_read_b128 v[108:111], v126 offset:17920
  ds_read_b128 v[112:115], v126 offset:18560
  s_mov_b64 exec, -1
  v_exp_f32 v60, v60
  v_exp_f32 v61, v61
  v_exp_f32 v62, v62
  v_exp_f32 v63, v63
  v_mfma_f32_32x32x8bf16_1k v[72:87], v[106:107], v[22:23], v[72:87]
  v_exp_f32 v64, v64
  v_exp_f32 v65, v65
  v_exp_f32 v66, v66
  v_exp_f32 v67, v67
  v_mfma_f32_32x32x16_bf16 v[40:55], v[116:119], v[88:91], v[40:55]
  v_exp_f32 v68, v68
  v_exp_f32 v69, v69
  v_exp_f32 v70, v70
  v_exp_f32 v71, v71
  s_setprio 0
  s_add_u32 m0, s29, 90112
  s_add_u32 s28, s28, 8192
  buffer_load_dwordx4 v2, s[12:15], s28 offen lds
  v_cvt_pk_bf16_f32 v88, v56, v57
  v_cvt_pk_bf16_f32 v89, v58, v59
  v_cvt_pk_bf16_f32 v90, v60, v61
  v_cvt_pk_bf16_f32 v91, v62, v63
  v_cvt_pk_bf16_f32 v92, v64, v65
  v_cvt_pk_bf16_f32 v93, v66, v67
  v_cvt_pk_bf16_f32 v94, v68, v69
  v_cvt_pk_bf16_f32 v95, v70, v71
  s_setprio 1
  v_mfma_f32_32x32x16_bf16 v[56:71], v[96:99], v[16:19], v[24:39]
  ds_read_b128 v[96:99], v124 offset:25600
  ds_read_b64 v[106:107], v125 offset:27648
  v_exp_f32 v72, v72
  v_exp_f32 v73, v73
  v_exp_f32 v74, v74
  v_exp_f32 v75, v75
  s_waitcnt lgkmcnt(2)
  v_mfma_f32_32x32x16_bf16 v[40:55], v[112:115], v[92:95], v[40:55]
  s_mov_b64 exec, s[20:21]
  ds_read_b128 v[116:119], v126 offset:19200
  ds_read_b128 v[120:123], v126 offset:19840
  s_mov_b64 exec, -1
  v_exp_f32 v76, v76
  v_exp_f32 v77, v77
  v_exp_f32 v78, v78
  v_exp_f32 v79, v79
  v_mfma_f32_32x32x8bf16_1k v[56:71], v[104:105], v[20:21], v[56:71]
  v_exp_f32 v80, v80
  v_exp_f32 v81, v81
  v_exp_f32 v82, v82
  v_exp_f32 v83, v83
  v_mfma_f32_32x32x16_bf16 v[40:55], v[108:111], v[88:91], v[40:55]
  v_exp_f32 v84, v84
  v_exp_f32 v85, v85
  v_exp_f32 v86, v86
  v_exp_f32 v87, v87
  s_setprio 0
  s_add_u32 m0, s29, 98304
  s_add_u32 s28, s28, 8192
  buffer_load_dwordx4 v2, s[12:15], s28 offen lds
  v_cvt_pk_bf16_f32 v88, v72, v73
  v_cvt_pk_bf16_f32 v89, v74, v75
  v_cvt_pk_bf16_f32 v90, v76, v77
  v_cvt_pk_bf16_f32 v91, v78, v79
  v_cvt_pk_bf16_f32 v92, v80, v81
  v_cvt_pk_bf16_f32 v93, v82, v83
  v_cvt_pk_bf16_f32 v94, v84, v85
  v_cvt_pk_bf16_f32 v95, v86, v87
  s_setprio 1
  v_mfma_f32_32x32x16_bf16 v[72:87], v[100:103], v[16:19], v[24:39]
  ds_read_b128 v[100:103], v124 offset:26624
  v_exp_f32 v56, v56
  v_exp_f32 v57, v57
  v_exp_f32 v58, v58
  v_exp_f32 v59, v59
  s_waitcnt lgkmcnt(1)
  v_mfma_f32_32x32x16_bf16 v[40:55], v[120:123], v[92:95], v[40:55]
  s_mov_b64 exec, s[20:21]
  ds_read_b128 v[108:111], v126 offset:23040
  ds_read_b128 v[112:115], v126 offset:23680
  s_mov_b64 exec, -1
  v_exp_f32 v60, v60
  v_exp_f32 v61, v61
  v_exp_f32 v62, v62
  v_exp_f32 v63, v63
  v_mfma_f32_32x32x8bf16_1k v[72:87], v[104:105], v[22:23], v[72:87]
  v_exp_f32 v64, v64
  v_exp_f32 v65, v65
  v_exp_f32 v66, v66
  v_exp_f32 v67, v67
  v_mfma_f32_32x32x16_bf16 v[40:55], v[116:119], v[88:91], v[40:55]
  v_exp_f32 v68, v68
  v_exp_f32 v69, v69
  v_exp_f32 v70, v70
  v_exp_f32 v71, v71
  s_setprio 0
  s_add_u32 m0, s29, 106496
  s_add_u32 s28, s28, 8192
  buffer_load_dwordx4 v2, s[12:15], s28 offen lds
  v_cvt_pk_bf16_f32 v88, v56, v57
  v_cvt_pk_bf16_f32 v89, v58, v59
  v_cvt_pk_bf16_f32 v90, v60, v61
  v_cvt_pk_bf16_f32 v91, v62, v63
  v_cvt_pk_bf16_f32 v92, v64, v65
  v_cvt_pk_bf16_f32 v93, v66, v67
  v_cvt_pk_bf16_f32 v94, v68, v69
  v_cvt_pk_bf16_f32 v95, v70, v71
  s_setprio 1
  v_mfma_f32_32x32x16_bf16 v[56:71], v[96:99], v[16:19], v[24:39]
  ds_read_b128 v[96:99], v124 offset:30720
  ds_read_b64 v[104:105], v125 offset:32768
  v_exp_f32 v72, v72
  v_exp_f32 v73, v73
  v_exp_f32 v74, v74
  v_exp_f32 v75, v75
  s_waitcnt lgkmcnt(2)
  v_mfma_f32_32x32x16_bf16 v[40:55], v[112:115], v[92:95], v[40:55]
  s_mov_b64 exec, s[20:21]
  ds_read_b128 v[116:119], v126 offset:24320
  ds_read_b128 v[120:123], v126 offset:24960
  s_mov_b64 exec, -1
  v_exp_f32 v76, v76
  v_exp_f32 v77, v77
  v_exp_f32 v78, v78
  v_exp_f32 v79, v79
  v_mfma_f32_32x32x8bf16_1k v[56:71], v[106:107], v[20:21], v[56:71]
  v_exp_f32 v80, v80
  v_exp_f32 v81, v81
  v_exp_f32 v82, v82
  v_exp_f32 v83, v83
  v_mfma_f32_32x32x16_bf16 v[40:55], v[108:111], v[88:91], v[40:55]
  v_exp_f32 v84, v84
  v_exp_f32 v85, v85
  v_exp_f32 v86, v86
  v_exp_f32 v87, v87
  s_setprio 0
  s_add_u32 m0, s29, 114688
  s_add_u32 s28, s28, 8192
  buffer_load_dwordx4 v2, s[12:15], s28 offen lds
  v_cvt_pk_bf16_f32 v88, v72, v73
  v_cvt_pk_bf16_f32 v89, v74, v75
  v_cvt_pk_bf16_f32 v90, v76, v77
  v_cvt_pk_bf16_f32 v91, v78, v79
  v_cvt_pk_bf16_f32 v92, v80, v81
  v_cvt_pk_bf16_f32 v93, v82, v83
  v_cvt_pk_bf16_f32 v94, v84, v85
  v_cvt_pk_bf16_f32 v95, v86, v87
  s_setprio 1
  v_mfma_f32_32x32x16_bf16 v[72:87], v[100:103], v[16:19], v[24:39]
  ds_read_b128 v[100:103], v124 offset:31744
  v_exp_f32 v56, v56
  v_exp_f32 v57, v57
  v_exp_f32 v58, v58
  v_exp_f32 v59, v59
  s_waitcnt lgkmcnt(1)
  v_mfma_f32_32x32x16_bf16 v[40:55], v[120:123], v[92:95], v[40:55]
  s_mov_b64 exec, s[20:21]
  ds_read_b128 v[108:111], v126 offset:28160
  ds_read_b128 v[112:115], v126 offset:28800
  s_mov_b64 exec, -1
  v_exp_f32 v60, v60
  v_exp_f32 v61, v61
  v_exp_f32 v62, v62
  v_exp_f32 v63, v63
  v_mfma_f32_32x32x8bf16_1k v[72:87], v[106:107], v[22:23], v[72:87]
  v_exp_f32 v64, v64
  v_exp_f32 v65, v65
  v_exp_f32 v66, v66
  v_exp_f32 v67, v67
  v_mfma_f32_32x32x16_bf16 v[40:55], v[116:119], v[88:91], v[40:55]
  v_exp_f32 v68, v68
  v_exp_f32 v69, v69
  v_exp_f32 v70, v70
  v_exp_f32 v71, v71
  s_setprio 0
  s_add_u32 m0, s29, 122880
  s_add_u32 s28, s28, 8192
  buffer_load_dwordx4 v2, s[12:15], s28 offen lds
  v_cvt_pk_bf16_f32 v88, v56, v57
  v_cvt_pk_bf16_f32 v89, v58, v59
  v_cvt_pk_bf16_f32 v90, v60, v61
  v_cvt_pk_bf16_f32 v91, v62, v63
  v_cvt_pk_bf16_f32 v92, v64, v65
  v_cvt_pk_bf16_f32 v93, v66, v67
  v_cvt_pk_bf16_f32 v94, v68, v69
  v_cvt_pk_bf16_f32 v95, v70, v71
  s_setprio 1
  v_mfma_f32_32x32x16_bf16 v[56:71], v[96:99], v[16:19], v[24:39]
  ds_read_b128 v[96:99], v124 offset:35840
  ds_read_b64 v[106:107], v125 offset:37888
  v_exp_f32 v72, v72
  v_exp_f32 v73, v73
  v_exp_f32 v74, v74
  v_exp_f32 v75, v75
  s_waitcnt lgkmcnt(2)
  v_mfma_f32_32x32x16_bf16 v[40:55], v[112:115], v[92:95], v[40:55]
  s_mov_b64 exec, s[20:21]
  ds_read_b128 v[116:119], v126 offset:29440
  ds_read_b128 v[120:123], v126 offset:30080
  s_mov_b64 exec, -1
  v_exp_f32 v76, v76
  v_exp_f32 v77, v77
  v_exp_f32 v78, v78
  v_exp_f32 v79, v79
  v_mfma_f32_32x32x8bf16_1k v[56:71], v[104:105], v[20:21], v[56:71]
  v_exp_f32 v80, v80
  v_exp_f32 v81, v81
  v_exp_f32 v82, v82
  v_exp_f32 v83, v83
  v_mfma_f32_32x32x16_bf16 v[40:55], v[108:111], v[88:91], v[40:55]
  v_exp_f32 v84, v84
  v_exp_f32 v85, v85
  v_exp_f32 v86, v86
  v_exp_f32 v87, v87
  s_setprio 0
  s_add_u32 m0, s29, 131072
  s_add_u32 s28, s28, 8192
  buffer_load_dwordx4 v2, s[12:15], s28 offen lds
  v_cvt_pk_bf16_f32 v88, v72, v73
  v_cvt_pk_bf16_f32 v89, v74, v75
  v_cvt_pk_bf16_f32 v90, v76, v77
  v_cvt_pk_bf16_f32 v91, v78, v79
  v_cvt_pk_bf16_f32 v92, v80, v81
  v_cvt_pk_bf16_f32 v93, v82, v83
  v_cvt_pk_bf16_f32 v94, v84, v85
  v_cvt_pk_bf16_f32 v95, v86, v87
  s_waitcnt vmcnt(7)
  s_barrier
  s_setprio 1
  v_mfma_f32_32x32x16_bf16 v[72:87], v[100:103], v[16:19], v[24:39]
  ds_read_b128 v[100:103], v124 offset:36864
  v_exp_f32 v56, v56
  v_exp_f32 v57, v57
  v_exp_f32 v58, v58
  v_exp_f32 v59, v59
  s_waitcnt lgkmcnt(1)
  v_mfma_f32_32x32x16_bf16 v[40:55], v[120:123], v[92:95], v[40:55]
  s_mov_b64 exec, s[20:21]
  ds_read_b128 v[108:111], v126 offset:33280
  ds_read_b128 v[112:115], v126 offset:33920
  s_mov_b64 exec, -1
  v_exp_f32 v60, v60
  v_exp_f32 v61, v61
  v_exp_f32 v62, v62
  v_exp_f32 v63, v63
  v_mfma_f32_32x32x8bf16_1k v[72:87], v[104:105], v[22:23], v[72:87]
  v_exp_f32 v64, v64
  v_exp_f32 v65, v65
  v_exp_f32 v66, v66
  v_exp_f32 v67, v67
  v_mfma_f32_32x32x16_bf16 v[40:55], v[116:119], v[88:91], v[40:55]
  v_exp_f32 v68, v68
  v_exp_f32 v69, v69
  v_exp_f32 v70, v70
  v_exp_f32 v71, v71
  s_setprio 0
  s_add_u32 m0, s29, 139264
  s_add_u32 s28, s28, 8192
  buffer_load_dwordx4 v2, s[12:15], s28 offen lds
  v_cvt_pk_bf16_f32 v88, v56, v57
  v_cvt_pk_bf16_f32 v89, v58, v59
  v_cvt_pk_bf16_f32 v90, v60, v61
  v_cvt_pk_bf16_f32 v91, v62, v63
  v_cvt_pk_bf16_f32 v92, v64, v65
  v_cvt_pk_bf16_f32 v93, v66, v67
  v_cvt_pk_bf16_f32 v94, v68, v69
  v_cvt_pk_bf16_f32 v95, v70, v71
  s_setprio 1
  v_mfma_f32_32x32x16_bf16 v[56:71], v[96:99], v[16:19], v[24:39]
  ds_read_b128 v[96:99], v124 offset:40960
  ds_read_b64 v[104:105], v125 offset:43008
  v_exp_f32 v72, v72
  v_exp_f32 v73, v73
  v_exp_f32 v74, v74
  v_exp_f32 v75, v75
  s_waitcnt lgkmcnt(2)
  v_mfma_f32_32x32x16_bf16 v[40:55], v[112:115], v[92:95], v[40:55]
  s_mov_b64 exec, s[20:21]
  ds_read_b128 v[116:119], v126 offset:34560
  ds_read_b128 v[120:123], v126 offset:35200
  s_mov_b64 exec, -1
  v_exp_f32 v76, v76
  v_exp_f32 v77, v77
  v_exp_f32 v78, v78
  v_exp_f32 v79, v79
  v_mfma_f32_32x32x8bf16_1k v[56:71], v[106:107], v[20:21], v[56:71]
  v_exp_f32 v80, v80
  v_exp_f32 v81, v81
  v_exp_f32 v82, v82
  v_exp_f32 v83, v83
  v_mfma_f32_32x32x16_bf16 v[40:55], v[108:111], v[88:91], v[40:55]
  v_exp_f32 v84, v84
  v_exp_f32 v85, v85
  v_exp_f32 v86, v86
  v_exp_f32 v87, v87
  s_setprio 0
  s_add_u32 m0, s29, 147456
  s_add_u32 s28, s28, 8192
  buffer_load_dwordx4 v2, s[12:15], s28 offen lds
  v_cvt_pk_bf16_f32 v88, v72, v73
  v_cvt_pk_bf16_f32 v89, v74, v75
  v_cvt_pk_bf16_f32 v90, v76, v77
  v_cvt_pk_bf16_f32 v91, v78, v79
  v_cvt_pk_bf16_f32 v92, v80, v81
  v_cvt_pk_bf16_f32 v93, v82, v83
  v_cvt_pk_bf16_f32 v94, v84, v85
  v_cvt_pk_bf16_f32 v95, v86, v87
  s_setprio 1
  v_mfma_f32_32x32x16_bf16 v[72:87], v[100:103], v[16:19], v[24:39]
  ds_read_b128 v[100:103], v124 offset:41984
  v_exp_f32 v56, v56
  v_exp_f32 v57, v57
  v_exp_f32 v58, v58
  v_exp_f32 v59, v59
  s_waitcnt lgkmcnt(1)
  v_mfma_f32_32x32x16_bf16 v[40:55], v[120:123], v[92:95], v[40:55]
  s_mov_b64 exec, s[20:21]
  ds_read_b128 v[108:111], v126 offset:38400
  ds_read_b128 v[112:115], v126 offset:39040
  s_mov_b64 exec, -1
  v_exp_f32 v60, v60
  v_exp_f32 v61, v61
  v_exp_f32 v62, v62
  v_exp_f32 v63, v63
  v_mfma_f32_32x32x8bf16_1k v[72:87], v[106:107], v[22:23], v[72:87]
  v_exp_f32 v64, v64
  v_exp_f32 v65, v65
  v_exp_f32 v66, v66
  v_exp_f32 v67, v67
  v_mfma_f32_32x32x16_bf16 v[40:55], v[116:119], v[88:91], v[40:55]
  v_exp_f32 v68, v68
  v_exp_f32 v69, v69
  v_exp_f32 v70, v70
  v_exp_f32 v71, v71
  s_setprio 0
  s_add_u32 m0, s29, 155648
  s_add_u32 s28, s28, 8192
  buffer_load_dwordx4 v2, s[12:15], s28 offen lds
  v_cvt_pk_bf16_f32 v88, v56, v57
  v_cvt_pk_bf16_f32 v89, v58, v59
  v_cvt_pk_bf16_f32 v90, v60, v61
  v_cvt_pk_bf16_f32 v91, v62, v63
  v_cvt_pk_bf16_f32 v92, v64, v65
  v_cvt_pk_bf16_f32 v93, v66, v67
  v_cvt_pk_bf16_f32 v94, v68, v69
  v_cvt_pk_bf16_f32 v95, v70, v71
  s_setprio 1
  v_mfma_f32_32x32x16_bf16 v[56:71], v[96:99], v[16:19], v[24:39]
  ds_read_b128 v[96:99], v124 offset:46080
  ds_read_b64 v[106:107], v125 offset:48128
  v_exp_f32 v72, v72
  v_exp_f32 v73, v73
  v_exp_f32 v74, v74
  v_exp_f32 v75, v75
  s_waitcnt lgkmcnt(2)
  v_mfma_f32_32x32x16_bf16 v[40:55], v[112:115], v[92:95], v[40:55]
  s_mov_b64 exec, s[20:21]
  ds_read_b128 v[116:119], v126 offset:39680
  ds_read_b128 v[120:123], v126 offset:40320
  s_mov_b64 exec, -1
  v_exp_f32 v76, v76
  v_exp_f32 v77, v77
  v_exp_f32 v78, v78
  v_exp_f32 v79, v79
  v_mfma_f32_32x32x8bf16_1k v[56:71], v[104:105], v[20:21], v[56:71]
  v_exp_f32 v80, v80
  v_exp_f32 v81, v81
  v_exp_f32 v82, v82
  v_exp_f32 v83, v83
  v_mfma_f32_32x32x16_bf16 v[40:55], v[108:111], v[88:91], v[40:55]
  v_exp_f32 v84, v84
  v_exp_f32 v85, v85
  v_exp_f32 v86, v86
  v_exp_f32 v87, v87
  s_setprio 0
  v_add_u32 v124, 40960, v124
  v_add_u32 v125, 40960, v125
  v_add_u32 v126, 40960, v126
  v_cvt_pk_bf16_f32 v88, v72, v73
  v_cvt_pk_bf16_f32 v89, v74, v75
  v_cvt_pk_bf16_f32 v90, v76, v77
  v_cvt_pk_bf16_f32 v91, v78, v79
  v_cvt_pk_bf16_f32 v92, v80, v81
  v_cvt_pk_bf16_f32 v93, v82, v83
  v_cvt_pk_bf16_f32 v94, v84, v85
  v_cvt_pk_bf16_f32 v95, v86, v87
  s_setprio 1
  v_mfma_f32_32x32x16_bf16 v[72:87], v[100:103], v[16:19], v[24:39]
  ds_read_b128 v[100:103], v124 offset:6144
  v_exp_f32 v56, v56
  v_exp_f32 v57, v57
  v_exp_f32 v58, v58
  v_exp_f32 v59, v59
  s_waitcnt lgkmcnt(1)
  v_mfma_f32_32x32x16_bf16 v[40:55], v[120:123], v[92:95], v[40:55]
  s_mov_b64 exec, s[20:21]
  ds_read_b128 v[108:111], v126 offset:2560
  ds_read_b128 v[112:115], v126 offset:3200
  s_mov_b64 exec, -1
  v_exp_f32 v60, v60
  v_exp_f32 v61, v61
  v_exp_f32 v62, v62
  v_exp_f32 v63, v63
  v_mfma_f32_32x32x8bf16_1k v[72:87], v[104:105], v[22:23], v[72:87]
  v_exp_f32 v64, v64
  v_exp_f32 v65, v65
  v_exp_f32 v66, v66
  v_exp_f32 v67, v67
  v_mfma_f32_32x32x16_bf16 v[40:55], v[116:119], v[88:91], v[40:55]
  v_exp_f32 v68, v68
  v_exp_f32 v69, v69
  v_exp_f32 v70, v70
  v_exp_f32 v71, v71
  s_setprio 0
  s_mov_b32 s57, 0
  buffer_load_dwordx2 v[128:129], v12, s[36:39], s57 offen
  v_cvt_pk_bf16_f32 v88, v56, v57
  v_cvt_pk_bf16_f32 v89, v58, v59
  v_cvt_pk_bf16_f32 v90, v60, v61
  v_cvt_pk_bf16_f32 v91, v62, v63
  v_cvt_pk_bf16_f32 v92, v64, v65
  v_cvt_pk_bf16_f32 v93, v66, v67
  v_cvt_pk_bf16_f32 v94, v68, v69
  v_cvt_pk_bf16_f32 v95, v70, v71
  s_setprio 1
  v_mfma_f32_32x32x16_bf16 v[56:71], v[96:99], v[16:19], v[24:39]
  ds_read_b128 v[96:99], v124 offset:10240
  ds_read_b64 v[104:105], v125 offset:12288
  v_exp_f32 v72, v72
  v_exp_f32 v73, v73
  v_exp_f32 v74, v74
  v_exp_f32 v75, v75
  s_waitcnt lgkmcnt(2)
  v_mfma_f32_32x32x16_bf16 v[40:55], v[112:115], v[92:95], v[40:55]
  s_mov_b64 exec, s[20:21]
  ds_read_b128 v[116:119], v126 offset:3840
  ds_read_b128 v[120:123], v126 offset:4480
  s_mov_b64 exec, -1
  v_exp_f32 v76, v76
  v_exp_f32 v77, v77
  v_exp_f32 v78, v78
  v_exp_f32 v79, v79
  v_mfma_f32_32x32x8bf16_1k v[56:71], v[106:107], v[20:21], v[56:71]
  v_exp_f32 v80, v80
  v_exp_f32 v81, v81
  v_exp_f32 v82, v82
  v_exp_f32 v83, v83
  v_mfma_f32_32x32x16_bf16 v[40:55], v[108:111], v[88:91], v[40:55]
  v_exp_f32 v84, v84
  v_exp_f32 v85, v85
  v_exp_f32 v86, v86
  v_exp_f32 v87, v87
  s_setprio 0
  v_cvt_pk_bf16_f32 v88, v72, v73
  v_cvt_pk_bf16_f32 v89, v74, v75
  v_cvt_pk_bf16_f32 v90, v76, v77
  v_cvt_pk_bf16_f32 v91, v78, v79
  v_cvt_pk_bf16_f32 v92, v80, v81
  v_cvt_pk_bf16_f32 v93, v82, v83
  v_cvt_pk_bf16_f32 v94, v84, v85
  v_cvt_pk_bf16_f32 v95, v86, v87
  s_setprio 1
  v_mfma_f32_32x32x16_bf16 v[72:87], v[100:103], v[16:19], v[24:39]
  ds_read_b128 v[100:103], v124 offset:11264
  v_exp_f32 v56, v56
  v_exp_f32 v57, v57
  v_exp_f32 v58, v58
  v_exp_f32 v59, v59
  s_waitcnt lgkmcnt(1)
  v_mfma_f32_32x32x16_bf16 v[40:55], v[120:123], v[92:95], v[40:55]
  s_mov_b64 exec, s[20:21]
  ds_read_b128 v[108:111], v126 offset:7680
  ds_read_b128 v[112:115], v126 offset:8320
  s_mov_b64 exec, -1
  v_exp_f32 v60, v60
  v_exp_f32 v61, v61
  v_exp_f32 v62, v62
  v_exp_f32 v63, v63
  v_mfma_f32_32x32x8bf16_1k v[72:87], v[106:107], v[22:23], v[72:87]
  v_exp_f32 v64, v64
  v_exp_f32 v65, v65
  v_exp_f32 v66, v66
  v_exp_f32 v67, v67
  v_mfma_f32_32x32x16_bf16 v[40:55], v[116:119], v[88:91], v[40:55]
  v_exp_f32 v68, v68
  v_exp_f32 v69, v69
  v_exp_f32 v70, v70
  v_exp_f32 v71, v71
  s_setprio 0
  buffer_load_dwordx2 v[136:137], v13, s[36:39], s57 offen
  v_cvt_pk_bf16_f32 v88, v56, v57
  v_cvt_pk_bf16_f32 v89, v58, v59
  v_cvt_pk_bf16_f32 v90, v60, v61
  v_cvt_pk_bf16_f32 v91, v62, v63
  v_cvt_pk_bf16_f32 v92, v64, v65
  v_cvt_pk_bf16_f32 v93, v66, v67
  v_cvt_pk_bf16_f32 v94, v68, v69
  v_cvt_pk_bf16_f32 v95, v70, v71
  s_setprio 1
  v_mfma_f32_32x32x16_bf16 v[56:71], v[96:99], v[16:19], v[24:39]
  ds_read_b128 v[96:99], v124 offset:15360
  ds_read_b64 v[106:107], v125 offset:17408
  v_exp_f32 v72, v72
  v_exp_f32 v73, v73
  v_exp_f32 v74, v74
  v_exp_f32 v75, v75
  s_waitcnt lgkmcnt(2)
  v_mfma_f32_32x32x16_bf16 v[40:55], v[112:115], v[92:95], v[40:55]
  s_mov_b64 exec, s[20:21]
  ds_read_b128 v[116:119], v126 offset:8960
  ds_read_b128 v[120:123], v126 offset:9600
  s_mov_b64 exec, -1
  v_exp_f32 v76, v76
  v_exp_f32 v77, v77
  v_exp_f32 v78, v78
  v_exp_f32 v79, v79
  v_mfma_f32_32x32x8bf16_1k v[56:71], v[104:105], v[20:21], v[56:71]
  v_exp_f32 v80, v80
  v_exp_f32 v81, v81
  v_exp_f32 v82, v82
  v_exp_f32 v83, v83
  v_mfma_f32_32x32x16_bf16 v[40:55], v[108:111], v[88:91], v[40:55]
  v_exp_f32 v84, v84
  v_exp_f32 v85, v85
  v_exp_f32 v86, v86
  v_exp_f32 v87, v87
  s_setprio 0
  v_cvt_pk_bf16_f32 v88, v72, v73
  v_cvt_pk_bf16_f32 v89, v74, v75
  v_cvt_pk_bf16_f32 v90, v76, v77
  v_cvt_pk_bf16_f32 v91, v78, v79
  v_cvt_pk_bf16_f32 v92, v80, v81
  v_cvt_pk_bf16_f32 v93, v82, v83
  v_cvt_pk_bf16_f32 v94, v84, v85
  v_cvt_pk_bf16_f32 v95, v86, v87
  s_setprio 1
  v_mfma_f32_32x32x16_bf16 v[72:87], v[100:103], v[16:19], v[24:39]
  ds_read_b128 v[100:103], v124 offset:16384
  v_exp_f32 v56, v56
  v_exp_f32 v57, v57
  v_exp_f32 v58, v58
  v_exp_f32 v59, v59
  s_waitcnt lgkmcnt(1)
  v_mfma_f32_32x32x16_bf16 v[40:55], v[120:123], v[92:95], v[40:55]
  s_mov_b64 exec, s[20:21]
  ds_read_b128 v[108:111], v126 offset:12800
  ds_read_b128 v[112:115], v126 offset:13440
  s_mov_b64 exec, -1
  v_exp_f32 v60, v60
  v_exp_f32 v61, v61
  v_exp_f32 v62, v62
  v_exp_f32 v63, v63
  v_mfma_f32_32x32x8bf16_1k v[72:87], v[104:105], v[22:23], v[72:87]
  v_exp_f32 v64, v64
  v_exp_f32 v65, v65
  v_exp_f32 v66, v66
  v_exp_f32 v67, v67
  v_mfma_f32_32x32x16_bf16 v[40:55], v[116:119], v[88:91], v[40:55]
  v_exp_f32 v68, v68
  v_exp_f32 v69, v69
  v_exp_f32 v70, v70
  v_exp_f32 v71, v71
  s_setprio 0
  s_add_u32 s57, s57, s53
  buffer_load_dwordx2 v[130:131], v12, s[36:39], s57 offen
  v_cvt_pk_bf16_f32 v88, v56, v57
  v_cvt_pk_bf16_f32 v89, v58, v59
  v_cvt_pk_bf16_f32 v90, v60, v61
  v_cvt_pk_bf16_f32 v91, v62, v63
  v_cvt_pk_bf16_f32 v92, v64, v65
  v_cvt_pk_bf16_f32 v93, v66, v67
  v_cvt_pk_bf16_f32 v94, v68, v69
  v_cvt_pk_bf16_f32 v95, v70, v71
  s_setprio 1
  v_mfma_f32_32x32x16_bf16 v[56:71], v[96:99], v[16:19], v[24:39]
  ds_read_b128 v[96:99], v124 offset:20480
  ds_read_b64 v[104:105], v125 offset:22528
  v_exp_f32 v72, v72
  v_exp_f32 v73, v73
  v_exp_f32 v74, v74
  v_exp_f32 v75, v75
  s_waitcnt lgkmcnt(2)
  v_mfma_f32_32x32x16_bf16 v[40:55], v[112:115], v[92:95], v[40:55]
  s_mov_b64 exec, s[20:21]
  ds_read_b128 v[116:119], v126 offset:14080
  ds_read_b128 v[120:123], v126 offset:14720
  s_mov_b64 exec, -1
  v_exp_f32 v76, v76
  v_exp_f32 v77, v77
  v_exp_f32 v78, v78
  v_exp_f32 v79, v79
  v_mfma_f32_32x32x8bf16_1k v[56:71], v[106:107], v[20:21], v[56:71]
  v_exp_f32 v80, v80
  v_exp_f32 v81, v81
  v_exp_f32 v82, v82
  v_exp_f32 v83, v83
  v_mfma_f32_32x32x16_bf16 v[40:55], v[108:111], v[88:91], v[40:55]
  v_exp_f32 v84, v84
  v_exp_f32 v85, v85
  v_exp_f32 v86, v86
  v_exp_f32 v87, v87
  s_setprio 0
  v_cvt_pk_bf16_f32 v88, v72, v73
  v_cvt_pk_bf16_f32 v89, v74, v75
  v_cvt_pk_bf16_f32 v90, v76, v77
  v_cvt_pk_bf16_f32 v91, v78, v79
  v_cvt_pk_bf16_f32 v92, v80, v81
  v_cvt_pk_bf16_f32 v93, v82, v83
  v_cvt_pk_bf16_f32 v94, v84, v85
  v_cvt_pk_bf16_f32 v95, v86, v87
  s_setprio 1
  v_mfma_f32_32x32x16_bf16 v[72:87], v[100:103], v[16:19], v[24:39]
  ds_read_b128 v[100:103], v124 offset:21504
  v_exp_f32 v56, v56
  v_exp_f32 v57, v57
  v_exp_f32 v58, v58
  v_exp_f32 v59, v59
  s_waitcnt lgkmcnt(1)
  v_mfma_f32_32x32x16_bf16 v[40:55], v[120:123], v[92:95], v[40:55]
  s_mov_b64 exec, s[20:21]
  ds_read_b128 v[108:111], v126 offset:17920
  ds_read_b128 v[112:115], v126 offset:18560
  s_mov_b64 exec, -1
  v_exp_f32 v60, v60
  v_exp_f32 v61, v61
  v_exp_f32 v62, v62
  v_exp_f32 v63, v63
  v_mfma_f32_32x32x8bf16_1k v[72:87], v[106:107], v[22:23], v[72:87]
  v_exp_f32 v64, v64
  v_exp_f32 v65, v65
  v_exp_f32 v66, v66
  v_exp_f32 v67, v67
  v_mfma_f32_32x32x16_bf16 v[40:55], v[116:119], v[88:91], v[40:55]
  v_exp_f32 v68, v68
  v_exp_f32 v69, v69
  v_exp_f32 v70, v70
  v_exp_f32 v71, v71
  s_setprio 0
  buffer_load_dwordx2 v[138:139], v13, s[36:39], s57 offen
  v_cvt_pk_bf16_f32 v88, v56, v57
  v_cvt_pk_bf16_f32 v89, v58, v59
  v_cvt_pk_bf16_f32 v90, v60, v61
  v_cvt_pk_bf16_f32 v91, v62, v63
  v_cvt_pk_bf16_f32 v92, v64, v65
  v_cvt_pk_bf16_f32 v93, v66, v67
  v_cvt_pk_bf16_f32 v94, v68, v69
  v_cvt_pk_bf16_f32 v95, v70, v71
  s_setprio 1
  v_mfma_f32_32x32x16_bf16 v[56:71], v[96:99], v[16:19], v[24:39]
  ds_read_b128 v[96:99], v124 offset:25600
  ds_read_b64 v[106:107], v125 offset:27648
  v_exp_f32 v72, v72
  v_exp_f32 v73, v73
  v_exp_f32 v74, v74
  v_exp_f32 v75, v75
  s_waitcnt lgkmcnt(2)
  v_mfma_f32_32x32x16_bf16 v[40:55], v[112:115], v[92:95], v[40:55]
  s_mov_b64 exec, s[20:21]
  ds_read_b128 v[116:119], v126 offset:19200
  ds_read_b128 v[120:123], v126 offset:19840
  s_mov_b64 exec, -1
  v_exp_f32 v76, v76
  v_exp_f32 v77, v77
  v_exp_f32 v78, v78
  v_exp_f32 v79, v79
  v_mfma_f32_32x32x8bf16_1k v[56:71], v[104:105], v[20:21], v[56:71]
  v_exp_f32 v80, v80
  v_exp_f32 v81, v81
  v_exp_f32 v82, v82
  v_exp_f32 v83, v83
  v_mfma_f32_32x32x16_bf16 v[40:55], v[108:111], v[88:91], v[40:55]
  v_exp_f32 v84, v84
  v_exp_f32 v85, v85
  v_exp_f32 v86, v86
  v_exp_f32 v87, v87
  s_setprio 0
  v_cvt_pk_bf16_f32 v88, v72, v73
  v_cvt_pk_bf16_f32 v89, v74, v75
  v_cvt_pk_bf16_f32 v90, v76, v77
  v_cvt_pk_bf16_f32 v91, v78, v79
  v_cvt_pk_bf16_f32 v92, v80, v81
  v_cvt_pk_bf16_f32 v93, v82, v83
  v_cvt_pk_bf16_f32 v94, v84, v85
  v_cvt_pk_bf16_f32 v95, v86, v87
  s_setprio 1
  v_mfma_f32_32x32x16_bf16 v[72:87], v[100:103], v[16:19], v[24:39]
  ds_read_b128 v[100:103], v124 offset:26624
  v_exp_f32 v56, v56
  v_exp_f32 v57, v57
  v_exp_f32 v58, v58
  v_exp_f32 v59, v59
  s_waitcnt lgkmcnt(1)
  v_mfma_f32_32x32x16_bf16 v[40:55], v[120:123], v[92:95], v[40:55]
  s_mov_b64 exec, s[20:21]
  ds_read_b128 v[108:111], v126 offset:23040
  ds_read_b128 v[112:115], v126 offset:23680
  s_mov_b64 exec, -1
  v_exp_f32 v60, v60
  v_exp_f32 v61, v61
  v_exp_f32 v62, v62
  v_exp_f32 v63, v63
  v_mfma_f32_32x32x8bf16_1k v[72:87], v[104:105], v[22:23], v[72:87]
  v_exp_f32 v64, v64
  v_exp_f32 v65, v65
  v_exp_f32 v66, v66
  v_exp_f32 v67, v67
  v_mfma_f32_32x32x16_bf16 v[40:55], v[116:119], v[88:91], v[40:55]
  v_exp_f32 v68, v68
  v_exp_f32 v69, v69
  v_exp_f32 v70, v70
  v_exp_f32 v71, v71
  s_setprio 0
  s_add_u32 s57, s57, s53
  buffer_load_dwordx2 v[132:133], v12, s[36:39], s57 offen
  v_cvt_pk_bf16_f32 v88, v56, v57
  v_cvt_pk_bf16_f32 v89, v58, v59
  v_cvt_pk_bf16_f32 v90, v60, v61
  v_cvt_pk_bf16_f32 v91, v62, v63
  v_cvt_pk_bf16_f32 v92, v64, v65
  v_cvt_pk_bf16_f32 v93, v66, v67
  v_cvt_pk_bf16_f32 v94, v68, v69
  v_cvt_pk_bf16_f32 v95, v70, v71
  s_setprio 1
  v_mfma_f32_32x32x16_bf16 v[56:71], v[96:99], v[16:19], v[24:39]
  ds_read_b128 v[96:99], v124 offset:30720
  ds_read_b64 v[104:105], v125 offset:32768
  v_exp_f32 v72, v72
  v_exp_f32 v73, v73
  v_exp_f32 v74, v74
  v_exp_f32 v75, v75
  s_waitcnt lgkmcnt(2)
  v_mfma_f32_32x32x16_bf16 v[40:55], v[112:115], v[92:95], v[40:55]
  s_mov_b64 exec, s[20:21]
  ds_read_b128 v[116:119], v126 offset:24320
  ds_read_b128 v[120:123], v126 offset:24960
  s_mov_b64 exec, -1
  v_exp_f32 v76, v76
  v_exp_f32 v77, v77
  v_exp_f32 v78, v78
  v_exp_f32 v79, v79
  v_mfma_f32_32x32x8bf16_1k v[56:71], v[106:107], v[20:21], v[56:71]
  v_exp_f32 v80, v80
  v_exp_f32 v81, v81
  v_exp_f32 v82, v82
  v_exp_f32 v83, v83
  v_mfma_f32_32x32x16_bf16 v[40:55], v[108:111], v[88:91], v[40:55]
  v_exp_f32 v84, v84
  v_exp_f32 v85, v85
  v_exp_f32 v86, v86
  v_exp_f32 v87, v87
  s_setprio 0
  v_cvt_pk_bf16_f32 v88, v72, v73
  v_cvt_pk_bf16_f32 v89, v74, v75
  v_cvt_pk_bf16_f32 v90, v76, v77
  v_cvt_pk_bf16_f32 v91, v78, v79
  v_cvt_pk_bf16_f32 v92, v80, v81
  v_cvt_pk_bf16_f32 v93, v82, v83
  v_cvt_pk_bf16_f32 v94, v84, v85
  v_cvt_pk_bf16_f32 v95, v86, v87
  s_setprio 1
  v_mfma_f32_32x32x16_bf16 v[72:87], v[100:103], v[16:19], v[24:39]
  ds_read_b128 v[100:103], v124 offset:31744
  v_exp_f32 v56, v56
  v_exp_f32 v57, v57
  v_exp_f32 v58, v58
  v_exp_f32 v59, v59
  s_waitcnt lgkmcnt(1)
  v_mfma_f32_32x32x16_bf16 v[40:55], v[120:123], v[92:95], v[40:55]
  s_mov_b64 exec, s[20:21]
  ds_read_b128 v[108:111], v126 offset:28160
  ds_read_b128 v[112:115], v126 offset:28800
  s_mov_b64 exec, -1
  v_exp_f32 v60, v60
  v_exp_f32 v61, v61
  v_exp_f32 v62, v62
  v_exp_f32 v63, v63
  v_mfma_f32_32x32x8bf16_1k v[72:87], v[106:107], v[22:23], v[72:87]
  v_exp_f32 v64, v64
  v_exp_f32 v65, v65
  v_exp_f32 v66, v66
  v_exp_f32 v67, v67
  v_mfma_f32_32x32x16_bf16 v[40:55], v[116:119], v[88:91], v[40:55]
  v_exp_f32 v68, v68
  v_exp_f32 v69, v69
  v_exp_f32 v70, v70
  v_exp_f32 v71, v71
  s_setprio 0
  buffer_load_dwordx2 v[140:141], v13, s[36:39], s57 offen
  v_cvt_pk_bf16_f32 v88, v56, v57
  v_cvt_pk_bf16_f32 v89, v58, v59
  v_cvt_pk_bf16_f32 v90, v60, v61
  v_cvt_pk_bf16_f32 v91, v62, v63
  v_cvt_pk_bf16_f32 v92, v64, v65
  v_cvt_pk_bf16_f32 v93, v66, v67
  v_cvt_pk_bf16_f32 v94, v68, v69
  v_cvt_pk_bf16_f32 v95, v70, v71
  s_setprio 1
  v_mfma_f32_32x32x16_bf16 v[56:71], v[96:99], v[16:19], v[24:39]
  ds_read_b128 v[96:99], v124 offset:35840
  ds_read_b64 v[106:107], v125 offset:37888
  v_exp_f32 v72, v72
  v_exp_f32 v73, v73
  v_exp_f32 v74, v74
  v_exp_f32 v75, v75
  s_waitcnt lgkmcnt(2)
  v_mfma_f32_32x32x16_bf16 v[40:55], v[112:115], v[92:95], v[40:55]
  s_mov_b64 exec, s[20:21]
  ds_read_b128 v[116:119], v126 offset:29440
  ds_read_b128 v[120:123], v126 offset:30080
  s_mov_b64 exec, -1
  v_exp_f32 v76, v76
  v_exp_f32 v77, v77
  v_exp_f32 v78, v78
  v_exp_f32 v79, v79
  v_mfma_f32_32x32x8bf16_1k v[56:71], v[104:105], v[20:21], v[56:71]
  v_exp_f32 v80, v80
  v_exp_f32 v81, v81
  v_exp_f32 v82, v82
  v_exp_f32 v83, v83
  v_mfma_f32_32x32x16_bf16 v[40:55], v[108:111], v[88:91], v[40:55]
  v_exp_f32 v84, v84
  v_exp_f32 v85, v85
  v_exp_f32 v86, v86
  v_exp_f32 v87, v87
  s_setprio 0
  v_cvt_pk_bf16_f32 v88, v72, v73
  v_cvt_pk_bf16_f32 v89, v74, v75
  v_cvt_pk_bf16_f32 v90, v76, v77
  v_cvt_pk_bf16_f32 v91, v78, v79
  v_cvt_pk_bf16_f32 v92, v80, v81
  v_cvt_pk_bf16_f32 v93, v82, v83
  v_cvt_pk_bf16_f32 v94, v84, v85
  v_cvt_pk_bf16_f32 v95, v86, v87
  s_waitcnt vmcnt(6)
  s_barrier
  s_setprio 1
  v_mfma_f32_32x32x16_bf16 v[72:87], v[100:103], v[16:19], v[24:39]
  ds_read_b128 v[100:103], v124 offset:36864
  v_exp_f32 v56, v56
  v_exp_f32 v57, v57
  v_exp_f32 v58, v58
  v_exp_f32 v59, v59
  s_waitcnt lgkmcnt(1)
  v_mfma_f32_32x32x16_bf16 v[40:55], v[120:123], v[92:95], v[40:55]
  s_mov_b64 exec, s[20:21]
  ds_read_b128 v[108:111], v126 offset:33280
  ds_read_b128 v[112:115], v126 offset:33920
  s_mov_b64 exec, -1
  v_exp_f32 v60, v60
  v_exp_f32 v61, v61
  v_exp_f32 v62, v62
  v_exp_f32 v63, v63
  v_mfma_f32_32x32x8bf16_1k v[72:87], v[104:105], v[22:23], v[72:87]
  v_exp_f32 v64, v64
  v_exp_f32 v65, v65
  v_exp_f32 v66, v66
  v_exp_f32 v67, v67
  v_mfma_f32_32x32x16_bf16 v[40:55], v[116:119], v[88:91], v[40:55]
  v_exp_f32 v68, v68
  v_exp_f32 v69, v69
  v_exp_f32 v70, v70
  v_exp_f32 v71, v71
  s_setprio 0
  s_add_u32 s57, s57, s53
  buffer_load_dwordx2 v[134:135], v12, s[36:39], s57 offen
  v_cvt_pk_bf16_f32 v88, v56, v57
  v_cvt_pk_bf16_f32 v89, v58, v59
  v_cvt_pk_bf16_f32 v90, v60, v61
  v_cvt_pk_bf16_f32 v91, v62, v63
  v_cvt_pk_bf16_f32 v92, v64, v65
  v_cvt_pk_bf16_f32 v93, v66, v67
  v_cvt_pk_bf16_f32 v94, v68, v69
  v_cvt_pk_bf16_f32 v95, v70, v71
  s_setprio 1
  v_mfma_f32_32x32x16_bf16 v[56:71], v[96:99], v[16:19], v[24:39]
  ds_read_b128 v[96:99], v124 offset:40960
  ds_read_b64 v[104:105], v125 offset:43008
  v_exp_f32 v72, v72
  v_exp_f32 v73, v73
  v_exp_f32 v74, v74
  v_exp_f32 v75, v75
  s_waitcnt lgkmcnt(2)
  v_mfma_f32_32x32x16_bf16 v[40:55], v[112:115], v[92:95], v[40:55]
  s_mov_b64 exec, s[20:21]
  ds_read_b128 v[116:119], v126 offset:34560
  ds_read_b128 v[120:123], v126 offset:35200
  s_mov_b64 exec, -1
  v_exp_f32 v76, v76
  v_exp_f32 v77, v77
  v_exp_f32 v78, v78
  v_exp_f32 v79, v79
  v_mfma_f32_32x32x8bf16_1k v[56:71], v[106:107], v[20:21], v[56:71]
  v_exp_f32 v80, v80
  v_exp_f32 v81, v81
  v_exp_f32 v82, v82
  v_exp_f32 v83, v83
  v_mfma_f32_32x32x16_bf16 v[40:55], v[108:111], v[88:91], v[40:55]
  v_exp_f32 v84, v84
  v_exp_f32 v85, v85
  v_exp_f32 v86, v86
  v_exp_f32 v87, v87
  s_setprio 0
  v_cvt_pk_bf16_f32 v88, v72, v73
  v_cvt_pk_bf16_f32 v89, v74, v75
  v_cvt_pk_bf16_f32 v90, v76, v77
  v_cvt_pk_bf16_f32 v91, v78, v79
  v_cvt_pk_bf16_f32 v92, v80, v81
  v_cvt_pk_bf16_f32 v93, v82, v83
  v_cvt_pk_bf16_f32 v94, v84, v85
  v_cvt_pk_bf16_f32 v95, v86, v87
  s_setprio 1
  v_mfma_f32_32x32x16_bf16 v[72:87], v[100:103], v[16:19], v[24:39]
  ds_read_b128 v[100:103], v124 offset:41984
  v_exp_f32 v56, v56
  v_exp_f32 v57, v57
  v_exp_f32 v58, v58
  v_exp_f32 v59, v59
  s_waitcnt lgkmcnt(1)
  v_mfma_f32_32x32x16_bf16 v[40:55], v[120:123], v[92:95], v[40:55]
  s_mov_b64 exec, s[20:21]
  ds_read_b128 v[108:111], v126 offset:38400
  ds_read_b128 v[112:115], v126 offset:39040
  s_mov_b64 exec, -1
  v_exp_f32 v60, v60
  v_exp_f32 v61, v61
  v_exp_f32 v62, v62
  v_exp_f32 v63, v63
  v_mfma_f32_32x32x8bf16_1k v[72:87], v[106:107], v[22:23], v[72:87]
  v_exp_f32 v64, v64
  v_exp_f32 v65, v65
  v_exp_f32 v66, v66
  v_exp_f32 v67, v67
  v_mfma_f32_32x32x16_bf16 v[40:55], v[116:119], v[88:91], v[40:55]
  v_exp_f32 v68, v68
  v_exp_f32 v69, v69
  v_exp_f32 v70, v70
  v_exp_f32 v71, v71
  s_setprio 0
  buffer_load_dwordx2 v[142:143], v13, s[36:39], s57 offen
  v_cvt_pk_bf16_f32 v88, v56, v57
  v_cvt_pk_bf16_f32 v89, v58, v59
  v_cvt_pk_bf16_f32 v90, v60, v61
  v_cvt_pk_bf16_f32 v91, v62, v63
  v_cvt_pk_bf16_f32 v92, v64, v65
  v_cvt_pk_bf16_f32 v93, v66, v67
  v_cvt_pk_bf16_f32 v94, v68, v69
  v_cvt_pk_bf16_f32 v95, v70, v71
  s_setprio 1
  v_mfma_f32_32x32x16_bf16 v[56:71], v[96:99], v[16:19], v[24:39]
  ds_read_b128 v[96:99], v124 offset:46080
  ds_read_b64 v[106:107], v125 offset:48128
  v_exp_f32 v72, v72
  v_exp_f32 v73, v73
  v_exp_f32 v74, v74
  v_exp_f32 v75, v75
  s_waitcnt lgkmcnt(2)
  v_mfma_f32_32x32x16_bf16 v[40:55], v[112:115], v[92:95], v[40:55]
  s_mov_b64 exec, s[20:21]
  ds_read_b128 v[116:119], v126 offset:39680
  ds_read_b128 v[120:123], v126 offset:40320
  s_mov_b64 exec, -1
  v_exp_f32 v76, v76
  v_exp_f32 v77, v77
  v_exp_f32 v78, v78
  v_exp_f32 v79, v79
  v_mfma_f32_32x32x8bf16_1k v[56:71], v[104:105], v[20:21], v[56:71]
  v_exp_f32 v80, v80
  v_exp_f32 v81, v81
  v_exp_f32 v82, v82
  v_exp_f32 v83, v83
  v_mfma_f32_32x32x16_bf16 v[40:55], v[108:111], v[88:91], v[40:55]
  v_exp_f32 v84, v84
  v_exp_f32 v85, v85
  v_exp_f32 v86, v86
  v_exp_f32 v87, v87
  s_setprio 0
  v_add_u32 v124, 40960, v124
  v_add_u32 v125, 40960, v125
  v_add_u32 v126, 40960, v126
  v_cvt_pk_bf16_f32 v88, v72, v73
  v_cvt_pk_bf16_f32 v89, v74, v75
  v_cvt_pk_bf16_f32 v90, v76, v77
  v_cvt_pk_bf16_f32 v91, v78, v79
  v_cvt_pk_bf16_f32 v92, v80, v81
  v_cvt_pk_bf16_f32 v93, v82, v83
  v_cvt_pk_bf16_f32 v94, v84, v85
  v_cvt_pk_bf16_f32 v95, v86, v87
  s_setprio 1
  v_mfma_f32_32x32x16_bf16 v[72:87], v[100:103], v[16:19], v[24:39]
  ds_read_b128 v[100:103], v124 offset:6144
  v_exp_f32 v56, v56
  v_exp_f32 v57, v57
  v_exp_f32 v58, v58
  v_exp_f32 v59, v59
  s_waitcnt lgkmcnt(1)
  v_mfma_f32_32x32x16_bf16 v[40:55], v[120:123], v[92:95], v[40:55]
  s_mov_b64 exec, s[20:21]
  ds_read_b128 v[108:111], v126 offset:2560
  ds_read_b128 v[112:115], v126 offset:3200
  s_mov_b64 exec, -1
  v_exp_f32 v60, v60
  v_exp_f32 v61, v61
  v_exp_f32 v62, v62
  v_exp_f32 v63, v63
  v_mfma_f32_32x32x8bf16_1k v[72:87], v[104:105], v[22:23], v[72:87]
  v_exp_f32 v64, v64
  v_exp_f32 v65, v65
  v_exp_f32 v66, v66
  v_exp_f32 v67, v67
  v_mfma_f32_32x32x16_bf16 v[40:55], v[116:119], v[88:91], v[40:55]
  v_exp_f32 v68, v68
  v_exp_f32 v69, v69
  v_exp_f32 v70, v70
  v_exp_f32 v71, v71
  s_setprio 0
  v_cvt_pk_bf16_f32 v88, v56, v57
  v_cvt_pk_bf16_f32 v89, v58, v59
  v_cvt_pk_bf16_f32 v90, v60, v61
  v_cvt_pk_bf16_f32 v91, v62, v63
  v_cvt_pk_bf16_f32 v92, v64, v65
  v_cvt_pk_bf16_f32 v93, v66, v67
  v_cvt_pk_bf16_f32 v94, v68, v69
  v_cvt_pk_bf16_f32 v95, v70, v71
  s_setprio 1
  v_mfma_f32_32x32x16_bf16 v[56:71], v[96:99], v[16:19], v[24:39]
  ds_read_b128 v[96:99], v124 offset:10240
  ds_read_b64 v[104:105], v125 offset:12288
  v_exp_f32 v72, v72
  v_exp_f32 v73, v73
  v_exp_f32 v74, v74
  v_exp_f32 v75, v75
  s_waitcnt lgkmcnt(2)
  v_mfma_f32_32x32x16_bf16 v[40:55], v[112:115], v[92:95], v[40:55]
  s_mov_b64 exec, s[20:21]
  ds_read_b128 v[116:119], v126 offset:3840
  ds_read_b128 v[120:123], v126 offset:4480
  s_mov_b64 exec, -1
  v_exp_f32 v76, v76
  v_exp_f32 v77, v77
  v_exp_f32 v78, v78
  v_exp_f32 v79, v79
  v_mfma_f32_32x32x8bf16_1k v[56:71], v[106:107], v[20:21], v[56:71]
  v_exp_f32 v80, v80
  v_exp_f32 v81, v81
  v_exp_f32 v82, v82
  v_exp_f32 v83, v83
  v_mfma_f32_32x32x16_bf16 v[40:55], v[108:111], v[88:91], v[40:55]
  v_exp_f32 v84, v84
  v_exp_f32 v85, v85
  v_exp_f32 v86, v86
  v_exp_f32 v87, v87
  s_setprio 0
  v_cvt_pk_bf16_f32 v88, v72, v73
  v_cvt_pk_bf16_f32 v89, v74, v75
  v_cvt_pk_bf16_f32 v90, v76, v77
  v_cvt_pk_bf16_f32 v91, v78, v79
  v_cvt_pk_bf16_f32 v92, v80, v81
  v_cvt_pk_bf16_f32 v93, v82, v83
  v_cvt_pk_bf16_f32 v94, v84, v85
  v_cvt_pk_bf16_f32 v95, v86, v87
  s_setprio 1
  v_mfma_f32_32x32x16_bf16 v[72:87], v[100:103], v[16:19], v[24:39]
  ds_read_b128 v[100:103], v124 offset:11264
  v_exp_f32 v56, v56
  v_exp_f32 v57, v57
  v_exp_f32 v58, v58
  v_exp_f32 v59, v59
  s_waitcnt lgkmcnt(1)
  v_mfma_f32_32x32x16_bf16 v[40:55], v[120:123], v[92:95], v[40:55]
  s_mov_b64 exec, s[20:21]
  ds_read_b128 v[108:111], v126 offset:7680
  ds_read_b128 v[112:115], v126 offset:8320
  s_mov_b64 exec, -1
  v_exp_f32 v60, v60
  v_exp_f32 v61, v61
  v_exp_f32 v62, v62
  v_exp_f32 v63, v63
  v_mfma_f32_32x32x8bf16_1k v[72:87], v[106:107], v[22:23], v[72:87]
  v_exp_f32 v64, v64
  v_exp_f32 v65, v65
  v_exp_f32 v66, v66
  v_exp_f32 v67, v67
  v_mfma_f32_32x32x16_bf16 v[40:55], v[116:119], v[88:91], v[40:55]
  v_exp_f32 v68, v68
  v_exp_f32 v69, v69
  v_exp_f32 v70, v70
  v_exp_f32 v71, v71
  s_setprio 0
  v_cvt_pk_bf16_f32 v88, v56, v57
  v_cvt_pk_bf16_f32 v89, v58, v59
  v_cvt_pk_bf16_f32 v90, v60, v61
  v_cvt_pk_bf16_f32 v91, v62, v63
  v_cvt_pk_bf16_f32 v92, v64, v65
  v_cvt_pk_bf16_f32 v93, v66, v67
  v_cvt_pk_bf16_f32 v94, v68, v69
  v_cvt_pk_bf16_f32 v95, v70, v71
  s_setprio 1
  v_mfma_f32_32x32x16_bf16 v[56:71], v[96:99], v[16:19], v[24:39]
  ds_read_b128 v[96:99], v124 offset:15360
  ds_read_b64 v[106:107], v125 offset:17408
  v_exp_f32 v72, v72
  v_exp_f32 v73, v73
  v_exp_f32 v74, v74
  v_exp_f32 v75, v75
  s_waitcnt lgkmcnt(2)
  v_mfma_f32_32x32x16_bf16 v[40:55], v[112:115], v[92:95], v[40:55]
  s_mov_b64 exec, s[20:21]
  ds_read_b128 v[116:119], v126 offset:8960
  ds_read_b128 v[120:123], v126 offset:9600
  s_mov_b64 exec, -1
  v_exp_f32 v76, v76
  v_exp_f32 v77, v77
  v_exp_f32 v78, v78
  v_exp_f32 v79, v79
  v_mfma_f32_32x32x8bf16_1k v[56:71], v[104:105], v[20:21], v[56:71]
  v_exp_f32 v80, v80
  v_exp_f32 v81, v81
  v_exp_f32 v82, v82
  v_exp_f32 v83, v83
  v_mfma_f32_32x32x16_bf16 v[40:55], v[108:111], v[88:91], v[40:55]
  v_exp_f32 v84, v84
  v_exp_f32 v85, v85
  v_exp_f32 v86, v86
  v_exp_f32 v87, v87
  s_setprio 0
  v_cvt_pk_bf16_f32 v88, v72, v73
  v_cvt_pk_bf16_f32 v89, v74, v75
  v_cvt_pk_bf16_f32 v90, v76, v77
  v_cvt_pk_bf16_f32 v91, v78, v79
  v_cvt_pk_bf16_f32 v92, v80, v81
  v_cvt_pk_bf16_f32 v93, v82, v83
  v_cvt_pk_bf16_f32 v94, v84, v85
  v_cvt_pk_bf16_f32 v95, v86, v87
  s_setprio 1
  v_mfma_f32_32x32x16_bf16 v[72:87], v[100:103], v[16:19], v[24:39]
  ds_read_b128 v[100:103], v124 offset:16384
  v_exp_f32 v56, v56
  v_exp_f32 v57, v57
  v_exp_f32 v58, v58
  v_exp_f32 v59, v59
  s_waitcnt lgkmcnt(1)
  v_mfma_f32_32x32x16_bf16 v[40:55], v[120:123], v[92:95], v[40:55]
  s_mov_b64 exec, s[20:21]
  ds_read_b128 v[108:111], v126 offset:12800
  ds_read_b128 v[112:115], v126 offset:13440
  s_mov_b64 exec, -1
  v_exp_f32 v60, v60
  v_exp_f32 v61, v61
  v_exp_f32 v62, v62
  v_exp_f32 v63, v63
  v_mfma_f32_32x32x8bf16_1k v[72:87], v[104:105], v[22:23], v[72:87]
  v_exp_f32 v64, v64
  v_exp_f32 v65, v65
  v_exp_f32 v66, v66
  v_exp_f32 v67, v67
  v_mfma_f32_32x32x16_bf16 v[40:55], v[116:119], v[88:91], v[40:55]
  v_exp_f32 v68, v68
  v_exp_f32 v69, v69
  v_exp_f32 v70, v70
  v_exp_f32 v71, v71
  s_setprio 0
  s_mov_b32 s50, 0x05040100
  s_mov_b32 s51, 0x07060302
  s_waitcnt vmcnt(0)
  v_perm_b32 v144, v130, v128, s50
  v_perm_b32 v145, v134, v132, s50
  v_perm_b32 v146, v138, v136, s50
  v_perm_b32 v147, v142, v140, s50
  buffer_store_dwordx4 v[144:147], v160, s[16:19], 0 offen offset:0
  v_cvt_pk_bf16_f32 v88, v56, v57
  v_cvt_pk_bf16_f32 v89, v58, v59
  v_cvt_pk_bf16_f32 v90, v60, v61
  v_cvt_pk_bf16_f32 v91, v62, v63
  v_cvt_pk_bf16_f32 v92, v64, v65
  v_cvt_pk_bf16_f32 v93, v66, v67
  v_cvt_pk_bf16_f32 v94, v68, v69
  v_cvt_pk_bf16_f32 v95, v70, v71
  s_setprio 1
  v_mfma_f32_32x32x16_bf16 v[56:71], v[96:99], v[16:19], v[24:39]
  ds_read_b128 v[96:99], v124 offset:20480
  ds_read_b64 v[104:105], v125 offset:22528
  v_exp_f32 v72, v72
  v_exp_f32 v73, v73
  v_exp_f32 v74, v74
  v_exp_f32 v75, v75
  s_waitcnt lgkmcnt(2)
  v_mfma_f32_32x32x16_bf16 v[40:55], v[112:115], v[92:95], v[40:55]
  s_mov_b64 exec, s[20:21]
  ds_read_b128 v[116:119], v126 offset:14080
  ds_read_b128 v[120:123], v126 offset:14720
  s_mov_b64 exec, -1
  v_exp_f32 v76, v76
  v_exp_f32 v77, v77
  v_exp_f32 v78, v78
  v_exp_f32 v79, v79
  v_mfma_f32_32x32x8bf16_1k v[56:71], v[106:107], v[20:21], v[56:71]
  v_exp_f32 v80, v80
  v_exp_f32 v81, v81
  v_exp_f32 v82, v82
  v_exp_f32 v83, v83
  v_mfma_f32_32x32x16_bf16 v[40:55], v[108:111], v[88:91], v[40:55]
  v_exp_f32 v84, v84
  v_exp_f32 v85, v85
  v_exp_f32 v86, v86
  v_exp_f32 v87, v87
  s_setprio 0
  v_cvt_pk_bf16_f32 v88, v72, v73
  v_cvt_pk_bf16_f32 v89, v74, v75
  v_cvt_pk_bf16_f32 v90, v76, v77
  v_cvt_pk_bf16_f32 v91, v78, v79
  v_cvt_pk_bf16_f32 v92, v80, v81
  v_cvt_pk_bf16_f32 v93, v82, v83
  v_cvt_pk_bf16_f32 v94, v84, v85
  v_cvt_pk_bf16_f32 v95, v86, v87
  s_setprio 1
  v_mfma_f32_32x32x16_bf16 v[72:87], v[100:103], v[16:19], v[24:39]
  ds_read_b128 v[100:103], v124 offset:21504
  v_exp_f32 v56, v56
  v_exp_f32 v57, v57
  v_exp_f32 v58, v58
  v_exp_f32 v59, v59
  s_waitcnt lgkmcnt(1)
  v_mfma_f32_32x32x16_bf16 v[40:55], v[120:123], v[92:95], v[40:55]
  s_mov_b64 exec, s[20:21]
  ds_read_b128 v[108:111], v126 offset:17920
  ds_read_b128 v[112:115], v126 offset:18560
  s_mov_b64 exec, -1
  v_exp_f32 v60, v60
  v_exp_f32 v61, v61
  v_exp_f32 v62, v62
  v_exp_f32 v63, v63
  v_mfma_f32_32x32x8bf16_1k v[72:87], v[106:107], v[22:23], v[72:87]
  v_exp_f32 v64, v64
  v_exp_f32 v65, v65
  v_exp_f32 v66, v66
  v_exp_f32 v67, v67
  v_mfma_f32_32x32x16_bf16 v[40:55], v[116:119], v[88:91], v[40:55]
  v_exp_f32 v68, v68
  v_exp_f32 v69, v69
  v_exp_f32 v70, v70
  v_exp_f32 v71, v71
  s_setprio 0
  v_perm_b32 v148, v130, v128, s51
  v_perm_b32 v149, v134, v132, s51
  v_perm_b32 v150, v138, v136, s51
  v_perm_b32 v151, v142, v140, s51
  buffer_store_dwordx4 v[148:151], v160, s[16:19], 0 offen offset:16
  v_cvt_pk_bf16_f32 v88, v56, v57
  v_cvt_pk_bf16_f32 v89, v58, v59
  v_cvt_pk_bf16_f32 v90, v60, v61
  v_cvt_pk_bf16_f32 v91, v62, v63
  v_cvt_pk_bf16_f32 v92, v64, v65
  v_cvt_pk_bf16_f32 v93, v66, v67
  v_cvt_pk_bf16_f32 v94, v68, v69
  v_cvt_pk_bf16_f32 v95, v70, v71
  s_setprio 1
  v_mfma_f32_32x32x16_bf16 v[56:71], v[96:99], v[16:19], v[24:39]
  ds_read_b128 v[96:99], v124 offset:25600
  ds_read_b64 v[106:107], v125 offset:27648
  v_exp_f32 v72, v72
  v_exp_f32 v73, v73
  v_exp_f32 v74, v74
  v_exp_f32 v75, v75
  s_waitcnt lgkmcnt(2)
  v_mfma_f32_32x32x16_bf16 v[40:55], v[112:115], v[92:95], v[40:55]
  s_mov_b64 exec, s[20:21]
  ds_read_b128 v[116:119], v126 offset:19200
  ds_read_b128 v[120:123], v126 offset:19840
  s_mov_b64 exec, -1
  v_exp_f32 v76, v76
  v_exp_f32 v77, v77
  v_exp_f32 v78, v78
  v_exp_f32 v79, v79
  v_mfma_f32_32x32x8bf16_1k v[56:71], v[104:105], v[20:21], v[56:71]
  v_exp_f32 v80, v80
  v_exp_f32 v81, v81
  v_exp_f32 v82, v82
  v_exp_f32 v83, v83
  v_mfma_f32_32x32x16_bf16 v[40:55], v[108:111], v[88:91], v[40:55]
  v_exp_f32 v84, v84
  v_exp_f32 v85, v85
  v_exp_f32 v86, v86
  v_exp_f32 v87, v87
  s_setprio 0
  v_cvt_pk_bf16_f32 v88, v72, v73
  v_cvt_pk_bf16_f32 v89, v74, v75
  v_cvt_pk_bf16_f32 v90, v76, v77
  v_cvt_pk_bf16_f32 v91, v78, v79
  v_cvt_pk_bf16_f32 v92, v80, v81
  v_cvt_pk_bf16_f32 v93, v82, v83
  v_cvt_pk_bf16_f32 v94, v84, v85
  v_cvt_pk_bf16_f32 v95, v86, v87
  s_setprio 1
  v_mfma_f32_32x32x16_bf16 v[72:87], v[100:103], v[16:19], v[24:39]
  ds_read_b128 v[100:103], v124 offset:26624
  v_exp_f32 v56, v56
  v_exp_f32 v57, v57
  v_exp_f32 v58, v58
  v_exp_f32 v59, v59
  s_waitcnt lgkmcnt(1)
  v_mfma_f32_32x32x16_bf16 v[40:55], v[120:123], v[92:95], v[40:55]
  s_mov_b64 exec, s[20:21]
  ds_read_b128 v[108:111], v126 offset:23040
  ds_read_b128 v[112:115], v126 offset:23680
  s_mov_b64 exec, -1
  v_exp_f32 v60, v60
  v_exp_f32 v61, v61
  v_exp_f32 v62, v62
  v_exp_f32 v63, v63
  v_mfma_f32_32x32x8bf16_1k v[72:87], v[104:105], v[22:23], v[72:87]
  v_exp_f32 v64, v64
  v_exp_f32 v65, v65
  v_exp_f32 v66, v66
  v_exp_f32 v67, v67
  v_mfma_f32_32x32x16_bf16 v[40:55], v[116:119], v[88:91], v[40:55]
  v_exp_f32 v68, v68
  v_exp_f32 v69, v69
  v_exp_f32 v70, v70
  v_exp_f32 v71, v71
  s_setprio 0
  v_perm_b32 v152, v131, v129, s50
  v_perm_b32 v153, v135, v133, s50
  v_perm_b32 v154, v139, v137, s50
  v_perm_b32 v155, v143, v141, s50
  buffer_store_dwordx4 v[152:155], v160, s[16:19], 0 offen offset:32
  v_cvt_pk_bf16_f32 v88, v56, v57
  v_cvt_pk_bf16_f32 v89, v58, v59
  v_cvt_pk_bf16_f32 v90, v60, v61
  v_cvt_pk_bf16_f32 v91, v62, v63
  v_cvt_pk_bf16_f32 v92, v64, v65
  v_cvt_pk_bf16_f32 v93, v66, v67
  v_cvt_pk_bf16_f32 v94, v68, v69
  v_cvt_pk_bf16_f32 v95, v70, v71
  s_setprio 1
  v_mfma_f32_32x32x16_bf16 v[56:71], v[96:99], v[16:19], v[24:39]
  ds_read_b128 v[96:99], v124 offset:30720
  ds_read_b64 v[104:105], v125 offset:32768
  v_exp_f32 v72, v72
  v_exp_f32 v73, v73
  v_exp_f32 v74, v74
  v_exp_f32 v75, v75
  s_waitcnt lgkmcnt(2)
  v_mfma_f32_32x32x16_bf16 v[40:55], v[112:115], v[92:95], v[40:55]
  s_mov_b64 exec, s[20:21]
  ds_read_b128 v[116:119], v126 offset:24320
  ds_read_b128 v[120:123], v126 offset:24960
  s_mov_b64 exec, -1
  v_exp_f32 v76, v76
  v_exp_f32 v77, v77
  v_exp_f32 v78, v78
  v_exp_f32 v79, v79
  v_mfma_f32_32x32x8bf16_1k v[56:71], v[106:107], v[20:21], v[56:71]
  v_exp_f32 v80, v80
  v_exp_f32 v81, v81
  v_exp_f32 v82, v82
  v_exp_f32 v83, v83
  v_mfma_f32_32x32x16_bf16 v[40:55], v[108:111], v[88:91], v[40:55]
  v_exp_f32 v84, v84
  v_exp_f32 v85, v85
  v_exp_f32 v86, v86
  v_exp_f32 v87, v87
  s_setprio 0
  v_cvt_pk_bf16_f32 v88, v72, v73
  v_cvt_pk_bf16_f32 v89, v74, v75
  v_cvt_pk_bf16_f32 v90, v76, v77
  v_cvt_pk_bf16_f32 v91, v78, v79
  v_cvt_pk_bf16_f32 v92, v80, v81
  v_cvt_pk_bf16_f32 v93, v82, v83
  v_cvt_pk_bf16_f32 v94, v84, v85
  v_cvt_pk_bf16_f32 v95, v86, v87
  s_setprio 1
  v_mfma_f32_32x32x16_bf16 v[72:87], v[100:103], v[16:19], v[24:39]
  ds_read_b128 v[100:103], v124 offset:31744
  v_exp_f32 v56, v56
  v_exp_f32 v57, v57
  v_exp_f32 v58, v58
  v_exp_f32 v59, v59
  s_waitcnt lgkmcnt(1)
  v_mfma_f32_32x32x16_bf16 v[40:55], v[120:123], v[92:95], v[40:55]
  s_mov_b64 exec, s[20:21]
  ds_read_b128 v[108:111], v126 offset:28160
  ds_read_b128 v[112:115], v126 offset:28800
  s_mov_b64 exec, -1
  v_exp_f32 v60, v60
  v_exp_f32 v61, v61
  v_exp_f32 v62, v62
  v_exp_f32 v63, v63
  v_mfma_f32_32x32x8bf16_1k v[72:87], v[106:107], v[22:23], v[72:87]
  v_exp_f32 v64, v64
  v_exp_f32 v65, v65
  v_exp_f32 v66, v66
  v_exp_f32 v67, v67
  v_mfma_f32_32x32x16_bf16 v[40:55], v[116:119], v[88:91], v[40:55]
  v_exp_f32 v68, v68
  v_exp_f32 v69, v69
  v_exp_f32 v70, v70
  v_exp_f32 v71, v71
  s_setprio 0
  v_perm_b32 v156, v131, v129, s51
  v_perm_b32 v157, v135, v133, s51
  v_perm_b32 v158, v139, v137, s51
  v_perm_b32 v159, v143, v141, s51
  buffer_store_dwordx4 v[156:159], v160, s[16:19], 0 offen offset:48
  v_cvt_pk_bf16_f32 v88, v56, v57
  v_cvt_pk_bf16_f32 v89, v58, v59
  v_cvt_pk_bf16_f32 v90, v60, v61
  v_cvt_pk_bf16_f32 v91, v62, v63
  v_cvt_pk_bf16_f32 v92, v64, v65
  v_cvt_pk_bf16_f32 v93, v66, v67
  v_cvt_pk_bf16_f32 v94, v68, v69
  v_cvt_pk_bf16_f32 v95, v70, v71
  s_setprio 1
  v_mfma_f32_32x32x16_bf16 v[56:71], v[96:99], v[16:19], v[24:39]
  ds_read_b128 v[96:99], v124 offset:35840
  ds_read_b64 v[106:107], v125 offset:37888
  v_exp_f32 v72, v72
  v_exp_f32 v73, v73
  v_exp_f32 v74, v74
  v_exp_f32 v75, v75
  s_waitcnt lgkmcnt(2)
  v_mfma_f32_32x32x16_bf16 v[40:55], v[112:115], v[92:95], v[40:55]
  s_mov_b64 exec, s[20:21]
  ds_read_b128 v[116:119], v126 offset:29440
  ds_read_b128 v[120:123], v126 offset:30080
  s_mov_b64 exec, -1
  v_exp_f32 v76, v76
  v_exp_f32 v77, v77
  v_exp_f32 v78, v78
  v_exp_f32 v79, v79
  v_mfma_f32_32x32x8bf16_1k v[56:71], v[104:105], v[20:21], v[56:71]
  v_exp_f32 v80, v80
  v_exp_f32 v81, v81
  v_exp_f32 v82, v82
  v_exp_f32 v83, v83
  v_mfma_f32_32x32x16_bf16 v[40:55], v[108:111], v[88:91], v[40:55]
  v_exp_f32 v84, v84
  v_exp_f32 v85, v85
  v_exp_f32 v86, v86
  v_exp_f32 v87, v87
  s_setprio 0
  v_mfma_f32_16x16x32_bf16 v[128:131], v[164:167], v[144:147], 0
  v_mfma_f32_16x16x32_bf16 v[132:135], v[164:167], v[148:151], 0
  v_mfma_f32_16x16x32_bf16 v[136:139], v[164:167], v[152:155], 0
  v_mfma_f32_16x16x32_bf16 v[140:143], v[164:167], v[156:159], 0
  v_cvt_pk_bf16_f32 v88, v72, v73
  v_cvt_pk_bf16_f32 v89, v74, v75
  v_cvt_pk_bf16_f32 v90, v76, v77
  v_cvt_pk_bf16_f32 v91, v78, v79
  v_cvt_pk_bf16_f32 v92, v80, v81
  v_cvt_pk_bf16_f32 v93, v82, v83
  v_cvt_pk_bf16_f32 v94, v84, v85
  v_cvt_pk_bf16_f32 v95, v86, v87
  s_setprio 1
  v_mfma_f32_32x32x16_bf16 v[72:87], v[100:103], v[16:19], v[24:39]
  ds_read_b128 v[100:103], v124 offset:36864
  v_exp_f32 v56, v56
  v_exp_f32 v57, v57
  v_exp_f32 v58, v58
  v_exp_f32 v59, v59
  s_waitcnt lgkmcnt(1)
  v_mfma_f32_32x32x16_bf16 v[40:55], v[120:123], v[92:95], v[40:55]
  s_mov_b64 exec, s[20:21]
  ds_read_b128 v[108:111], v126 offset:33280
  ds_read_b128 v[112:115], v126 offset:33920
  s_mov_b64 exec, -1
  v_exp_f32 v60, v60
  v_exp_f32 v61, v61
  v_exp_f32 v62, v62
  v_exp_f32 v63, v63
  v_mfma_f32_32x32x8bf16_1k v[72:87], v[104:105], v[22:23], v[72:87]
  v_exp_f32 v64, v64
  v_exp_f32 v65, v65
  v_exp_f32 v66, v66
  v_exp_f32 v67, v67
  v_mfma_f32_32x32x16_bf16 v[40:55], v[116:119], v[88:91], v[40:55]
  v_exp_f32 v68, v68
  v_exp_f32 v69, v69
  v_exp_f32 v70, v70
  v_exp_f32 v71, v71
  s_setprio 0
  v_mov_b32_dpp v128, v132 quad_perm:[0,1,2,3] row_mask:0x2 bank_mask:0xf
  v_mov_b32_dpp v128, v136 quad_perm:[0,1,2,3] row_mask:0x4 bank_mask:0xf
  v_mov_b32_dpp v128, v140 quad_perm:[0,1,2,3] row_mask:0x8 bank_mask:0xf
  buffer_store_dword v128, v4, s[16:19], 0 offen
  v_cvt_pk_bf16_f32 v88, v56, v57
  v_cvt_pk_bf16_f32 v89, v58, v59
  v_cvt_pk_bf16_f32 v90, v60, v61
  v_cvt_pk_bf16_f32 v91, v62, v63
  v_cvt_pk_bf16_f32 v92, v64, v65
  v_cvt_pk_bf16_f32 v93, v66, v67
  v_cvt_pk_bf16_f32 v94, v68, v69
  v_cvt_pk_bf16_f32 v95, v70, v71
  s_setprio 1
  v_mfma_f32_32x32x16_bf16 v[56:71], v[96:99], v[16:19], v[24:39]
  ds_read_b128 v[96:99], v124 offset:40960
  ds_read_b64 v[104:105], v125 offset:43008
  v_exp_f32 v72, v72
  v_exp_f32 v73, v73
  v_exp_f32 v74, v74
  v_exp_f32 v75, v75
  s_waitcnt lgkmcnt(2)
  v_mfma_f32_32x32x16_bf16 v[40:55], v[112:115], v[92:95], v[40:55]
  s_mov_b64 exec, s[20:21]
  ds_read_b128 v[116:119], v126 offset:34560
  ds_read_b128 v[120:123], v126 offset:35200
  s_mov_b64 exec, -1
  v_exp_f32 v76, v76
  v_exp_f32 v77, v77
  v_exp_f32 v78, v78
  v_exp_f32 v79, v79
  v_mfma_f32_32x32x8bf16_1k v[56:71], v[106:107], v[20:21], v[56:71]
  v_exp_f32 v80, v80
  v_exp_f32 v81, v81
  v_exp_f32 v82, v82
  v_exp_f32 v83, v83
  v_mfma_f32_32x32x16_bf16 v[40:55], v[108:111], v[88:91], v[40:55]
  v_exp_f32 v84, v84
  v_exp_f32 v85, v85
  v_exp_f32 v86, v86
  v_exp_f32 v87, v87
  s_setprio 0
  v_cvt_pk_bf16_f32 v88, v72, v73
  v_cvt_pk_bf16_f32 v89, v74, v75
  v_cvt_pk_bf16_f32 v90, v76, v77
  v_cvt_pk_bf16_f32 v91, v78, v79
  v_cvt_pk_bf16_f32 v92, v80, v81
  v_cvt_pk_bf16_f32 v93, v82, v83
  v_cvt_pk_bf16_f32 v94, v84, v85
  v_cvt_pk_bf16_f32 v95, v86, v87
  s_setprio 1
  v_mfma_f32_32x32x16_bf16 v[72:87], v[100:103], v[16:19], v[24:39]
  ds_read_b128 v[100:103], v124 offset:41984
  v_exp_f32 v56, v56
  v_exp_f32 v57, v57
  v_exp_f32 v58, v58
  v_exp_f32 v59, v59
  s_waitcnt lgkmcnt(1)
  v_mfma_f32_32x32x16_bf16 v[40:55], v[120:123], v[92:95], v[40:55]
  s_mov_b64 exec, s[20:21]
  ds_read_b128 v[108:111], v126 offset:38400
  ds_read_b128 v[112:115], v126 offset:39040
  s_mov_b64 exec, -1
  v_exp_f32 v60, v60
  v_exp_f32 v61, v61
  v_exp_f32 v62, v62
  v_exp_f32 v63, v63
  v_mfma_f32_32x32x8bf16_1k v[72:87], v[106:107], v[22:23], v[72:87]
  v_exp_f32 v64, v64
  v_exp_f32 v65, v65
  v_exp_f32 v66, v66
  v_exp_f32 v67, v67
  v_mfma_f32_32x32x16_bf16 v[40:55], v[116:119], v[88:91], v[40:55]
  v_exp_f32 v68, v68
  v_exp_f32 v69, v69
  v_exp_f32 v70, v70
  v_exp_f32 v71, v71
  s_setprio 0
  v_cvt_pk_bf16_f32 v88, v56, v57
  v_cvt_pk_bf16_f32 v89, v58, v59
  v_cvt_pk_bf16_f32 v90, v60, v61
  v_cvt_pk_bf16_f32 v91, v62, v63
  v_cvt_pk_bf16_f32 v92, v64, v65
  v_cvt_pk_bf16_f32 v93, v66, v67
  v_cvt_pk_bf16_f32 v94, v68, v69
  v_cvt_pk_bf16_f32 v95, v70, v71
  s_setprio 1
  v_mfma_f32_32x32x16_bf16 v[56:71], v[96:99], v[16:19], v[24:39]
  ds_read_b128 v[96:99], v124 offset:46080
  ds_read_b64 v[106:107], v125 offset:48128
  v_exp_f32 v72, v72
  v_exp_f32 v73, v73
  v_exp_f32 v74, v74
  v_exp_f32 v75, v75
  s_waitcnt lgkmcnt(2)
  v_mfma_f32_32x32x16_bf16 v[40:55], v[112:115], v[92:95], v[40:55]
  s_mov_b64 exec, s[20:21]
  ds_read_b128 v[116:119], v126 offset:39680
  ds_read_b128 v[120:123], v126 offset:40320
  s_mov_b64 exec, -1
  v_exp_f32 v76, v76
  v_exp_f32 v77, v77
  v_exp_f32 v78, v78
  v_exp_f32 v79, v79
  v_mfma_f32_32x32x8bf16_1k v[56:71], v[104:105], v[20:21], v[56:71]
  v_exp_f32 v80, v80
  v_exp_f32 v81, v81
  v_exp_f32 v82, v82
  v_exp_f32 v83, v83
  v_mfma_f32_32x32x16_bf16 v[40:55], v[108:111], v[88:91], v[40:55]
  v_exp_f32 v84, v84
  v_exp_f32 v85, v85
  v_exp_f32 v86, v86
  v_exp_f32 v87, v87
  s_setprio 0
  v_add_u32 v124, 40960, v124
  v_add_u32 v125, 40960, v125
  v_add_u32 v126, 40960, v126
  v_cvt_pk_bf16_f32 v88, v72, v73
  v_cvt_pk_bf16_f32 v89, v74, v75
  v_cvt_pk_bf16_f32 v90, v76, v77
  v_cvt_pk_bf16_f32 v91, v78, v79
  v_cvt_pk_bf16_f32 v92, v80, v81
  v_cvt_pk_bf16_f32 v93, v82, v83
  v_cvt_pk_bf16_f32 v94, v84, v85
  v_cvt_pk_bf16_f32 v95, v86, v87
  s_setprio 1
  v_mfma_f32_32x32x16_bf16 v[72:87], v[100:103], v[16:19], v[24:39]
  ds_read_b128 v[100:103], v124 offset:6144
  v_exp_f32 v56, v56
  v_exp_f32 v57, v57
  v_exp_f32 v58, v58
  v_exp_f32 v59, v59
  s_waitcnt lgkmcnt(1)
  v_mfma_f32_32x32x16_bf16 v[40:55], v[120:123], v[92:95], v[40:55]
  s_mov_b64 exec, s[20:21]
  ds_read_b128 v[108:111], v126 offset:2560
  ds_read_b128 v[112:115], v126 offset:3200
  s_mov_b64 exec, -1
  v_exp_f32 v60, v60
  v_exp_f32 v61, v61
  v_exp_f32 v62, v62
  v_exp_f32 v63, v63
  v_mfma_f32_32x32x8bf16_1k v[72:87], v[104:105], v[22:23], v[72:87]
  v_exp_f32 v64, v64
  v_exp_f32 v65, v65
  v_exp_f32 v66, v66
  v_exp_f32 v67, v67
  v_mfma_f32_32x32x16_bf16 v[40:55], v[116:119], v[88:91], v[40:55]
  v_exp_f32 v68, v68
  v_exp_f32 v69, v69
  v_exp_f32 v70, v70
  v_exp_f32 v71, v71
  s_setprio 0
  v_cvt_pk_bf16_f32 v88, v56, v57
  v_cvt_pk_bf16_f32 v89, v58, v59
  v_cvt_pk_bf16_f32 v90, v60, v61
  v_cvt_pk_bf16_f32 v91, v62, v63
  v_cvt_pk_bf16_f32 v92, v64, v65
  v_cvt_pk_bf16_f32 v93, v66, v67
  v_cvt_pk_bf16_f32 v94, v68, v69
  v_cvt_pk_bf16_f32 v95, v70, v71
  s_setprio 1
  v_mfma_f32_32x32x16_bf16 v[56:71], v[96:99], v[16:19], v[24:39]
  ds_read_b128 v[96:99], v124 offset:10240
  ds_read_b64 v[104:105], v125 offset:12288
  v_exp_f32 v72, v72
  v_exp_f32 v73, v73
  v_exp_f32 v74, v74
  v_exp_f32 v75, v75
  s_waitcnt lgkmcnt(2)
  v_mfma_f32_32x32x16_bf16 v[40:55], v[112:115], v[92:95], v[40:55]
  s_mov_b64 exec, s[20:21]
  ds_read_b128 v[116:119], v126 offset:3840
  ds_read_b128 v[120:123], v126 offset:4480
  s_mov_b64 exec, -1
  v_exp_f32 v76, v76
  v_exp_f32 v77, v77
  v_exp_f32 v78, v78
  v_exp_f32 v79, v79
  v_mfma_f32_32x32x8bf16_1k v[56:71], v[106:107], v[20:21], v[56:71]
  v_exp_f32 v80, v80
  v_exp_f32 v81, v81
  v_exp_f32 v82, v82
  v_exp_f32 v83, v83
  v_mfma_f32_32x32x16_bf16 v[40:55], v[108:111], v[88:91], v[40:55]
  v_exp_f32 v84, v84
  v_exp_f32 v85, v85
  v_exp_f32 v86, v86
  v_exp_f32 v87, v87
  s_setprio 0
  v_cvt_pk_bf16_f32 v88, v72, v73
  v_cvt_pk_bf16_f32 v89, v74, v75
  v_cvt_pk_bf16_f32 v90, v76, v77
  v_cvt_pk_bf16_f32 v91, v78, v79
  v_cvt_pk_bf16_f32 v92, v80, v81
  v_cvt_pk_bf16_f32 v93, v82, v83
  v_cvt_pk_bf16_f32 v94, v84, v85
  v_cvt_pk_bf16_f32 v95, v86, v87
  s_setprio 1
  v_mfma_f32_32x32x16_bf16 v[72:87], v[100:103], v[16:19], v[24:39]
  ds_read_b128 v[100:103], v124 offset:11264
  v_exp_f32 v56, v56
  v_exp_f32 v57, v57
  v_exp_f32 v58, v58
  v_exp_f32 v59, v59
  s_waitcnt lgkmcnt(1)
  v_mfma_f32_32x32x16_bf16 v[40:55], v[120:123], v[92:95], v[40:55]
  s_mov_b64 exec, s[20:21]
  ds_read_b128 v[108:111], v126 offset:7680
  ds_read_b128 v[112:115], v126 offset:8320
  s_mov_b64 exec, -1
  v_exp_f32 v60, v60
  v_exp_f32 v61, v61
  v_exp_f32 v62, v62
  v_exp_f32 v63, v63
  v_mfma_f32_32x32x8bf16_1k v[72:87], v[106:107], v[22:23], v[72:87]
  v_exp_f32 v64, v64
  v_exp_f32 v65, v65
  v_exp_f32 v66, v66
  v_exp_f32 v67, v67
  v_mfma_f32_32x32x16_bf16 v[40:55], v[116:119], v[88:91], v[40:55]
  v_exp_f32 v68, v68
  v_exp_f32 v69, v69
  v_exp_f32 v70, v70
  v_exp_f32 v71, v71
  s_setprio 0
  v_cvt_pk_bf16_f32 v88, v56, v57
  v_cvt_pk_bf16_f32 v89, v58, v59
  v_cvt_pk_bf16_f32 v90, v60, v61
  v_cvt_pk_bf16_f32 v91, v62, v63
  v_cvt_pk_bf16_f32 v92, v64, v65
  v_cvt_pk_bf16_f32 v93, v66, v67
  v_cvt_pk_bf16_f32 v94, v68, v69
  v_cvt_pk_bf16_f32 v95, v70, v71
  s_setprio 1
  v_mfma_f32_32x32x16_bf16 v[56:71], v[96:99], v[16:19], v[24:39]
  ds_read_b128 v[96:99], v124 offset:15360
  ds_read_b64 v[106:107], v125 offset:17408
  v_exp_f32 v72, v72
  v_exp_f32 v73, v73
  v_exp_f32 v74, v74
  v_exp_f32 v75, v75
  s_waitcnt lgkmcnt(2)
  v_mfma_f32_32x32x16_bf16 v[40:55], v[112:115], v[92:95], v[40:55]
  s_mov_b64 exec, s[20:21]
  ds_read_b128 v[116:119], v126 offset:8960
  ds_read_b128 v[120:123], v126 offset:9600
  s_mov_b64 exec, -1
  v_exp_f32 v76, v76
  v_exp_f32 v77, v77
  v_exp_f32 v78, v78
  v_exp_f32 v79, v79
  v_mfma_f32_32x32x8bf16_1k v[56:71], v[104:105], v[20:21], v[56:71]
  v_exp_f32 v80, v80
  v_exp_f32 v81, v81
  v_exp_f32 v82, v82
  v_exp_f32 v83, v83
  v_mfma_f32_32x32x16_bf16 v[40:55], v[108:111], v[88:91], v[40:55]
  v_exp_f32 v84, v84
  v_exp_f32 v85, v85
  v_exp_f32 v86, v86
  v_exp_f32 v87, v87
  s_setprio 0
  v_cvt_pk_bf16_f32 v88, v72, v73
  v_cvt_pk_bf16_f32 v89, v74, v75
  v_cvt_pk_bf16_f32 v90, v76, v77
  v_cvt_pk_bf16_f32 v91, v78, v79
  v_cvt_pk_bf16_f32 v92, v80, v81
  v_cvt_pk_bf16_f32 v93, v82, v83
  v_cvt_pk_bf16_f32 v94, v84, v85
  v_cvt_pk_bf16_f32 v95, v86, v87
  s_setprio 1
  v_mfma_f32_32x32x16_bf16 v[72:87], v[100:103], v[16:19], v[24:39]
  ds_read_b128 v[100:103], v124 offset:16384
  v_exp_f32 v56, v56
  v_exp_f32 v57, v57
  v_exp_f32 v58, v58
  v_exp_f32 v59, v59
  s_waitcnt lgkmcnt(1)
  v_mfma_f32_32x32x16_bf16 v[40:55], v[120:123], v[92:95], v[40:55]
  s_mov_b64 exec, s[20:21]
  ds_read_b128 v[108:111], v126 offset:12800
  ds_read_b128 v[112:115], v126 offset:13440
  s_mov_b64 exec, -1
  v_exp_f32 v60, v60
  v_exp_f32 v61, v61
  v_exp_f32 v62, v62
  v_exp_f32 v63, v63
  v_mfma_f32_32x32x8bf16_1k v[72:87], v[104:105], v[22:23], v[72:87]
  v_exp_f32 v64, v64
  v_exp_f32 v65, v65
  v_exp_f32 v66, v66
  v_exp_f32 v67, v67
  v_mfma_f32_32x32x16_bf16 v[40:55], v[116:119], v[88:91], v[40:55]
  v_exp_f32 v68, v68
  v_exp_f32 v69, v69
  v_exp_f32 v70, v70
  v_exp_f32 v71, v71
  s_setprio 0
  buffer_load_dword v127, v163, s[40:43], 0 offen
  s_lshl_b32 s3, s11, 3
  s_add_u32 s3, s3, s26
  s_cmp_lg_u32 s3, 7
  s_cbranch_scc1 s2_att_wb_8
  buffer_wbl2 sc1
s2_att_wb_8:
  v_cvt_pk_bf16_f32 v88, v56, v57
  v_cvt_pk_bf16_f32 v89, v58, v59
  v_cvt_pk_bf16_f32 v90, v60, v61
  v_cvt_pk_bf16_f32 v91, v62, v63
  v_cvt_pk_bf16_f32 v92, v64, v65
  v_cvt_pk_bf16_f32 v93, v66, v67
  v_cvt_pk_bf16_f32 v94, v68, v69
  v_cvt_pk_bf16_f32 v95, v70, v71
  s_setprio 1
  v_mfma_f32_32x32x16_bf16 v[56:71], v[96:99], v[16:19], v[24:39]
  ds_read_b128 v[96:99], v124 offset:20480
  ds_read_b64 v[104:105], v125 offset:22528
  v_exp_f32 v72, v72
  v_exp_f32 v73, v73
  v_exp_f32 v74, v74
  v_exp_f32 v75, v75
  s_waitcnt lgkmcnt(2)
  v_mfma_f32_32x32x16_bf16 v[40:55], v[112:115], v[92:95], v[40:55]
  s_mov_b64 exec, s[20:21]
  ds_read_b128 v[116:119], v126 offset:14080
  ds_read_b128 v[120:123], v126 offset:14720
  s_mov_b64 exec, -1
  v_exp_f32 v76, v76
  v_exp_f32 v77, v77
  v_exp_f32 v78, v78
  v_exp_f32 v79, v79
  v_mfma_f32_32x32x8bf16_1k v[56:71], v[106:107], v[20:21], v[56:71]
  v_exp_f32 v80, v80
  v_exp_f32 v81, v81
  v_exp_f32 v82, v82
  v_exp_f32 v83, v83
  v_mfma_f32_32x32x16_bf16 v[40:55], v[108:111], v[88:91], v[40:55]
  v_exp_f32 v84, v84
  v_exp_f32 v85, v85
  v_exp_f32 v86, v86
  v_exp_f32 v87, v87
  s_setprio 0
  v_cvt_pk_bf16_f32 v88, v72, v73
  v_cvt_pk_bf16_f32 v89, v74, v75
  v_cvt_pk_bf16_f32 v90, v76, v77
  v_cvt_pk_bf16_f32 v91, v78, v79
  v_cvt_pk_bf16_f32 v92, v80, v81
  v_cvt_pk_bf16_f32 v93, v82, v83
  v_cvt_pk_bf16_f32 v94, v84, v85
  v_cvt_pk_bf16_f32 v95, v86, v87
  s_setprio 1
  v_mfma_f32_32x32x16_bf16 v[72:87], v[100:103], v[16:19], v[24:39]
  ds_read_b128 v[100:103], v124 offset:21504
  v_exp_f32 v56, v56
  v_exp_f32 v57, v57
  v_exp_f32 v58, v58
  v_exp_f32 v59, v59
  s_waitcnt lgkmcnt(1)
  v_mfma_f32_32x32x16_bf16 v[40:55], v[120:123], v[92:95], v[40:55]
  s_mov_b64 exec, s[20:21]
  ds_read_b128 v[108:111], v126 offset:17920
  ds_read_b128 v[112:115], v126 offset:18560
  s_mov_b64 exec, -1
  v_exp_f32 v60, v60
  v_exp_f32 v61, v61
  v_exp_f32 v62, v62
  v_exp_f32 v63, v63
  v_mfma_f32_32x32x8bf16_1k v[72:87], v[106:107], v[22:23], v[72:87]
  v_exp_f32 v64, v64
  v_exp_f32 v65, v65
  v_exp_f32 v66, v66
  v_exp_f32 v67, v67
  v_mfma_f32_32x32x16_bf16 v[40:55], v[116:119], v[88:91], v[40:55]
  v_exp_f32 v68, v68
  v_exp_f32 v69, v69
  v_exp_f32 v70, v70
  v_exp_f32 v71, v71
  s_setprio 0
  v_cvt_pk_bf16_f32 v88, v56, v57
  v_cvt_pk_bf16_f32 v89, v58, v59
  v_cvt_pk_bf16_f32 v90, v60, v61
  v_cvt_pk_bf16_f32 v91, v62, v63
  v_cvt_pk_bf16_f32 v92, v64, v65
  v_cvt_pk_bf16_f32 v93, v66, v67
  v_cvt_pk_bf16_f32 v94, v68, v69
  v_cvt_pk_bf16_f32 v95, v70, v71
  s_setprio 1
  v_mfma_f32_32x32x16_bf16 v[56:71], v[96:99], v[16:19], v[24:39]
  ds_read_b128 v[96:99], v124 offset:25600
  ds_read_b64 v[106:107], v125 offset:27648
  v_exp_f32 v72, v72
  v_exp_f32 v73, v73
  v_exp_f32 v74, v74
  v_exp_f32 v75, v75
  s_waitcnt lgkmcnt(2)
  v_mfma_f32_32x32x16_bf16 v[40:55], v[112:115], v[92:95], v[40:55]
  s_mov_b64 exec, s[20:21]
  ds_read_b128 v[116:119], v126 offset:19200
  ds_read_b128 v[120:123], v126 offset:19840
  s_mov_b64 exec, -1
  v_exp_f32 v76, v76
  v_exp_f32 v77, v77
  v_exp_f32 v78, v78
  v_exp_f32 v79, v79
  v_mfma_f32_32x32x8bf16_1k v[56:71], v[104:105], v[20:21], v[56:71]
  v_exp_f32 v80, v80
  v_exp_f32 v81, v81
  v_exp_f32 v82, v82
  v_exp_f32 v83, v83
  v_mfma_f32_32x32x16_bf16 v[40:55], v[108:111], v[88:91], v[40:55]
  v_exp_f32 v84, v84
  v_exp_f32 v85, v85
  v_exp_f32 v86, v86
  v_exp_f32 v87, v87
  s_setprio 0
  v_cvt_pk_bf16_f32 v88, v72, v73
  v_cvt_pk_bf16_f32 v89, v74, v75
  v_cvt_pk_bf16_f32 v90, v76, v77
  v_cvt_pk_bf16_f32 v91, v78, v79
  v_cvt_pk_bf16_f32 v92, v80, v81
  v_cvt_pk_bf16_f32 v93, v82, v83
  v_cvt_pk_bf16_f32 v94, v84, v85
  v_cvt_pk_bf16_f32 v95, v86, v87
  s_setprio 1
  v_mfma_f32_32x32x16_bf16 v[72:87], v[100:103], v[16:19], v[24:39]
  ds_read_b128 v[100:103], v124 offset:26624
  v_exp_f32 v56, v56
  v_exp_f32 v57, v57
  v_exp_f32 v58, v58
  v_exp_f32 v59, v59
  s_waitcnt lgkmcnt(1)
  v_mfma_f32_32x32x16_bf16 v[40:55], v[120:123], v[92:95], v[40:55]
  s_mov_b64 exec, s[20:21]
  ds_read_b128 v[108:111], v126 offset:23040
  ds_read_b128 v[112:115], v126 offset:23680
  s_mov_b64 exec, -1
  v_exp_f32 v60, v60
  v_exp_f32 v61, v61
  v_exp_f32 v62, v62
  v_exp_f32 v63, v63
  v_mfma_f32_32x32x8bf16_1k v[72:87], v[104:105], v[22:23], v[72:87]
  v_exp_f32 v64, v64
  v_exp_f32 v65, v65
  v_exp_f32 v66, v66
  v_exp_f32 v67, v67
  v_mfma_f32_32x32x16_bf16 v[40:55], v[116:119], v[88:91], v[40:55]
  v_exp_f32 v68, v68
  v_exp_f32 v69, v69
  v_exp_f32 v70, v70
  v_exp_f32 v71, v71
  s_setprio 0
  v_cvt_pk_bf16_f32 v88, v56, v57
  v_cvt_pk_bf16_f32 v89, v58, v59
  v_cvt_pk_bf16_f32 v90, v60, v61
  v_cvt_pk_bf16_f32 v91, v62, v63
  v_cvt_pk_bf16_f32 v92, v64, v65
  v_cvt_pk_bf16_f32 v93, v66, v67
  v_cvt_pk_bf16_f32 v94, v68, v69
  v_cvt_pk_bf16_f32 v95, v70, v71
  s_setprio 1
  v_mfma_f32_32x32x16_bf16 v[56:71], v[96:99], v[16:19], v[24:39]
  ds_read_b128 v[96:99], v124 offset:30720
  ds_read_b64 v[104:105], v125 offset:32768
  v_exp_f32 v72, v72
  v_exp_f32 v73, v73
  v_exp_f32 v74, v74
  v_exp_f32 v75, v75
  s_waitcnt lgkmcnt(2)
  v_mfma_f32_32x32x16_bf16 v[40:55], v[112:115], v[92:95], v[40:55]
  s_mov_b64 exec, s[20:21]
  ds_read_b128 v[116:119], v126 offset:24320
  ds_read_b128 v[120:123], v126 offset:24960
  s_mov_b64 exec, -1
  v_exp_f32 v76, v76
  v_exp_f32 v77, v77
  v_exp_f32 v78, v78
  v_exp_f32 v79, v79
  v_mfma_f32_32x32x8bf16_1k v[56:71], v[106:107], v[20:21], v[56:71]
  v_exp_f32 v80, v80
  v_exp_f32 v81, v81
  v_exp_f32 v82, v82
  v_exp_f32 v83, v83
  v_mfma_f32_32x32x16_bf16 v[40:55], v[108:111], v[88:91], v[40:55]
  v_exp_f32 v84, v84
  v_exp_f32 v85, v85
  v_exp_f32 v86, v86
  v_exp_f32 v87, v87
  s_setprio 0
  v_cvt_pk_bf16_f32 v88, v72, v73
  v_cvt_pk_bf16_f32 v89, v74, v75
  v_cvt_pk_bf16_f32 v90, v76, v77
  v_cvt_pk_bf16_f32 v91, v78, v79
  v_cvt_pk_bf16_f32 v92, v80, v81
  v_cvt_pk_bf16_f32 v93, v82, v83
  v_cvt_pk_bf16_f32 v94, v84, v85
  v_cvt_pk_bf16_f32 v95, v86, v87
  s_setprio 1
  v_mfma_f32_32x32x16_bf16 v[72:87], v[100:103], v[16:19], v[24:39]
  ds_read_b128 v[100:103], v124 offset:31744
  v_exp_f32 v56, v56
  v_exp_f32 v57, v57
  v_exp_f32 v58, v58
  v_exp_f32 v59, v59
  s_waitcnt lgkmcnt(1)
  v_mfma_f32_32x32x16_bf16 v[40:55], v[120:123], v[92:95], v[40:55]
  s_mov_b64 exec, s[20:21]
  ds_read_b128 v[108:111], v126 offset:28160
  ds_read_b128 v[112:115], v126 offset:28800
  s_mov_b64 exec, -1
  v_exp_f32 v60, v60
  v_exp_f32 v61, v61
  v_exp_f32 v62, v62
  v_exp_f32 v63, v63
  v_mfma_f32_32x32x8bf16_1k v[72:87], v[106:107], v[22:23], v[72:87]
  v_exp_f32 v64, v64
  v_exp_f32 v65, v65
  v_exp_f32 v66, v66
  v_exp_f32 v67, v67
  v_mfma_f32_32x32x16_bf16 v[40:55], v[116:119], v[88:91], v[40:55]
  v_exp_f32 v68, v68
  v_exp_f32 v69, v69
  v_exp_f32 v70, v70
  v_exp_f32 v71, v71
  s_setprio 0
  v_cvt_pk_bf16_f32 v88, v56, v57
  v_cvt_pk_bf16_f32 v89, v58, v59
  v_cvt_pk_bf16_f32 v90, v60, v61
  v_cvt_pk_bf16_f32 v91, v62, v63
  v_cvt_pk_bf16_f32 v92, v64, v65
  v_cvt_pk_bf16_f32 v93, v66, v67
  v_cvt_pk_bf16_f32 v94, v68, v69
  v_cvt_pk_bf16_f32 v95, v70, v71
  s_setprio 1
  v_mfma_f32_32x32x16_bf16 v[56:71], v[96:99], v[16:19], v[24:39]
  ds_read_b128 v[96:99], v124 offset:35840
  ds_read_b64 v[106:107], v125 offset:37888
  v_exp_f32 v72, v72
  v_exp_f32 v73, v73
  v_exp_f32 v74, v74
  v_exp_f32 v75, v75
  s_waitcnt lgkmcnt(2)
  v_mfma_f32_32x32x16_bf16 v[40:55], v[112:115], v[92:95], v[40:55]
  s_mov_b64 exec, s[20:21]
  ds_read_b128 v[116:119], v126 offset:29440
  ds_read_b128 v[120:123], v126 offset:30080
  s_mov_b64 exec, -1
  v_exp_f32 v76, v76
  v_exp_f32 v77, v77
  v_exp_f32 v78, v78
  v_exp_f32 v79, v79
  v_mfma_f32_32x32x8bf16_1k v[56:71], v[104:105], v[20:21], v[56:71]
  v_exp_f32 v80, v80
  v_exp_f32 v81, v81
  v_exp_f32 v82, v82
  v_exp_f32 v83, v83
  v_mfma_f32_32x32x16_bf16 v[40:55], v[108:111], v[88:91], v[40:55]
  v_exp_f32 v84, v84
  v_exp_f32 v85, v85
  v_exp_f32 v86, v86
  v_exp_f32 v87, v87
  s_setprio 0
  v_cvt_pk_bf16_f32 v88, v72, v73
  v_cvt_pk_bf16_f32 v89, v74, v75
  v_cvt_pk_bf16_f32 v90, v76, v77
  v_cvt_pk_bf16_f32 v91, v78, v79
  v_cvt_pk_bf16_f32 v92, v80, v81
  v_cvt_pk_bf16_f32 v93, v82, v83
  v_cvt_pk_bf16_f32 v94, v84, v85
  v_cvt_pk_bf16_f32 v95, v86, v87
  s_setprio 1
  v_mfma_f32_32x32x16_bf16 v[72:87], v[100:103], v[16:19], v[24:39]
  ds_read_b128 v[100:103], v124 offset:36864
  v_exp_f32 v56, v56
  v_exp_f32 v57, v57
  v_exp_f32 v58, v58
  v_exp_f32 v59, v59
  s_waitcnt lgkmcnt(1)
  v_mfma_f32_32x32x16_bf16 v[40:55], v[120:123], v[92:95], v[40:55]
  s_mov_b64 exec, s[20:21]
  ds_read_b128 v[108:111], v126 offset:33280
  ds_read_b128 v[112:115], v126 offset:33920
  s_mov_b64 exec, -1
  v_exp_f32 v60, v60
  v_exp_f32 v61, v61
  v_exp_f32 v62, v62
  v_exp_f32 v63, v63
  v_mfma_f32_32x32x8bf16_1k v[72:87], v[104:105], v[22:23], v[72:87]
  v_exp_f32 v64, v64
  v_exp_f32 v65, v65
  v_exp_f32 v66, v66
  v_exp_f32 v67, v67
  v_mfma_f32_32x32x16_bf16 v[40:55], v[116:119], v[88:91], v[40:55]
  v_exp_f32 v68, v68
  v_exp_f32 v69, v69
  v_exp_f32 v70, v70
  v_exp_f32 v71, v71
  s_setprio 0
  v_cvt_pk_bf16_f32 v88, v56, v57
  v_cvt_pk_bf16_f32 v89, v58, v59
  v_cvt_pk_bf16_f32 v90, v60, v61
  v_cvt_pk_bf16_f32 v91, v62, v63
  v_cvt_pk_bf16_f32 v92, v64, v65
  v_cvt_pk_bf16_f32 v93, v66, v67
  v_cvt_pk_bf16_f32 v94, v68, v69
  v_cvt_pk_bf16_f32 v95, v70, v71
  s_setprio 1
  v_mfma_f32_32x32x16_bf16 v[56:71], v[96:99], v[16:19], v[24:39]
  ds_read_b128 v[96:99], v124 offset:40960
  ds_read_b64 v[104:105], v125 offset:43008
  v_exp_f32 v72, v72
  v_exp_f32 v73, v73
  v_exp_f32 v74, v74
  v_exp_f32 v75, v75
  s_waitcnt lgkmcnt(2)
  v_mfma_f32_32x32x16_bf16 v[40:55], v[112:115], v[92:95], v[40:55]
  s_mov_b64 exec, s[20:21]
  ds_read_b128 v[116:119], v126 offset:34560
  ds_read_b128 v[120:123], v126 offset:35200
  s_mov_b64 exec, -1
  v_exp_f32 v76, v76
  v_exp_f32 v77, v77
  v_exp_f32 v78, v78
  v_exp_f32 v79, v79
  v_mfma_f32_32x32x8bf16_1k v[56:71], v[106:107], v[20:21], v[56:71]
  v_exp_f32 v80, v80
  v_exp_f32 v81, v81
  v_exp_f32 v82, v82
  v_exp_f32 v83, v83
  v_mfma_f32_32x32x16_bf16 v[40:55], v[108:111], v[88:91], v[40:55]
  v_exp_f32 v84, v84
  v_exp_f32 v85, v85
  v_exp_f32 v86, v86
  v_exp_f32 v87, v87
  s_setprio 0
  v_cvt_pk_bf16_f32 v88, v72, v73
  v_cvt_pk_bf16_f32 v89, v74, v75
  v_cvt_pk_bf16_f32 v90, v76, v77
  v_cvt_pk_bf16_f32 v91, v78, v79
  v_cvt_pk_bf16_f32 v92, v80, v81
  v_cvt_pk_bf16_f32 v93, v82, v83
  v_cvt_pk_bf16_f32 v94, v84, v85
  v_cvt_pk_bf16_f32 v95, v86, v87
  s_setprio 1
  v_mfma_f32_32x32x16_bf16 v[72:87], v[100:103], v[16:19], v[24:39]
  ds_read_b128 v[100:103], v124 offset:41984
  v_exp_f32 v56, v56
  v_exp_f32 v57, v57
  v_exp_f32 v58, v58
  v_exp_f32 v59, v59
  s_waitcnt lgkmcnt(1)
  v_mfma_f32_32x32x16_bf16 v[40:55], v[120:123], v[92:95], v[40:55]
  s_mov_b64 exec, s[20:21]
  ds_read_b128 v[108:111], v126 offset:38400
  ds_read_b128 v[112:115], v126 offset:39040
  s_mov_b64 exec, -1
  v_exp_f32 v60, v60
  v_exp_f32 v61, v61
  v_exp_f32 v62, v62
  v_exp_f32 v63, v63
  v_mfma_f32_32x32x8bf16_1k v[72:87], v[106:107], v[22:23], v[72:87]
  v_exp_f32 v64, v64
  v_exp_f32 v65, v65
  v_exp_f32 v66, v66
  v_exp_f32 v67, v67
  v_mfma_f32_32x32x16_bf16 v[40:55], v[116:119], v[88:91], v[40:55]
  v_exp_f32 v68, v68
  v_exp_f32 v69, v69
  v_exp_f32 v70, v70
  v_exp_f32 v71, v71
  s_setprio 0
  v_cvt_pk_bf16_f32 v88, v56, v57
  v_cvt_pk_bf16_f32 v89, v58, v59
  v_cvt_pk_bf16_f32 v90, v60, v61
  v_cvt_pk_bf16_f32 v91, v62, v63
  v_cvt_pk_bf16_f32 v92, v64, v65
  v_cvt_pk_bf16_f32 v93, v66, v67
  v_cvt_pk_bf16_f32 v94, v68, v69
  v_cvt_pk_bf16_f32 v95, v70, v71
  s_setprio 1
  v_mfma_f32_32x32x16_bf16 v[56:71], v[96:99], v[16:19], v[24:39]
  ds_read_b128 v[96:99], v124 offset:46080
  ds_read_b64 v[106:107], v125 offset:48128
  v_exp_f32 v72, v72
  v_exp_f32 v73, v73
  v_exp_f32 v74, v74
  v_exp_f32 v75, v75
  s_waitcnt lgkmcnt(2)
  v_mfma_f32_32x32x16_bf16 v[40:55], v[112:115], v[92:95], v[40:55]
  s_mov_b64 exec, s[20:21]
  ds_read_b128 v[116:119], v126 offset:39680
  ds_read_b128 v[120:123], v126 offset:40320
  s_mov_b64 exec, -1
  v_exp_f32 v76, v76
  v_exp_f32 v77, v77
  v_exp_f32 v78, v78
  v_exp_f32 v79, v79
  v_mfma_f32_32x32x8bf16_1k v[56:71], v[104:105], v[20:21], v[56:71]
  v_exp_f32 v80, v80
  v_exp_f32 v81, v81
  v_exp_f32 v82, v82
  v_exp_f32 v83, v83
  v_mfma_f32_32x32x16_bf16 v[40:55], v[108:111], v[88:91], v[40:55]
  v_exp_f32 v84, v84
  v_exp_f32 v85, v85
  v_exp_f32 v86, v86
  v_exp_f32 v87, v87
  s_setprio 0
  v_cvt_pk_bf16_f32 v88, v72, v73
  v_cvt_pk_bf16_f32 v89, v74, v75
  v_cvt_pk_bf16_f32 v90, v76, v77
  v_cvt_pk_bf16_f32 v91, v78, v79
  v_cvt_pk_bf16_f32 v92, v80, v81
  v_cvt_pk_bf16_f32 v93, v82, v83
  v_cvt_pk_bf16_f32 v94, v84, v85
  v_cvt_pk_bf16_f32 v95, v86, v87
s2_att_fin_7:
  s_waitcnt lgkmcnt(0)
  v_mfma_f32_32x32x16_bf16 v[40:55], v[116:119], v[88:91], v[40:55]
  v_mfma_f32_32x32x16_bf16 v[40:55], v[120:123], v[92:95], v[40:55]
  v_mov_b32 v5, 0x5d800000
  s_waitcnt vmcnt(0)
  s_nop 14
  v_mov_b32 v6, v48
  v_mov_b32 v7, v48
  s_nop 1
  v_permlane32_swap_b32 v6, v7
  s_nop 1
  v_cmp_nlt_f32 vcc, v7, v5
  v_rcp_f32 v7, v7
  s_cmp_eq_u32 s31, 0
  s_cselect_b64 s[34:35], vcc, 0
  s_cmp_lg_u64 s[34:35], 0
  s_cbranch_scc1 s2_att_fb_6
  v_mul_f32 v40, v40, v7
  v_mul_f32 v41, v41, v7
  v_mul_f32 v42, v42, v7
  v_mul_f32 v43, v43, v7
  v_mul_f32 v44, v44, v7
  v_mul_f32 v45, v45, v7
  v_mul_f32 v46, v46, v7
  v_mul_f32 v47, v47, v7
  v_mul_f32 v48, v48, v7
  v_mul_f32 v49, v49, v7
  v_mul_f32 v50, v50, v7
  v_mul_f32 v51, v51, v7
  v_cvt_pk_bf16_f32 v40, v40, v41
  v_cvt_pk_bf16_f32 v41, v42, v43
  v_cvt_pk_bf16_f32 v42, v44, v45
  v_cvt_pk_bf16_f32 v43, v46, v47
  v_cvt_pk_bf16_f32 v44, v48, v49
  v_cvt_pk_bf16_f32 v45, v50, v51
  buffer_store_dwordx4 v[40:43], v161, s[16:19], s33 offen
  s_mov_b64 exec, s[22:23]
  buffer_store_dwordx2 v[44:45], v162, s[16:19], s33 offen
s2_att_end_1:
  s_endpgm
.globl s3_wo_kernel
.p2align 8
.type s3_wo_kernel,@function
s3_wo_kernel:
  s_cmp_ge_u32 s2, 256
  s_cbranch_scc1 s3_wo_end_1
  s_load_dwordx2 s[8:9], s[0:1], 72
  s_load_dwordx2 s[4:5], s[0:1], 0
  v_lshrrev_b32 v1, 6, v0
  v_and_b32 v0, 63, v0
  v_readfirstlane_b32 s26, v1
  v_lshlrev_b32 v1, 4, v0
  s_and_b32 s10, s2, 7
  s_lshr_b32 s11, s2, 3
  s_and_b32 s3, s10, 1
  s_lshl_b32 s24, s3, 4
  s_lshr_b32 s3, s10, 1
  s_lshl_b32 s3, s3, 2
  s_add_u32 s24, s24, s3
  s_and_b32 s3, s11, 3
  s_add_u32 s24, s24, s3
  s_lshl_b32 s24, s24, 2
  s_lshr_b32 s25, s11, 2
  s_cmp_lt_u32 s26, 4
  s_cbranch_scc1 s3_wo_c_2
  s_mul_i32 s28, s25, 102400
  s_add_u32 s28, s28, 0x1340000
  s_mul_i32 s30, s24, 20480
  s_add_u32 s30, s30, 0x780000
  s_mov_b32 s57, s30
  s_cmp_eq_u32 s26, 5
  s_cbranch_scc1 s3_wo_sb_3
  v_add_u32 v8, 0, v1
  v_add_u32 v9, 0, v1
  v_add_u32 v10, 0, v1
  v_add_u32 v11, 0, v1
  v_add_u32 v12, 4096, v1
  v_add_u32 v13, 4096, v1
  v_add_u32 v14, 4096, v1
  v_add_u32 v15, 4096, v1
  v_add_u32 v16, 8192, v1
  s_mov_b32 s30, s28
  s_mov_b32 s27, 10240
  s_mov_b32 s29, 0
  s_branch s3_wo_sj_4
s3_wo_sb_3:
  v_add_u32 v8, 0, v1
  v_add_u32 v9, 0, v1
  v_add_u32 v10, 18432, v1
  v_add_u32 v11, 18432, v1
  v_add_u32 v12, 40960, v1
  v_add_u32 v13, 40960, v1
  v_add_u32 v14, 59392, v1
  v_add_u32 v15, 59392, v1
  v_add_u32 v16, 9216, v1
  s_mov_b32 s27, 2048
  s_mov_b32 s29, 9216
s3_wo_sj_4:
  s_waitcnt lgkmcnt(0)
  s_mov_b32 s12, s8
  s_and_b32 s13, s9, 0xffff
  s_mov_b32 s14, 0x1b00000
  s_mov_b32 s15, 0x00020000
  s_add_u32 m0, s29, 0
  s_nop 0
  buffer_load_dwordx4 v8, s[12:15], s30 offen offset:0 lds
  buffer_load_dwordx4 v9, s[12:15], s30 offen offset:1024 lds
  buffer_load_dwordx4 v10, s[12:15], s30 offen offset:2048 lds
  buffer_load_dwordx4 v11, s[12:15], s30 offen offset:3072 lds
  s_add_u32 m0, s29, 4096
  s_nop 0
  buffer_load_dwordx4 v12, s[12:15], s30 offen offset:0 lds
  buffer_load_dwordx4 v13, s[12:15], s30 offen offset:1024 lds
  buffer_load_dwordx4 v14, s[12:15], s30 offen offset:2048 lds
  buffer_load_dwordx4 v15, s[12:15], s30 offen offset:3072 lds
  s_add_u32 m0, s29, 8192
  s_nop 0
  buffer_load_dwordx4 v16, s[12:15], s28 offen offset:0 lds
  s_mov_b32 s3, s25
  s_add_u32 s56, s3, 2
  s_lshl_b32 s3, s26, 1
  v_lshrrev_b32 v46, 4, v0
  v_add_u32 v46, s3, v46
  v_and_b32 v46, 3, v46
  v_and_b32 v47, 15, v0
  v_mul_u32_u24 v46, 20480, v46
  v_lshl_add_u32 v46, v47, 7, v46
  s_add_u32 s3, s56, 0
  s_min_u32 s3, s3, 9
  s_mul_i32 s3, s3, 2048
  s_add_u32 s3, s3, s57
  s_mov_b32 exec_hi, 0
  buffer_load_dword v47, v46, s[12:15], s3 offen
  s_mov_b64 exec, -1
  s_add_u32 m0, s29, 18432
  s_add_u32 s30, s30, s27
  s_add_u32 s28, s28, 10240
  buffer_load_dwordx4 v8, s[12:15], s30 offen offset:0 lds
  buffer_load_dwordx4 v9, s[12:15], s30 offen offset:1024 lds
  buffer_load_dwordx4 v10, s[12:15], s30 offen offset:2048 lds
  buffer_load_dwordx4 v11, s[12:15], s30 offen offset:3072 lds
  s_add_u32 m0, s29, 22528
  s_nop 0
  buffer_load_dwordx4 v12, s[12:15], s30 offen offset:0 lds
  buffer_load_dwordx4 v13, s[12:15], s30 offen offset:1024 lds
  buffer_load_dwordx4 v14, s[12:15], s30 offen offset:2048 lds
  buffer_load_dwordx4 v15, s[12:15], s30 offen offset:3072 lds
  s_add_u32 m0, s29, 26624
  s_nop 0
  buffer_load_dwordx4 v16, s[12:15], s28 offen offset:0 lds
  s_add_u32 m0, s29, 36864
  s_add_u32 s30, s30, s27
  s_add_u32 s28, s28, 10240
  buffer_load_dwordx4 v8, s[12:15], s30 offen offset:0 lds
  buffer_load_dwordx4 v9, s[12:15], s30 offen offset:1024 lds
  buffer_load_dwordx4 v10, s[12:15], s30 offen offset:2048 lds
  buffer_load_dwordx4 v11, s[12:15], s30 offen offset:3072 lds
  s_add_u32 m0, s29, 40960
  s_nop 0
  buffer_load_dwordx4 v12, s[12:15], s30 offen offset:0 lds
  buffer_load_dwordx4 v13, s[12:15], s30 offen offset:1024 lds
  buffer_load_dwordx4 v14, s[12:15], s30 offen offset:2048 lds
  buffer_load_dwordx4 v15, s[12:15], s30 offen offset:3072 lds
  s_add_u32 m0, s29, 45056
  s_nop 0
  buffer_load_dwordx4 v16, s[12:15], s28 offen offset:0 lds
  s_mov_b32 s16, s4
  s_and_b32 s17, s5, 0xffff
  s_mov_b32 s18, 0x280000
  s_mov_b32 s19, 0x00020000
  s_lshl_b32 s3, s24, 4
  s_mul_i32 s31, s3, 1280
  s_mul_i32 s3, s25, 160
  s_add_u32 s31, s31, s3
  s_sub_u32 s39, s26, 4
  s_mul_i32 s3, s39, 320
  s_mul_i32 s38, s39, 5120
  v_add_u32 v43, s3, v0
  v_add_u32 v40, 0, v43
  v_mul_u32_u24 v41, 6554, v40
  v_lshrrev_b32 v41, 16, v41
  v_mul_u32_u24 v42, 10, v41
  v_sub_u32 v40, v40, v42
  v_mul_u32_u24 v41, 1280, v41
  v_lshl_add_u32 v17, v40, 4, v41
  v_add_u32 v40, 64, v43
  v_mul_u32_u24 v41, 6554, v40
  v_lshrrev_b32 v41, 16, v41
  v_mul_u32_u24 v42, 10, v41
  v_sub_u32 v40, v40, v42
  v_mul_u32_u24 v41, 1280, v41
  v_lshl_add_u32 v18, v40, 4, v41
  v_add_u32 v40, 128, v43
  v_mul_u32_u24 v41, 6554, v40
  v_lshrrev_b32 v41, 16, v41
  v_mul_u32_u24 v42, 10, v41
  v_sub_u32 v40, v40, v42
  v_mul_u32_u24 v41, 1280, v41
  v_lshl_add_u32 v19, v40, 4, v41
  v_add_u32 v40, 192, v43
  v_mul_u32_u24 v41, 6554, v40
  v_lshrrev_b32 v41, 16, v41
  v_mul_u32_u24 v42, 10, v41
  v_sub_u32 v40, v40, v42
  v_mul_u32_u24 v41, 1280, v41
  v_lshl_add_u32 v20, v40, 4, v41
  v_add_u32 v40, 256, v43
  v_mul_u32_u24 v41, 6554, v40
  v_lshrrev_b32 v41, 16, v41
  v_mul_u32_u24 v42, 10, v41
  v_sub_u32 v40, v40, v42
  v_mul_u32_u24 v41, 1280, v41
  v_lshl_add_u32 v21, v40, 4, v41
  s_waitcnt vmcnt(19)
  s_barrier
  s_add_u32 m0, s29, 55296
  s_add_u32 s30, s30, s27
  s_add_u32 s28, s28, 10240
  buffer_load_dwordx4 v8, s[12:15], s30 offen offset:0 lds
  buffer_load_dwordx4 v9, s[12:15], s30 offen offset:1024 lds
  buffer_load_dwordx4 v10, s[12:15], s30 offen offset:2048 lds
  buffer_load_dwordx4 v11, s[12:15], s30 offen offset:3072 lds
  s_add_u32 m0, s29, 59392
  s_nop 0
  buffer_load_dwordx4 v12, s[12:15], s30 offen offset:0 lds
  buffer_load_dwordx4 v13, s[12:15], s30 offen offset:1024 lds
  buffer_load_dwordx4 v14, s[12:15], s30 offen offset:2048 lds
  buffer_load_dwordx4 v15, s[12:15], s30 offen offset:3072 lds
  s_add_u32 m0, s29, 63488
  s_nop 0
  buffer_load_dwordx4 v16, s[12:15], s28 offen offset:0 lds
  s_waitcnt vmcnt(18)
  s_barrier
  s_add_u32 m0, s29, 73728
  s_add_u32 s30, s30, s27
  s_add_u32 s28, s28, 10240
  buffer_load_dwordx4 v8, s[12:15], s30 offen offset:0 lds
  buffer_load_dwordx4 v9, s[12:15], s30 offen offset:1024 lds
  buffer_load_dwordx4 v10, s[12:15], s30 offen offset:2048 lds
  buffer_load_dwordx4 v11, s[12:15], s30 offen offset:3072 lds
  s_add_u32 m0, s29, 77824
  s_nop 0
  buffer_load_dwordx4 v12, s[12:15], s30 offen offset:0 lds
  buffer_load_dwordx4 v13, s[12:15], s30 offen offset:1024 lds
  buffer_load_dwordx4 v14, s[12:15], s30 offen offset:2048 lds
  buffer_load_dwordx4 v15, s[12:15], s30 offen offset:3072 lds
  s_add_u32 m0, s29, 81920
  s_nop 0
  buffer_load_dwordx4 v16, s[12:15], s28 offen offset:0 lds
  s_add_u32 m0, s29, 92160
  s_add_u32 s30, s30, s27
  s_add_u32 s28, s28, 10240
  buffer_load_dwordx4 v8, s[12:15], s30 offen offset:0 lds
  buffer_load_dwordx4 v9, s[12:15], s30 offen offset:1024 lds
  buffer_load_dwordx4 v10, s[12:15], s30 offen offset:2048 lds
  buffer_load_dwordx4 v11, s[12:15], s30 offen offset:3072 lds
  s_add_u32 m0, s29, 96256
  s_nop 0
  buffer_load_dwordx4 v12, s[12:15], s30 offen offset:0 lds
  buffer_load_dwordx4 v13, s[12:15], s30 offen offset:1024 lds
  buffer_load_dwordx4 v14, s[12:15], s30 offen offset:2048 lds
  buffer_load_dwordx4 v15, s[12:15], s30 offen offset:3072 lds
  s_add_u32 m0, s29, 100352
  s_nop 0
  buffer_load_dwordx4 v16, s[12:15], s28 offen offset:0 lds
  s_waitcnt vmcnt(27)
  s_barrier
  s_add_u32 m0, s29, 110592
  s_add_u32 s30, s30, s27
  s_add_u32 s28, s28, 10240
  buffer_load_dwordx4 v8, s[12:15], s30 offen offset:0 lds
  buffer_load_dwordx4 v9, s[12:15], s30 offen offset:1024 lds
  buffer_load_dwordx4 v10, s[12:15], s30 offen offset:2048 lds
  buffer_load_dwordx4 v11, s[12:15], s30 offen offset:3072 lds
  s_add_u32 m0, s29, 114688
  s_nop 0
  buffer_load_dwordx4 v12, s[12:15], s30 offen offset:0 lds
  buffer_load_dwordx4 v13, s[12:15], s30 offen offset:1024 lds
  buffer_load_dwordx4 v14, s[12:15], s30 offen offset:2048 lds
  buffer_load_dwordx4 v15, s[12:15], s30 offen offset:3072 lds
  s_add_u32 m0, s29, 118784
  s_nop 0
  buffer_load_dwordx4 v16, s[12:15], s28 offen offset:0 lds
  s_waitcnt vmcnt(27)
  s_barrier
  s_add_u32 m0, s29, 129024
  s_add_u32 s30, s30, s27
  s_add_u32 s28, s28, 10240
  buffer_load_dwordx4 v8, s[12:15], s30 offen offset:0 lds
  buffer_load_dwordx4 v9, s[12:15], s30 offen offset:1024 lds
  buffer_load_dwordx4 v10, s[12:15], s30 offen offset:2048 lds
  buffer_load_dwordx4 v11, s[12:15], s30 offen offset:3072 lds
  s_add_u32 m0, s29, 133120
  s_nop 0
  buffer_load_dwordx4 v12, s[12:15], s30 offen offset:0 lds
  buffer_load_dwordx4 v13, s[12:15], s30 offen offset:1024 lds
  buffer_load_dwordx4 v14, s[12:15], s30 offen offset:2048 lds
  buffer_load_dwordx4 v15, s[12:15], s30 offen offset:3072 lds
  s_add_u32 m0, s29, 137216
  s_nop 0
  buffer_load_dwordx4 v16, s[12:15], s28 offen offset:0 lds
  s_add_u32 m0, s38, 147456
  s_nop 0
  buffer_load_dwordx4 v17, s[16:19], s31 offen offset:0 lds
  s_add_u32 m0, s38, 148480
  s_nop 0
  buffer_load_dwordx4 v18, s[16:19], s31 offen offset:0 lds
  s_add_u32 m0, s38, 149504
  s_nop 0
  buffer_load_dwordx4 v19, s[16:19], s31 offen offset:0 lds
  s_add_u32 m0, s38, 150528
  s_nop 0
  buffer_load_dwordx4 v20, s[16:19], s31 offen offset:0 lds
  s_add_u32 m0, s38, 151552
  s_nop 0
  buffer_load_dwordx4 v21, s[16:19], s31 offen offset:0 lds
  s_waitcnt vmcnt(32)
  s_barrier
  s_add_u32 m0, s29, 0
  s_add_u32 s30, s30, s27
  s_add_u32 s28, s28, 10240
  buffer_load_dwordx4 v8, s[12:15], s30 offen offset:0 lds
  buffer_load_dwordx4 v9, s[12:15], s30 offen offset:1024 lds
  buffer_load_dwordx4 v10, s[12:15], s30 offen offset:2048 lds
  buffer_load_dwordx4 v11, s[12:15], s30 offen offset:3072 lds
  s_add_u32 m0, s29, 4096
  s_nop 0
  buffer_load_dwordx4 v12, s[12:15], s30 offen offset:0 lds
  buffer_load_dwordx4 v13, s[12:15], s30 offen offset:1024 lds
  buffer_load_dwordx4 v14, s[12:15], s30 offen offset:2048 lds
  buffer_load_dwordx4 v15, s[12:15], s30 offen offset:3072 lds
  s_add_u32 m0, s29, 8192
  s_nop 0
  buffer_load_dwordx4 v16, s[12:15], s28 offen offset:0 lds
  s_waitcnt vmcnt(32)
  s_barrier
  s_add_u32 m0, s29, 18432
  s_add_u32 s30, s30, s27
  s_add_u32 s28, s28, 10240
  buffer_load_dwordx4 v8, s[12:15], s30 offen offset:0 lds
  buffer_load_dwordx4 v9, s[12:15], s30 offen offset:1024 lds
  buffer_load_dwordx4 v10, s[12:15], s30 offen offset:2048 lds
  buffer_load_dwordx4 v11, s[12:15], s30 offen offset:3072 lds
  s_add_u32 m0, s29, 22528
  s_nop 0
  buffer_load_dwordx4 v12, s[12:15], s30 offen offset:0 lds
  buffer_load_dwordx4 v13, s[12:15], s30 offen offset:1024 lds
  buffer_load_dwordx4 v14, s[12:15], s30 offen offset:2048 lds
  buffer_load_dwordx4 v15, s[12:15], s30 offen offset:3072 lds
  s_add_u32 m0, s29, 26624
  s_nop 0
  buffer_load_dwordx4 v16, s[12:15], s28 offen offset:0 lds
  s_cmp_eq_u32 s26, 5
  s_cbranch_scc1 s3_wo_tb_5
  s_lshl_b32 s3, s11, 1
  s_add_u32 s3, s3, s26
  s_add_u32 s3, s3, -4
  s_lshl_b32 s3, s3, 6
  v_add_u32 v40, s3, v0
  v_lshrrev_b32 v41, 4, v40
  v_mul_u32_u24 v41, 9363, v41
  v_lshrrev_b32 v41, 16, v41
  v_mul_u32_u24 v42, 112, v41
  v_sub_u32 v40, v40, v42
  v_and_b32 v42, 3, v41
  v_lshrrev_b32 v41, 2, v41
  v_mul_u32_u24 v42, 2240, v42
  v_mul_u32_u24 v41, 112, v41
  v_add3_u32 v40, v40, v41, v42
  v_lshlrev_b32 v40, 7, v40
  s_lshr_b32 s3, s10, 1
  s_mul_i32 s3, s3, 1146880
  s_add_u32 s3, s3, 0x1410000
  buffer_load_dword v44, v40, s[12:15], s3 offen
  s_waitcnt vmcnt(33)
  s_barrier
  s_waitcnt vmcnt(24)
  s_barrier
  s_waitcnt vmcnt(10)
  s_barrier
  s_waitcnt vmcnt(1)
  s_barrier
  s_waitcnt vmcnt(0)
  s_endpgm
s3_wo_tb_5:
  s_lshl_b32 s3, s11, 1
  s_add_u32 s3, s3, s26
  s_add_u32 s3, s3, -4
  s_lshl_b32 s3, s3, 6
  v_add_u32 v40, s3, v0
  v_lshrrev_b32 v41, 4, v40
  v_mul_u32_u24 v41, 9363, v41
  v_lshrrev_b32 v41, 16, v41
  v_mul_u32_u24 v42, 112, v41
  v_sub_u32 v40, v40, v42
  v_and_b32 v42, 3, v41
  v_lshrrev_b32 v41, 2, v41
  v_mul_u32_u24 v42, 2240, v42
  v_mul_u32_u24 v41, 112, v41
  v_add3_u32 v40, v40, v41, v42
  v_lshlrev_b32 v40, 7, v40
  s_lshr_b32 s3, s10, 1
  s_mul_i32 s3, s3, 1146880
  s_add_u32 s3, s3, 0x1410000
  buffer_load_dword v44, v40, s[12:15], s3 offen
  s_waitcnt vmcnt(33)
  s_barrier
  s_waitcnt vmcnt(24)
  s_barrier
  s_waitcnt vmcnt(10)
  s_barrier
  s_waitcnt vmcnt(1)
  s_barrier
  s_waitcnt vmcnt(0)
  s_endpgm
s3_wo_c_2:
  v_and_b32 v2, 15, v0
  v_lshrrev_b32 v3, 4, v0
  v_mov_b32 v4, v1
  v_add_u32 v5, 0x10000, v1
  v_add_u32 v6, 0x20000, v1
  s_mul_i32 s3, s26, 2048
  v_add_u32 v7, s3, v4
  v_add_u32 v8, s3, v5
  v_add_u32 v9, s3, v6
  s_add_u32 s24, s24, s26
  v_mov_b32 v28, 0x3f803f80
  s_mul_i32 s3, s26, 2560
  s_add_u32 s3, s3, 147456
  v_mul_u32_u24 v20, 160, v2
  v_lshl_add_u32 v20, v3, 3, v20
  v_add_u32 v20, s3, v20
  s_mul_i32 s40, s24, 20480
  s_add_u32 s40, s40, 0xa00000
  s_lshl_b32 s44, s25, 11
  s_add_u32 s44, s44, s40
  s_lshl_b32 s45, s25, 9
  s_add_u32 s45, s45, s40
  s_add_u32 s45, s45, 16384
  v_lshrrev_b32 v11, 1, v3
  v_lshlrev_b32 v11, 8, v11
  v_lshl_add_u32 v11, v2, 4, v11
  s_lshl_b32 s3, s24, 10
  s_lshl_b32 s43, s25, 3
  s_add_u32 s43, s43, s3
  s_add_u32 s43, s43, 0x1a90000
  v_lshlrev_b32 v21, 6, v2
  v_mov_b32 v24, 0
  v_mov_b32 v25, 0
  s_waitcnt lgkmcnt(0)
  s_mov_b32 s12, s8
  s_and_b32 s13, s9, 0xffff
  s_mov_b32 s14, 0x1b00000
  s_mov_b32 s15, 0x00020000
  s_barrier
  ds_read_b128 v[84:87], v7 offset:9216
  ds_read_b128 v[52:55], v4 offset:0
  ds_read_b128 v[56:59], v4 offset:1024
  ds_read_b128 v[60:63], v4 offset:2048
  ds_read_b128 v[64:67], v4 offset:3072
  ds_read_b128 v[68:71], v4 offset:4096
  ds_read_b128 v[88:91], v7 offset:10240
  s_waitcnt lgkmcnt(5)
  v_mfma_f32_16x16x32_bf16 v[32:35], v[52:55], v[84:87], 0
  ds_read_b128 v[72:75], v4 offset:5120
  s_waitcnt lgkmcnt(5)
  v_mfma_f32_16x16x32_bf16 v[36:39], v[56:59], v[84:87], 0
  ds_read_b128 v[76:79], v4 offset:6144
  s_waitcnt lgkmcnt(5)
  v_mfma_f32_16x16x32_bf16 v[40:43], v[60:63], v[84:87], 0
  ds_read_b128 v[80:83], v4 offset:7168
  s_waitcnt lgkmcnt(5)
  v_mfma_f32_16x16x32_bf16 v[44:47], v[64:67], v[84:87], 0
  ds_read_b128 v[52:55], v4 offset:8192
  s_waitcnt lgkmcnt(5)
  v_mfma_f32_16x16x32_bf16 v[48:51], v[68:71], v[84:87], 0
  ds_read_b128 v[56:59], v4 offset:17408
  s_barrier
  ds_read_b128 v[92:95], v7 offset:27648
  s_waitcnt lgkmcnt(5)
  v_mfma_f32_16x16x32_bf16 v[32:35], v[72:75], v[88:91], v[32:35]
  ds_read_b128 v[60:63], v4 offset:18432
  s_waitcnt lgkmcnt(5)
  v_mfma_f32_16x16x32_bf16 v[36:39], v[76:79], v[88:91], v[36:39]
  ds_read_b128 v[64:67], v4 offset:19456
  s_waitcnt lgkmcnt(5)
  v_mfma_f32_16x16x32_bf16 v[40:43], v[80:83], v[88:91], v[40:43]
  ds_read_b128 v[68:71], v4 offset:20480
  s_waitcnt lgkmcnt(5)
  v_mfma_f32_16x16x32_bf16 v[44:47], v[52:55], v[88:91], v[44:47]
  ds_read_b128 v[72:75], v4 offset:21504
  s_waitcnt lgkmcnt(5)
  v_mfma_f32_16x16x32_bf16 v[48:51], v[56:59], v[88:91], v[48:51]
  ds_read_b128 v[76:79], v4 offset:22528
  ds_read_b128 v[96:99], v7 offset:28672
  s_waitcnt lgkmcnt(5)
  v_mfma_f32_16x16x32_bf16 v[32:35], v[60:63], v[92:95], v[32:35]
  ds_read_b128 v[80:83], v4 offset:23552
  s_waitcnt lgkmcnt(5)
  v_mfma_f32_16x16x32_bf16 v[36:39], v[64:67], v[92:95], v[36:39]
  ds_read_b128 v[52:55], v4 offset:24576
  s_waitcnt lgkmcnt(5)
  v_mfma_f32_16x16x32_bf16 v[40:43], v[68:71], v[92:95], v[40:43]
  ds_read_b128 v[56:59], v4 offset:25600
  s_waitcnt lgkmcnt(5)
  v_mfma_f32_16x16x32_bf16 v[44:47], v[72:75], v[92:95], v[44:47]
  ds_read_b128 v[60:63], v4 offset:26624
  s_waitcnt lgkmcnt(5)
  v_mfma_f32_16x16x32_bf16 v[48:51], v[76:79], v[92:95], v[48:51]
  ds_read_b128 v[64:67], v4 offset:35840
  s_barrier
  ds_read_b128 v[84:87], v7 offset:46080
  s_waitcnt lgkmcnt(5)
  v_mfma_f32_16x16x32_bf16 v[32:35], v[80:83], v[96:99], v[32:35]
  ds_read_b128 v[68:71], v4 offset:36864
  s_waitcnt lgkmcnt(5)
  v_mfma_f32_16x16x32_bf16 v[36:39], v[52:55], v[96:99], v[36:39]
  ds_read_b128 v[72:75], v4 offset:37888
  s_waitcnt lgkmcnt(5)
  v_mfma_f32_16x16x32_bf16 v[40:43], v[56:59], v[96:99], v[40:43]
  ds_read_b128 v[76:79], v4 offset:38912
  s_waitcnt lgkmcnt(5)
  v_mfma_f32_16x16x32_bf16 v[44:47], v[60:63], v[96:99], v[44:47]
  ds_read_b128 v[80:83], v4 offset:39936
  s_waitcnt lgkmcnt(5)
  v_mfma_f32_16x16x32_bf16 v[48:51], v[64:67], v[96:99], v[48:51]
  ds_read_b128 v[52:55], v4 offset:40960
  ds_read_b128 v[88:91], v7 offset:47104
  s_waitcnt lgkmcnt(5)
  v_mfma_f32_16x16x32_bf16 v[32:35], v[68:71], v[84:87], v[32:35]
  ds_read_b128 v[56:59], v4 offset:41984
  s_waitcnt lgkmcnt(5)
  v_mfma_f32_16x16x32_bf16 v[36:39], v[72:75], v[84:87], v[36:39]
  ds_read_b128 v[60:63], v4 offset:43008
  s_waitcnt lgkmcnt(5)
  v_mfma_f32_16x16x32_bf16 v[40:43], v[76:79], v[84:87], v[40:43]
  ds_read_b128 v[64:67], v4 offset:44032
  s_waitcnt lgkmcnt(5)
  v_mfma_f32_16x16x32_bf16 v[44:47], v[80:83], v[84:87], v[44:47]
  ds_read_b128 v[68:71], v4 offset:45056
  s_waitcnt lgkmcnt(5)
  v_mfma_f32_16x16x32_bf16 v[48:51], v[52:55], v[84:87], v[48:51]
  ds_read_b128 v[72:75], v4 offset:54272
  s_barrier
  ds_read_b128 v[92:95], v7 offset:64512
  s_waitcnt lgkmcnt(5)
  v_mfma_f32_16x16x32_bf16 v[32:35], v[56:59], v[88:91], v[32:35]
  ds_read_b128 v[76:79], v4 offset:55296
  s_waitcnt lgkmcnt(5)
  v_mfma_f32_16x16x32_bf16 v[36:39], v[60:63], v[88:91], v[36:39]
  ds_read_b128 v[80:83], v4 offset:56320
  s_waitcnt lgkmcnt(5)
  v_mfma_f32_16x16x32_bf16 v[40:43], v[64:67], v[88:91], v[40:43]
  ds_read_b128 v[52:55], v4 offset:57344
  s_waitcnt lgkmcnt(5)
  v_mfma_f32_16x16x32_bf16 v[44:47], v[68:71], v[88:91], v[44:47]
  ds_read_b128 v[56:59], v4 offset:58368
  s_waitcnt lgkmcnt(5)
  v_mfma_f32_16x16x32_bf16 v[48:51], v[72:75], v[88:91], v[48:51]
  ds_read_b128 v[60:63], v4 offset:59392
  ds_read_b128 v[96:99], v8 offset:0
  s_waitcnt lgkmcnt(5)
  v_mfma_f32_16x16x32_bf16 v[32:35], v[76:79], v[92:95], v[32:35]
  ds_read_b128 v[64:67], v4 offset:60416
  s_waitcnt lgkmcnt(5)
  v_mfma_f32_16x16x32_bf16 v[36:39], v[80:83], v[92:95], v[36:39]
  ds_read_b128 v[68:71], v4 offset:61440
  s_waitcnt lgkmcnt(5)
  v_mfma_f32_16x16x32_bf16 v[40:43], v[52:55], v[92:95], v[40:43]
  ds_read_b128 v[72:75], v4 offset:62464
  s_waitcnt lgkmcnt(5)
  v_mfma_f32_16x16x32_bf16 v[44:47], v[56:59], v[92:95], v[44:47]
  ds_read_b128 v[76:79], v4 offset:63488
  s_waitcnt lgkmcnt(5)
  v_mfma_f32_16x16x32_bf16 v[48:51], v[60:63], v[92:95], v[48:51]
  ds_read_b128 v[80:83], v5 offset:7168
  s_barrier
  ds_read_b128 v[84:87], v8 offset:17408
  s_waitcnt lgkmcnt(5)
  v_mfma_f32_16x16x32_bf16 v[32:35], v[64:67], v[96:99], v[32:35]
  ds_read_b128 v[52:55], v5 offset:8192
  s_waitcnt lgkmcnt(5)
  v_mfma_f32_16x16x32_bf16 v[36:39], v[68:71], v[96:99], v[36:39]
  ds_read_b128 v[56:59], v5 offset:9216
  s_waitcnt lgkmcnt(5)
  v_mfma_f32_16x16x32_bf16 v[40:43], v[72:75], v[96:99], v[40:43]
  ds_read_b128 v[60:63], v5 offset:10240
  s_waitcnt lgkmcnt(5)
  v_mfma_f32_16x16x32_bf16 v[44:47], v[76:79], v[96:99], v[44:47]
  ds_read_b128 v[64:67], v5 offset:11264
  s_waitcnt lgkmcnt(5)
  v_mfma_f32_16x16x32_bf16 v[48:51], v[80:83], v[96:99], v[48:51]
  ds_read_b128 v[68:71], v5 offset:12288
  ds_read_b128 v[88:91], v8 offset:18432
  s_waitcnt lgkmcnt(5)
  v_mfma_f32_16x16x32_bf16 v[32:35], v[52:55], v[84:87], v[32:35]
  ds_read_b128 v[72:75], v5 offset:13312
  s_waitcnt lgkmcnt(5)
  v_mfma_f32_16x16x32_bf16 v[36:39], v[56:59], v[84:87], v[36:39]
  ds_read_b128 v[76:79], v5 offset:14336
  s_waitcnt lgkmcnt(5)
  v_mfma_f32_16x16x32_bf16 v[40:43], v[60:63], v[84:87], v[40:43]
  ds_read_b128 v[80:83], v5 offset:15360
  s_waitcnt lgkmcnt(5)
  v_mfma_f32_16x16x32_bf16 v[44:47], v[64:67], v[84:87], v[44:47]
  ds_read_b128 v[52:55], v5 offset:16384
  s_waitcnt lgkmcnt(5)
  v_mfma_f32_16x16x32_bf16 v[48:51], v[68:71], v[84:87], v[48:51]
  ds_read_b128 v[56:59], v5 offset:25600
  s_barrier
  ds_read_b128 v[92:95], v8 offset:35840
  s_waitcnt lgkmcnt(5)
  v_mfma_f32_16x16x32_bf16 v[32:35], v[72:75], v[88:91], v[32:35]
  ds_read_b128 v[60:63], v5 offset:26624
  s_waitcnt lgkmcnt(5)
  v_mfma_f32_16x16x32_bf16 v[36:39], v[76:79], v[88:91], v[36:39]
  ds_read_b128 v[64:67], v5 offset:27648
  s_waitcnt lgkmcnt(5)
  v_mfma_f32_16x16x32_bf16 v[40:43], v[80:83], v[88:91], v[40:43]
  ds_read_b128 v[68:71], v5 offset:28672
  s_waitcnt lgkmcnt(5)
  v_mfma_f32_16x16x32_bf16 v[44:47], v[52:55], v[88:91], v[44:47]
  ds_read_b128 v[72:75], v5 offset:29696
  s_waitcnt lgkmcnt(5)
  v_mfma_f32_16x16x32_bf16 v[48:51], v[56:59], v[88:91], v[48:51]
  ds_read_b128 v[76:79], v5 offset:30720
  ds_read_b128 v[96:99], v8 offset:36864
  s_waitcnt lgkmcnt(5)
  v_mfma_f32_16x16x32_bf16 v[32:35], v[60:63], v[92:95], v[32:35]
  ds_read_b128 v[80:83], v5 offset:31744
  s_waitcnt lgkmcnt(5)
  v_mfma_f32_16x16x32_bf16 v[36:39], v[64:67], v[92:95], v[36:39]
  ds_read_b128 v[52:55], v5 offset:32768
  s_waitcnt lgkmcnt(5)
  v_mfma_f32_16x16x32_bf16 v[40:43], v[68:71], v[92:95], v[40:43]
  ds_read_b128 v[56:59], v5 offset:33792
  s_waitcnt lgkmcnt(5)
  v_mfma_f32_16x16x32_bf16 v[44:47], v[72:75], v[92:95], v[44:47]
  ds_read_b128 v[60:63], v5 offset:34816
  s_waitcnt lgkmcnt(5)
  v_mfma_f32_16x16x32_bf16 v[48:51], v[76:79], v[92:95], v[48:51]
  ds_read_b128 v[64:67], v5 offset:44032
  s_barrier
  ds_read_b128 v[84:87], v8 offset:54272
  s_waitcnt lgkmcnt(5)
  v_mfma_f32_16x16x32_bf16 v[32:35], v[80:83], v[96:99], v[32:35]
  ds_read_b128 v[68:71], v5 offset:45056
  s_waitcnt lgkmcnt(5)
  v_mfma_f32_16x16x32_bf16 v[36:39], v[52:55], v[96:99], v[36:39]
  ds_read_b128 v[72:75], v5 offset:46080
  s_waitcnt lgkmcnt(5)
  v_mfma_f32_16x16x32_bf16 v[40:43], v[56:59], v[96:99], v[40:43]
  ds_read_b128 v[76:79], v5 offset:47104
  s_waitcnt lgkmcnt(5)
  v_mfma_f32_16x16x32_bf16 v[44:47], v[60:63], v[96:99], v[44:47]
  ds_read_b128 v[80:83], v5 offset:48128
  s_waitcnt lgkmcnt(5)
  v_mfma_f32_16x16x32_bf16 v[48:51], v[64:67], v[96:99], v[48:51]
  ds_read_b128 v[52:55], v5 offset:49152
  ds_read_b128 v[88:91], v8 offset:55296
  s_waitcnt lgkmcnt(5)
  v_mfma_f32_16x16x32_bf16 v[32:35], v[68:71], v[84:87], v[32:35]
  ds_read_b128 v[56:59], v5 offset:50176
  s_waitcnt lgkmcnt(5)
  v_mfma_f32_16x16x32_bf16 v[36:39], v[72:75], v[84:87], v[36:39]
  ds_read_b128 v[60:63], v5 offset:51200
  s_waitcnt lgkmcnt(5)
  v_mfma_f32_16x16x32_bf16 v[40:43], v[76:79], v[84:87], v[40:43]
  ds_read_b128 v[64:67], v5 offset:52224
  s_waitcnt lgkmcnt(5)
  v_mfma_f32_16x16x32_bf16 v[44:47], v[80:83], v[84:87], v[44:47]
  ds_read_b128 v[68:71], v5 offset:53248
  s_waitcnt lgkmcnt(5)
  v_mfma_f32_16x16x32_bf16 v[48:51], v[52:55], v[84:87], v[48:51]
  ds_read_b128 v[72:75], v5 offset:62464
  s_barrier
  ds_read_b128 v[92:95], v9 offset:7168
  s_waitcnt lgkmcnt(5)
  v_mfma_f32_16x16x32_bf16 v[32:35], v[56:59], v[88:91], v[32:35]
  ds_read_b128 v[76:79], v5 offset:63488
  s_waitcnt lgkmcnt(5)
  v_mfma_f32_16x16x32_bf16 v[36:39], v[60:63], v[88:91], v[36:39]
  ds_read_b128 v[80:83], v5 offset:64512
  s_waitcnt lgkmcnt(5)
  v_mfma_f32_16x16x32_bf16 v[40:43], v[64:67], v[88:91], v[40:43]
  ds_read_b128 v[52:55], v6 offset:0
  s_waitcnt lgkmcnt(5)
  v_mfma_f32_16x16x32_bf16 v[44:47], v[68:71], v[88:91], v[44:47]
  ds_read_b128 v[56:59], v6 offset:1024
  s_waitcnt lgkmcnt(5)
  v_mfma_f32_16x16x32_bf16 v[48:51], v[72:75], v[88:91], v[48:51]
  ds_read_b128 v[60:63], v6 offset:2048
  ds_read_b128 v[96:99], v9 offset:8192
  s_waitcnt lgkmcnt(5)
  v_mfma_f32_16x16x32_bf16 v[32:35], v[76:79], v[92:95], v[32:35]
  ds_read_b128 v[64:67], v6 offset:3072
  s_waitcnt lgkmcnt(5)
  v_mfma_f32_16x16x32_bf16 v[36:39], v[80:83], v[92:95], v[36:39]
  ds_read_b128 v[68:71], v6 offset:4096
  s_waitcnt lgkmcnt(5)
  v_mfma_f32_16x16x32_bf16 v[40:43], v[52:55], v[92:95], v[40:43]
  ds_read_b128 v[72:75], v6 offset:5120
  s_waitcnt lgkmcnt(5)
  v_mfma_f32_16x16x32_bf16 v[44:47], v[56:59], v[92:95], v[44:47]
  ds_read_b128 v[76:79], v6 offset:6144
  s_waitcnt lgkmcnt(5)
  v_mfma_f32_16x16x32_bf16 v[48:51], v[60:63], v[92:95], v[48:51]
  ds_read_b128 v[80:83], v6 offset:15360
  s_barrier
  ds_read_b128 v[84:87], v7 offset:9216
  s_waitcnt lgkmcnt(5)
  v_mfma_f32_16x16x32_bf16 v[32:35], v[64:67], v[96:99], v[32:35]
  ds_read_b128 v[52:55], v4 offset:0
  s_waitcnt lgkmcnt(5)
  v_mfma_f32_16x16x32_bf16 v[36:39], v[68:71], v[96:99], v[36:39]
  ds_read_b128 v[56:59], v4 offset:1024
  s_waitcnt lgkmcnt(5)
  v_mfma_f32_16x16x32_bf16 v[40:43], v[72:75], v[96:99], v[40:43]
  ds_read_b128 v[60:63], v4 offset:2048
  s_waitcnt lgkmcnt(5)
  v_mfma_f32_16x16x32_bf16 v[44:47], v[76:79], v[96:99], v[44:47]
  ds_read_b128 v[64:67], v4 offset:3072
  s_waitcnt lgkmcnt(5)
  v_mfma_f32_16x16x32_bf16 v[48:51], v[80:83], v[96:99], v[48:51]
  ds_read_b128 v[68:71], v4 offset:4096
  ds_read_b128 v[88:91], v7 offset:10240
  s_waitcnt lgkmcnt(5)
  v_mfma_f32_16x16x32_bf16 v[32:35], v[52:55], v[84:87], v[32:35]
  ds_read_b128 v[72:75], v4 offset:5120
  s_waitcnt lgkmcnt(5)
  v_mfma_f32_16x16x32_bf16 v[36:39], v[56:59], v[84:87], v[36:39]
  ds_read_b128 v[76:79], v4 offset:6144
  s_waitcnt lgkmcnt(5)
  v_mfma_f32_16x16x32_bf16 v[40:43], v[60:63], v[84:87], v[40:43]
  ds_read_b128 v[80:83], v4 offset:7168
  s_waitcnt lgkmcnt(5)
  v_mfma_f32_16x16x32_bf16 v[44:47], v[64:67], v[84:87], v[44:47]
  ds_read_b128 v[52:55], v4 offset:8192
  s_waitcnt lgkmcnt(5)
  v_mfma_f32_16x16x32_bf16 v[48:51], v[68:71], v[84:87], v[48:51]
  ds_read_b128 v[56:59], v4 offset:17408
  s_barrier
  ds_read_b64 v[100:101], v20 offset:0
  ds_read_b64 v[102:103], v20 offset:32
  ds_read_b64 v[104:105], v20 offset:64
  ds_read_b64 v[106:107], v20 offset:96
  ds_read_b64 v[108:109], v20 offset:128
  ds_read_b128 v[92:95], v7 offset:27648
  s_waitcnt lgkmcnt(10)
  v_mfma_f32_16x16x32_bf16 v[32:35], v[72:75], v[88:91], v[32:35]
  ds_read_b128 v[60:63], v4 offset:18432
  s_waitcnt lgkmcnt(10)
  v_mfma_f32_16x16x32_bf16 v[36:39], v[76:79], v[88:91], v[36:39]
  ds_read_b128 v[64:67], v4 offset:19456
  s_waitcnt lgkmcnt(10)
  v_mfma_f32_16x16x32_bf16 v[40:43], v[80:83], v[88:91], v[40:43]
  ds_read_b128 v[68:71], v4 offset:20480
  s_waitcnt lgkmcnt(10)
  v_mfma_f32_16x16x32_bf16 v[44:47], v[52:55], v[88:91], v[44:47]
  ds_read_b128 v[72:75], v4 offset:21504
  s_waitcnt lgkmcnt(10)
  v_mfma_f32_16x16x32_bf16 v[48:51], v[56:59], v[88:91], v[48:51]
  ds_read_b128 v[76:79], v4 offset:22528
  ds_read_b128 v[96:99], v7 offset:28672
  s_waitcnt lgkmcnt(5)
  v_mfma_f32_16x16x32_bf16 v[32:35], v[60:63], v[92:95], v[32:35]
  ds_read_b128 v[80:83], v4 offset:23552
  s_waitcnt lgkmcnt(5)
  v_mfma_f32_16x16x32_bf16 v[36:39], v[64:67], v[92:95], v[36:39]
  ds_read_b128 v[52:55], v4 offset:24576
  s_waitcnt lgkmcnt(5)
  v_mfma_f32_16x16x32_bf16 v[40:43], v[68:71], v[92:95], v[40:43]
  ds_read_b128 v[56:59], v4 offset:25600
  s_waitcnt lgkmcnt(5)
  v_mfma_f32_16x16x32_bf16 v[44:47], v[72:75], v[92:95], v[44:47]
  ds_read_b128 v[60:63], v4 offset:26624
  s_waitcnt lgkmcnt(5)
  v_mfma_f32_16x16x32_bf16 v[48:51], v[76:79], v[92:95], v[48:51]
  ds_read_b128 v[64:67], v4 offset:35840
  s_waitcnt lgkmcnt(4)
  v_mfma_f32_16x16x32_bf16 v[32:35], v[80:83], v[96:99], v[32:35]
  v_lshlrev_b32 v126, 16, v109
  v_and_b32 v127, 0xffff0000, v109
  v_and_b32 v125, 0xffff0000, v108
  v_lshlrev_b32 v124, 16, v108
  s_waitcnt lgkmcnt(3)
  v_mfma_f32_16x16x32_bf16 v[36:39], v[52:55], v[96:99], v[36:39]
  v_lshlrev_b32 v122, 16, v107
  v_and_b32 v123, 0xffff0000, v107
  v_and_b32 v121, 0xffff0000, v106
  v_lshlrev_b32 v120, 16, v106
  s_waitcnt lgkmcnt(2)
  v_mfma_f32_16x16x32_bf16 v[40:43], v[56:59], v[96:99], v[40:43]
  v_lshlrev_b32 v118, 16, v105
  v_and_b32 v119, 0xffff0000, v105
  v_and_b32 v117, 0xffff0000, v104
  v_lshlrev_b32 v116, 16, v104
  s_waitcnt lgkmcnt(1)
  v_mfma_f32_16x16x32_bf16 v[44:47], v[60:63], v[96:99], v[44:47]
  v_lshlrev_b32 v114, 16, v103
  v_and_b32 v115, 0xffff0000, v103
  v_and_b32 v113, 0xffff0000, v102
  v_lshlrev_b32 v112, 16, v102
  s_waitcnt lgkmcnt(0)
  v_mfma_f32_16x16x32_bf16 v[48:51], v[64:67], v[96:99], v[48:51]
  v_lshlrev_b32 v110, 16, v101
  v_and_b32 v111, 0xffff0000, v101
  v_and_b32 v109, 0xffff0000, v100
  v_lshlrev_b32 v108, 16, v100
  v_pk_add_f32 v[32:33], v[32:33], v[108:109]
  v_pk_add_f32 v[34:35], v[34:35], v[110:111]
  v_cvt_pk_bf16_f32 v32, v32, v33
  v_cvt_pk_bf16_f32 v33, v34, v35
  v_pk_add_f32 v[36:37], v[36:37], v[112:113]
  v_pk_add_f32 v[38:39], v[38:39], v[114:115]
  v_cvt_pk_bf16_f32 v34, v36, v37
  v_cvt_pk_bf16_f32 v35, v38, v39
  buffer_store_dwordx4 v[32:35], v1, s[12:15], s44 offen offset:0 sc0 sc1
  v_pk_add_f32 v[40:41], v[40:41], v[116:117]
  v_pk_add_f32 v[42:43], v[42:43], v[118:119]
  v_cvt_pk_bf16_f32 v40, v40, v41
  v_cvt_pk_bf16_f32 v41, v42, v43
  v_pk_add_f32 v[44:45], v[44:45], v[120:121]
  v_pk_add_f32 v[46:47], v[46:47], v[122:123]
  v_cvt_pk_bf16_f32 v42, v44, v45
  v_cvt_pk_bf16_f32 v43, v46, v47
  buffer_store_dwordx4 v[40:43], v1, s[12:15], s44 offen offset:1024 sc0 sc1
  v_pk_add_f32 v[48:49], v[48:49], v[124:125]
  v_pk_add_f32 v[50:51], v[50:51], v[126:127]
  v_cvt_pk_bf16_f32 v48, v48, v49
  v_cvt_pk_bf16_f32 v49, v50, v51
  v_mov_b32 v52, v48
  v_mov_b32 v53, v49
  v_mov_b32 v54, v48
  v_mov_b32 v55, v49
  s_nop 0
  v_permlane16_swap_b32 v52, v54
  v_permlane16_swap_b32 v53, v55
  s_mov_b32 exec_lo, 0xffff
  s_mov_b32 exec_hi, 0xffff
  buffer_store_dwordx4 v[52:55], v11, s[12:15], s45 offen sc0 sc1
  s_mov_b64 exec, -1
  v_dot2c_f32_bf16 v24, v32, v28
  v_dot2c_f32_bf16 v25, v32, v32
  v_dot2c_f32_bf16 v24, v33, v28
  v_dot2c_f32_bf16 v25, v33, v33
  v_dot2c_f32_bf16 v24, v34, v28
  v_dot2c_f32_bf16 v25, v34, v34
  v_dot2c_f32_bf16 v24, v35, v28
  v_dot2c_f32_bf16 v25, v35, v35
  v_dot2c_f32_bf16 v24, v40, v28
  v_dot2c_f32_bf16 v25, v40, v40
  v_dot2c_f32_bf16 v24, v41, v28
  v_dot2c_f32_bf16 v25, v41, v41
  v_dot2c_f32_bf16 v24, v42, v28
  v_dot2c_f32_bf16 v25, v42, v42
  v_dot2c_f32_bf16 v24, v43, v28
  v_dot2c_f32_bf16 v25, v43, v43
  v_dot2c_f32_bf16 v24, v48, v28
  v_dot2c_f32_bf16 v25, v48, v48
  v_dot2c_f32_bf16 v24, v49, v28
  v_dot2c_f32_bf16 v25, v49, v49
  s_nop 2
  v_mov_b32 v22, v24
  v_mov_b32 v23, v25
  s_nop 0
  v_permlane16_swap_b32 v24, v22
  v_permlane16_swap_b32 v25, v23
  s_nop 0
  v_add_f32 v24, v24, v22
  v_add_f32 v25, v25, v23
  v_mov_b32 v22, v24
  v_mov_b32 v23, v25
  s_nop 0
  v_permlane32_swap_b32 v24, v22
  v_permlane32_swap_b32 v25, v23
  s_nop 0
  v_add_f32 v24, v24, v22
  v_add_f32 v25, v25, v23
  s_mov_b64 exec, 0xffff
  buffer_store_dwordx2 v[24:25], v21, s[12:15], s43 offen
s3_wo_end_1:
  s_endpgm
.globl s4_gu_kernel
.p2align 8
.type s4_gu_kernel,@function
s4_gu_kernel:
  s_cmp_ge_u32 s2, 256
  s_cbranch_scc1 s4_gu_end_1
  s_load_dwordx2 s[8:9], s[0:1], 72
  v_lshrrev_b32 v1, 6, v0
  v_and_b32 v0, 63, v0
  v_readfirstlane_b32 s26, v1
  v_lshlrev_b32 v1, 4, v0
  s_and_b32 s10, s2, 7
  s_lshr_b32 s11, s2, 3
  s_and_b32 s3, s10, 1
  s_lshl_b32 s24, s3, 3
  s_and_b32 s3, s11, 7
  s_add_u32 s24, s24, s3
  s_lshl_b32 s24, s24, 3
  s_lshr_b32 s34, s11, 3
  s_lshr_b32 s33, s10, 1
  s_lshl_b32 s25, s33, 2
  s_add_u32 s25, s25, s34
  s_cmp_lt_u32 s26, 4
  s_cbranch_scc1 s4_gu_c_2
  s_mul_i32 s28, s25, 286720
  s_add_u32 s28, s28, 0x1410000
  s_mul_i32 s30, s24, 20480
  s_add_u32 s30, s30, 0xa00000
  s_cmp_eq_u32 s34, 3
  s_cselect_b32 s36, 1024, 0
  s_mov_b32 s57, s30
  s_cmp_eq_u32 s26, 5
  s_cbranch_scc1 s4_gu_sb_3
  v_add_u32 v8, 0, v1
  v_add_u32 v9, 0, v1
  v_add_u32 v10, 0, v1
  v_add_u32 v11, 0, v1
  v_add_u32 v12, 4096, v1
  v_add_u32 v13, 4096, v1
  v_add_u32 v14, 4096, v1
  v_subrev_u32 v14, s36, v14
  v_add_u32 v15, 4096, v1
  v_add_u32 v16, 8192, v1
  v_add_u32 v17, 8192, v1
  v_add_u32 v18, 8192, v1
  s_mov_b32 s30, s28
  s_mov_b32 s27, 14336
  s_mov_b32 s29, 0
  s_branch s4_gu_sj_4
s4_gu_sb_3:
  v_add_u32 v8, 0, v1
  v_add_u32 v9, 19456, v1
  v_add_u32 v10, 38912, v1
  v_add_u32 v11, 58368, v1
  v_add_u32 v12, 81920, v1
  v_add_u32 v13, 101376, v1
  v_add_u32 v14, 120832, v1
  v_add_u32 v15, 140288, v1
  v_add_u32 v16, 11264, v1
  v_add_u32 v17, 11264, v1
  v_add_u32 v18, 11264, v1
  v_subrev_u32 v18, s36, v18
  s_mov_b32 s27, 1024
  s_mov_b32 s29, 11264
s4_gu_sj_4:
  s_waitcnt lgkmcnt(0)
  s_mov_b32 s12, s8
  s_and_b32 s13, s9, 0xffff
  s_mov_b32 s14, 0x1b00000
  s_mov_b32 s15, 0x00020000
  s_add_u32 m0, s29, 0
  s_nop 0
  buffer_load_dwordx4 v8, s[12:15], s30 offen offset:0 lds
  buffer_load_dwordx4 v9, s[12:15], s30 offen offset:1024 lds
  buffer_load_dwordx4 v10, s[12:15], s30 offen offset:2048 lds
  buffer_load_dwordx4 v11, s[12:15], s30 offen offset:3072 lds
  s_add_u32 m0, s29, 4096
  s_nop 0
  buffer_load_dwordx4 v12, s[12:15], s30 offen offset:0 lds
  buffer_load_dwordx4 v13, s[12:15], s30 offen offset:1024 lds
  buffer_load_dwordx4 v14, s[12:15], s30 offen offset:2048 lds
  buffer_load_dwordx4 v15, s[12:15], s30 offen offset:3072 lds
  s_add_u32 m0, s29, 8192
  s_nop 0
  buffer_load_dwordx4 v16, s[12:15], s28 offen offset:0 lds
  buffer_load_dwordx4 v17, s[12:15], s28 offen offset:1024 lds
  buffer_load_dwordx4 v18, s[12:15], s28 offen offset:2048 lds
  s_add_u32 m0, s29, 22528
  s_add_u32 s30, s30, s27
  s_add_u32 s28, s28, 14336
  buffer_load_dwordx4 v8, s[12:15], s30 offen offset:0 lds
  buffer_load_dwordx4 v9, s[12:15], s30 offen offset:1024 lds
  buffer_load_dwordx4 v10, s[12:15], s30 offen offset:2048 lds
  buffer_load_dwordx4 v11, s[12:15], s30 offen offset:3072 lds
  s_add_u32 m0, s29, 26624
  s_nop 0
  buffer_load_dwordx4 v12, s[12:15], s30 offen offset:0 lds
  buffer_load_dwordx4 v13, s[12:15], s30 offen offset:1024 lds
  buffer_load_dwordx4 v14, s[12:15], s30 offen offset:2048 lds
  buffer_load_dwordx4 v15, s[12:15], s30 offen offset:3072 lds
  s_add_u32 m0, s29, 30720
  s_nop 0
  buffer_load_dwordx4 v16, s[12:15], s28 offen offset:0 lds
  buffer_load_dwordx4 v17, s[12:15], s28 offen offset:1024 lds
  buffer_load_dwordx4 v18, s[12:15], s28 offen offset:2048 lds
  s_waitcnt vmcnt(11)
  s_barrier
  s_add_u32 m0, s29, 45056
  s_add_u32 s30, s30, s27
  s_add_u32 s28, s28, 14336
  buffer_load_dwordx4 v8, s[12:15], s30 offen offset:0 lds
  buffer_load_dwordx4 v9, s[12:15], s30 offen offset:1024 lds
  buffer_load_dwordx4 v10, s[12:15], s30 offen offset:2048 lds
  buffer_load_dwordx4 v11, s[12:15], s30 offen offset:3072 lds
  s_add_u32 m0, s29, 49152
  s_nop 0
  buffer_load_dwordx4 v12, s[12:15], s30 offen offset:0 lds
  buffer_load_dwordx4 v13, s[12:15], s30 offen offset:1024 lds
  buffer_load_dwordx4 v14, s[12:15], s30 offen offset:2048 lds
  buffer_load_dwordx4 v15, s[12:15], s30 offen offset:3072 lds
  s_add_u32 m0, s29, 53248
  s_nop 0
  buffer_load_dwordx4 v16, s[12:15], s28 offen offset:0 lds
  buffer_load_dwordx4 v17, s[12:15], s28 offen offset:1024 lds
  buffer_load_dwordx4 v18, s[12:15], s28 offen offset:2048 lds
  s_waitcnt vmcnt(11)
  s_barrier
  s_add_u32 m0, s29, 67584
  s_add_u32 s30, s30, s27
  s_add_u32 s28, s28, 14336
  buffer_load_dwordx4 v8, s[12:15], s30 offen offset:0 lds
  buffer_load_dwordx4 v9, s[12:15], s30 offen offset:1024 lds
  buffer_load_dwordx4 v10, s[12:15], s30 offen offset:2048 lds
  buffer_load_dwordx4 v11, s[12:15], s30 offen offset:3072 lds
  s_add_u32 m0, s29, 71680
  s_nop 0
  buffer_load_dwordx4 v12, s[12:15], s30 offen offset:0 lds
  buffer_load_dwordx4 v13, s[12:15], s30 offen offset:1024 lds
  buffer_load_dwordx4 v14, s[12:15], s30 offen offset:2048 lds
  buffer_load_dwordx4 v15, s[12:15], s30 offen offset:3072 lds
  s_add_u32 m0, s29, 75776
  s_nop 0
  buffer_load_dwordx4 v16, s[12:15], s28 offen offset:0 lds
  buffer_load_dwordx4 v17, s[12:15], s28 offen offset:1024 lds
  buffer_load_dwordx4 v18, s[12:15], s28 offen offset:2048 lds
  s_add_u32 m0, s29, 90112
  s_add_u32 s30, s30, s27
  s_add_u32 s28, s28, 14336
  buffer_load_dwordx4 v8, s[12:15], s30 offen offset:0 lds
  buffer_load_dwordx4 v9, s[12:15], s30 offen offset:1024 lds
  buffer_load_dwordx4 v10, s[12:15], s30 offen offset:2048 lds
  buffer_load_dwordx4 v11, s[12:15], s30 offen offset:3072 lds
  s_add_u32 m0, s29, 94208
  s_nop 0
  buffer_load_dwordx4 v12, s[12:15], s30 offen offset:0 lds
  buffer_load_dwordx4 v13, s[12:15], s30 offen offset:1024 lds
  buffer_load_dwordx4 v14, s[12:15], s30 offen offset:2048 lds
  buffer_load_dwordx4 v15, s[12:15], s30 offen offset:3072 lds
  s_add_u32 m0, s29, 98304
  s_nop 0
  buffer_load_dwordx4 v16, s[12:15], s28 offen offset:0 lds
  buffer_load_dwordx4 v17, s[12:15], s28 offen offset:1024 lds
  buffer_load_dwordx4 v18, s[12:15], s28 offen offset:2048 lds
  s_waitcnt vmcnt(22)
  s_barrier
  s_add_u32 m0, s29, 112640
  s_add_u32 s30, s30, s27
  s_add_u32 s28, s28, 14336
  buffer_load_dwordx4 v8, s[12:15], s30 offen offset:0 lds
  buffer_load_dwordx4 v9, s[12:15], s30 offen offset:1024 lds
  buffer_load_dwordx4 v10, s[12:15], s30 offen offset:2048 lds
  buffer_load_dwordx4 v11, s[12:15], s30 offen offset:3072 lds
  s_add_u32 m0, s29, 116736
  s_nop 0
  buffer_load_dwordx4 v12, s[12:15], s30 offen offset:0 lds
  buffer_load_dwordx4 v13, s[12:15], s30 offen offset:1024 lds
  buffer_load_dwordx4 v14, s[12:15], s30 offen offset:2048 lds
  buffer_load_dwordx4 v15, s[12:15], s30 offen offset:3072 lds
  s_add_u32 m0, s29, 120832
  s_nop 0
  buffer_load_dwordx4 v16, s[12:15], s28 offen offset:0 lds
  buffer_load_dwordx4 v17, s[12:15], s28 offen offset:1024 lds
  buffer_load_dwordx4 v18, s[12:15], s28 offen offset:2048 lds
  s_waitcnt vmcnt(22)
  s_barrier
  s_add_u32 m0, s29, 135168
  s_add_u32 s30, s30, s27
  s_add_u32 s28, s28, 14336
  buffer_load_dwordx4 v8, s[12:15], s30 offen offset:0 lds
  buffer_load_dwordx4 v9, s[12:15], s30 offen offset:1024 lds
  buffer_load_dwordx4 v10, s[12:15], s30 offen offset:2048 lds
  buffer_load_dwordx4 v11, s[12:15], s30 offen offset:3072 lds
  s_add_u32 m0, s29, 139264
  s_nop 0
  buffer_load_dwordx4 v12, s[12:15], s30 offen offset:0 lds
  buffer_load_dwordx4 v13, s[12:15], s30 offen offset:1024 lds
  buffer_load_dwordx4 v14, s[12:15], s30 offen offset:2048 lds
  buffer_load_dwordx4 v15, s[12:15], s30 offen offset:3072 lds
  s_add_u32 m0, s29, 143360
  s_nop 0
  buffer_load_dwordx4 v16, s[12:15], s28 offen offset:0 lds
  buffer_load_dwordx4 v17, s[12:15], s28 offen offset:1024 lds
  buffer_load_dwordx4 v18, s[12:15], s28 offen offset:2048 lds
  s_add_u32 m0, s29, 0
  s_add_u32 s30, s30, s27
  s_add_u32 s28, s28, 14336
  buffer_load_dwordx4 v8, s[12:15], s30 offen offset:0 lds
  buffer_load_dwordx4 v9, s[12:15], s30 offen offset:1024 lds
  buffer_load_dwordx4 v10, s[12:15], s30 offen offset:2048 lds
  buffer_load_dwordx4 v11, s[12:15], s30 offen offset:3072 lds
  s_add_u32 m0, s29, 4096
  s_nop 0
  buffer_load_dwordx4 v12, s[12:15], s30 offen offset:0 lds
  buffer_load_dwordx4 v13, s[12:15], s30 offen offset:1024 lds
  buffer_load_dwordx4 v14, s[12:15], s30 offen offset:2048 lds
  buffer_load_dwordx4 v15, s[12:15], s30 offen offset:3072 lds
  s_add_u32 m0, s29, 8192
  s_nop 0
  buffer_load_dwordx4 v16, s[12:15], s28 offen offset:0 lds
  buffer_load_dwordx4 v17, s[12:15], s28 offen offset:1024 lds
  buffer_load_dwordx4 v18, s[12:15], s28 offen offset:2048 lds
  s_waitcnt vmcnt(33)
  s_barrier
  s_add_u32 m0, s29, 22528
  s_add_u32 s30, s30, s27
  s_add_u32 s28, s28, 14336
  buffer_load_dwordx4 v8, s[12:15], s30 offen offset:0 lds
  buffer_load_dwordx4 v9, s[12:15], s30 offen offset:1024 lds
  buffer_load_dwordx4 v10, s[12:15], s30 offen offset:2048 lds
  buffer_load_dwordx4 v11, s[12:15], s30 offen offset:3072 lds
  s_add_u32 m0, s29, 26624
  s_nop 0
  buffer_load_dwordx4 v12, s[12:15], s30 offen offset:0 lds
  buffer_load_dwordx4 v13, s[12:15], s30 offen offset:1024 lds
  buffer_load_dwordx4 v14, s[12:15], s30 offen offset:2048 lds
  buffer_load_dwordx4 v15, s[12:15], s30 offen offset:3072 lds
  s_add_u32 m0, s29, 30720
  s_nop 0
  buffer_load_dwordx4 v16, s[12:15], s28 offen offset:0 lds
  buffer_load_dwordx4 v17, s[12:15], s28 offen offset:1024 lds
  buffer_load_dwordx4 v18, s[12:15], s28 offen offset:2048 lds
  s_waitcnt vmcnt(33)
  s_barrier
  s_add_u32 m0, s29, 45056
  s_add_u32 s30, s30, s27
  s_add_u32 s28, s28, 14336
  buffer_load_dwordx4 v8, s[12:15], s30 offen offset:0 lds
  buffer_load_dwordx4 v9, s[12:15], s30 offen offset:1024 lds
  buffer_load_dwordx4 v10, s[12:15], s30 offen offset:2048 lds
  buffer_load_dwordx4 v11, s[12:15], s30 offen offset:3072 lds
  s_add_u32 m0, s29, 49152
  s_nop 0
  buffer_load_dwordx4 v12, s[12:15], s30 offen offset:0 lds
  buffer_load_dwordx4 v13, s[12:15], s30 offen offset:1024 lds
  buffer_load_dwordx4 v14, s[12:15], s30 offen offset:2048 lds
  buffer_load_dwordx4 v15, s[12:15], s30 offen offset:3072 lds
  s_add_u32 m0, s29, 53248
  s_nop 0
  buffer_load_dwordx4 v16, s[12:15], s28 offen offset:0 lds
  buffer_load_dwordx4 v17, s[12:15], s28 offen offset:1024 lds
  buffer_load_dwordx4 v18, s[12:15], s28 offen offset:2048 lds
  s_add_u32 m0, s29, 67584
  s_add_u32 s30, s30, s27
  s_add_u32 s28, s28, 14336
  buffer_load_dwordx4 v8, s[12:15], s30 offen offset:0 lds
  buffer_load_dwordx4 v9, s[12:15], s30 offen offset:1024 lds
  buffer_load_dwordx4 v10, s[12:15], s30 offen offset:2048 lds
  buffer_load_dwordx4 v11, s[12:15], s30 offen offset:3072 lds
  s_add_u32 m0, s29, 71680
  s_nop 0
  buffer_load_dwordx4 v12, s[12:15], s30 offen offset:0 lds
  buffer_load_dwordx4 v13, s[12:15], s30 offen offset:1024 lds
  buffer_load_dwordx4 v14, s[12:15], s30 offen offset:2048 lds
  buffer_load_dwordx4 v15, s[12:15], s30 offen offset:3072 lds
  s_add_u32 m0, s29, 75776
  s_nop 0
  buffer_load_dwordx4 v16, s[12:15], s28 offen offset:0 lds
  buffer_load_dwordx4 v17, s[12:15], s28 offen offset:1024 lds
  buffer_load_dwordx4 v18, s[12:15], s28 offen offset:2048 lds
  s_waitcnt vmcnt(44)
  s_barrier
  s_add_u32 m0, s29, 90112
  s_add_u32 s30, s30, s27
  s_add_u32 s28, s28, 14336
  buffer_load_dwordx4 v8, s[12:15], s30 offen offset:0 lds
  buffer_load_dwordx4 v9, s[12:15], s30 offen offset:1024 lds
  buffer_load_dwordx4 v10, s[12:15], s30 offen offset:2048 lds
  buffer_load_dwordx4 v11, s[12:15], s30 offen offset:3072 lds
  s_add_u32 m0, s29, 94208
  s_nop 0
  buffer_load_dwordx4 v12, s[12:15], s30 offen offset:0 lds
  buffer_load_dwordx4 v13, s[12:15], s30 offen offset:1024 lds
  buffer_load_dwordx4 v14, s[12:15], s30 offen offset:2048 lds
  buffer_load_dwordx4 v15, s[12:15], s30 offen offset:3072 lds
  s_add_u32 m0, s29, 98304
  s_nop 0
  buffer_load_dwordx4 v16, s[12:15], s28 offen offset:0 lds
  buffer_load_dwordx4 v17, s[12:15], s28 offen offset:1024 lds
  buffer_load_dwordx4 v18, s[12:15], s28 offen offset:2048 lds
  s_waitcnt vmcnt(44)
  s_barrier
  s_add_u32 m0, s29, 112640
  s_add_u32 s30, s30, s27
  s_add_u32 s28, s28, 14336
  buffer_load_dwordx4 v8, s[12:15], s30 offen offset:0 lds
  buffer_load_dwordx4 v9, s[12:15], s30 offen offset:1024 lds
  buffer_load_dwordx4 v10, s[12:15], s30 offen offset:2048 lds
  buffer_load_dwordx4 v11, s[12:15], s30 offen offset:3072 lds
  s_add_u32 m0, s29, 116736
  s_nop 0
  buffer_load_dwordx4 v12, s[12:15], s30 offen offset:0 lds
  buffer_load_dwordx4 v13, s[12:15], s30 offen offset:1024 lds
  buffer_load_dwordx4 v14, s[12:15], s30 offen offset:2048 lds
  buffer_load_dwordx4 v15, s[12:15], s30 offen offset:3072 lds
  s_add_u32 m0, s29, 120832
  s_nop 0
  buffer_load_dwordx4 v16, s[12:15], s28 offen offset:0 lds
  buffer_load_dwordx4 v17, s[12:15], s28 offen offset:1024 lds
  buffer_load_dwordx4 v18, s[12:15], s28 offen offset:2048 lds
  s_waitcnt vmcnt(44)
  s_barrier
  s_add_u32 m0, s29, 135168
  s_add_u32 s30, s30, s27
  s_add_u32 s28, s28, 14336
  buffer_load_dwordx4 v8, s[12:15], s30 offen offset:0 lds
  buffer_load_dwordx4 v9, s[12:15], s30 offen offset:1024 lds
  buffer_load_dwordx4 v10, s[12:15], s30 offen offset:2048 lds
  buffer_load_dwordx4 v11, s[12:15], s30 offen offset:3072 lds
  s_add_u32 m0, s29, 139264
  s_nop 0
  buffer_load_dwordx4 v12, s[12:15], s30 offen offset:0 lds
  buffer_load_dwordx4 v13, s[12:15], s30 offen offset:1024 lds
  buffer_load_dwordx4 v14, s[12:15], s30 offen offset:2048 lds
  buffer_load_dwordx4 v15, s[12:15], s30 offen offset:3072 lds
  s_add_u32 m0, s29, 143360
  s_nop 0
  buffer_load_dwordx4 v16, s[12:15], s28 offen offset:0 lds
  buffer_load_dwordx4 v17, s[12:15], s28 offen offset:1024 lds
  buffer_load_dwordx4 v18, s[12:15], s28 offen offset:2048 lds
  s_waitcnt vmcnt(44)
  s_barrier
  s_add_u32 m0, s29, 0
  s_add_u32 s30, s30, s27
  s_add_u32 s28, s28, 14336
  buffer_load_dwordx4 v8, s[12:15], s30 offen offset:0 lds
  buffer_load_dwordx4 v9, s[12:15], s30 offen offset:1024 lds
  buffer_load_dwordx4 v10, s[12:15], s30 offen offset:2048 lds
  buffer_load_dwordx4 v11, s[12:15], s30 offen offset:3072 lds
  s_add_u32 m0, s29, 4096
  s_nop 0
  buffer_load_dwordx4 v12, s[12:15], s30 offen offset:0 lds
  buffer_load_dwordx4 v13, s[12:15], s30 offen offset:1024 lds
  buffer_load_dwordx4 v14, s[12:15], s30 offen offset:2048 lds
  buffer_load_dwordx4 v15, s[12:15], s30 offen offset:3072 lds
  s_add_u32 m0, s29, 8192
  s_nop 0
  buffer_load_dwordx4 v16, s[12:15], s28 offen offset:0 lds
  buffer_load_dwordx4 v17, s[12:15], s28 offen offset:1024 lds
  buffer_load_dwordx4 v18, s[12:15], s28 offen offset:2048 lds
  s_waitcnt vmcnt(44)
  s_barrier
  s_add_u32 m0, s29, 22528
  s_add_u32 s30, s30, s27
  s_add_u32 s28, s28, 14336
  buffer_load_dwordx4 v8, s[12:15], s30 offen offset:0 lds
  buffer_load_dwordx4 v9, s[12:15], s30 offen offset:1024 lds
  buffer_load_dwordx4 v10, s[12:15], s30 offen offset:2048 lds
  buffer_load_dwordx4 v11, s[12:15], s30 offen offset:3072 lds
  s_add_u32 m0, s29, 26624
  s_nop 0
  buffer_load_dwordx4 v12, s[12:15], s30 offen offset:0 lds
  buffer_load_dwordx4 v13, s[12:15], s30 offen offset:1024 lds
  buffer_load_dwordx4 v14, s[12:15], s30 offen offset:2048 lds
  buffer_load_dwordx4 v15, s[12:15], s30 offen offset:3072 lds
  s_add_u32 m0, s29, 30720
  s_nop 0
  buffer_load_dwordx4 v16, s[12:15], s28 offen offset:0 lds
  buffer_load_dwordx4 v17, s[12:15], s28 offen offset:1024 lds
  buffer_load_dwordx4 v18, s[12:15], s28 offen offset:2048 lds
  s_waitcnt vmcnt(44)
  s_barrier
  s_add_u32 m0, s29, 45056
  s_add_u32 s30, s30, s27
  s_add_u32 s28, s28, 14336
  buffer_load_dwordx4 v8, s[12:15], s30 offen offset:0 lds
  buffer_load_dwordx4 v9, s[12:15], s30 offen offset:1024 lds
  buffer_load_dwordx4 v10, s[12:15], s30 offen offset:2048 lds
  buffer_load_dwordx4 v11, s[12:15], s30 offen offset:3072 lds
  s_add_u32 m0, s29, 49152
  s_nop 0
  buffer_load_dwordx4 v12, s[12:15], s30 offen offset:0 lds
  buffer_load_dwordx4 v13, s[12:15], s30 offen offset:1024 lds
  buffer_load_dwordx4 v14, s[12:15], s30 offen offset:2048 lds
  buffer_load_dwordx4 v15, s[12:15], s30 offen offset:3072 lds
  s_add_u32 m0, s29, 53248
  s_nop 0
  buffer_load_dwordx4 v16, s[12:15], s28 offen offset:0 lds
  buffer_load_dwordx4 v17, s[12:15], s28 offen offset:1024 lds
  buffer_load_dwordx4 v18, s[12:15], s28 offen offset:2048 lds
  s_waitcnt vmcnt(44)
  s_barrier
  s_add_u32 m0, s29, 67584
  s_add_u32 s30, s30, s27
  s_add_u32 s28, s28, 14336
  buffer_load_dwordx4 v8, s[12:15], s30 offen offset:0 lds
  buffer_load_dwordx4 v9, s[12:15], s30 offen offset:1024 lds
  buffer_load_dwordx4 v10, s[12:15], s30 offen offset:2048 lds
  buffer_load_dwordx4 v11, s[12:15], s30 offen offset:3072 lds
  s_add_u32 m0, s29, 71680
  s_nop 0
  buffer_load_dwordx4 v12, s[12:15], s30 offen offset:0 lds
  buffer_load_dwordx4 v13, s[12:15], s30 offen offset:1024 lds
  buffer_load_dwordx4 v14, s[12:15], s30 offen offset:2048 lds
  buffer_load_dwordx4 v15, s[12:15], s30 offen offset:3072 lds
  s_add_u32 m0, s29, 75776
  s_nop 0
  buffer_load_dwordx4 v16, s[12:15], s28 offen offset:0 lds
  buffer_load_dwordx4 v17, s[12:15], s28 offen offset:1024 lds
  buffer_load_dwordx4 v18, s[12:15], s28 offen offset:2048 lds
  s_waitcnt vmcnt(44)
  s_barrier
  s_add_u32 m0, s29, 90112
  s_add_u32 s30, s30, s27
  s_add_u32 s28, s28, 14336
  buffer_load_dwordx4 v8, s[12:15], s30 offen offset:0 lds
  buffer_load_dwordx4 v9, s[12:15], s30 offen offset:1024 lds
  buffer_load_dwordx4 v10, s[12:15], s30 offen offset:2048 lds
  buffer_load_dwordx4 v11, s[12:15], s30 offen offset:3072 lds
  s_add_u32 m0, s29, 94208
  s_nop 0
  buffer_load_dwordx4 v12, s[12:15], s30 offen offset:0 lds
  buffer_load_dwordx4 v13, s[12:15], s30 offen offset:1024 lds
  buffer_load_dwordx4 v14, s[12:15], s30 offen offset:2048 lds
  buffer_load_dwordx4 v15, s[12:15], s30 offen offset:3072 lds
  s_add_u32 m0, s29, 98304
  s_nop 0
  buffer_load_dwordx4 v16, s[12:15], s28 offen offset:0 lds
  buffer_load_dwordx4 v17, s[12:15], s28 offen offset:1024 lds
  buffer_load_dwordx4 v18, s[12:15], s28 offen offset:2048 lds
  s_waitcnt vmcnt(44)
  s_barrier
  s_add_u32 m0, s29, 112640
  s_add_u32 s30, s30, s27
  s_add_u32 s28, s28, 14336
  buffer_load_dwordx4 v8, s[12:15], s30 offen offset:0 lds
  buffer_load_dwordx4 v9, s[12:15], s30 offen offset:1024 lds
  buffer_load_dwordx4 v10, s[12:15], s30 offen offset:2048 lds
  buffer_load_dwordx4 v11, s[12:15], s30 offen offset:3072 lds
  s_add_u32 m0, s29, 116736
  s_nop 0
  buffer_load_dwordx4 v12, s[12:15], s30 offen offset:0 lds
  buffer_load_dwordx4 v13, s[12:15], s30 offen offset:1024 lds
  buffer_load_dwordx4 v14, s[12:15], s30 offen offset:2048 lds
  buffer_load_dwordx4 v15, s[12:15], s30 offen offset:3072 lds
  s_add_u32 m0, s29, 120832
  s_nop 0
  buffer_load_dwordx4 v16, s[12:15], s28 offen offset:0 lds
  buffer_load_dwordx4 v17, s[12:15], s28 offen offset:1024 lds
  buffer_load_dwordx4 v18, s[12:15], s28 offen offset:2048 lds
  s_mul_i32 s38, s25, 17920
  s_mul_i32 s39, s26, 448
  s_add_u32 s38, s38, s39
  s_add_u32 s38, s38, 0x1aaf900
  v_and_b32 v20, 31, v0
  v_min_u32 v20, 27, v20
  v_lshlrev_b32 v20, 4, v20
  v_lshrrev_b32 v21, 5, v0
  v_mul_u32_u24 v21, 0x380, v21
  v_add_u32 v21, v21, v20
  s_add_u32 s39, s39, 155904
  v_add_u32 v20, s39, v20
  buffer_load_dwordx4 v[48:51], v21, s[12:15], s38 offen offset:0
  buffer_load_dwordx4 v[52:55], v21, s[12:15], s38 offen offset:1792
  buffer_load_dwordx4 v[56:59], v21, s[12:15], s38 offen offset:3584
  s_add_u32 s38, s38, 5376
  buffer_load_dwordx4 v[60:63], v21, s[12:15], s38 offen offset:0
  buffer_load_dwordx4 v[64:67], v21, s[12:15], s38 offen offset:1792
  buffer_load_dwordx4 v[68:71], v21, s[12:15], s38 offen offset:3584
  s_add_u32 s38, s38, 5376
  buffer_load_dwordx4 v[72:75], v21, s[12:15], s38 offen offset:0
  buffer_load_dwordx4 v[76:79], v21, s[12:15], s38 offen offset:1792
  buffer_load_dwordx4 v[80:83], v21, s[12:15], s38 offen offset:3584
  s_add_u32 s38, s38, 5376
  buffer_load_dwordx4 v[84:87], v21, s[12:15], s38 offen offset:0
  s_cmp_eq_u32 s26, 5
  s_cbranch_scc1 s4_gu_tb_5
  s_bfe_u32 s3, s10, 0x10001
  s_lshl_b32 s3, s3, 2
  s_lshr_b32 s38, s11, 3
  s_add_u32 s3, s3, s38
  s_mul_i32 s38, s3, 276480
  s_and_b32 s3, s11, 7
  s_mul_i32 s3, s3, 16384
  s_add_u32 s38, s38, s3
  s_add_u32 s38, s38, 0x1870000
  v_min_u32 v40, 63, v0
  v_lshlrev_b32 v40, 7, v40
  buffer_load_dword v44, v40, s[12:15], s38 offen
  s_waitcnt vmcnt(55)
  s_barrier
  s_waitcnt vmcnt(44)
  s_barrier
  s_waitcnt vmcnt(33)
  s_barrier
  s_waitcnt vmcnt(22)
  s_barrier
  s_waitcnt vmcnt(1)
  v_add_f32 v48, v48, v68
  v_add_f32 v49, v49, v69
  v_add_f32 v50, v50, v70
  v_add_f32 v51, v51, v71
  v_add_f32 v52, v52, v72
  v_add_f32 v53, v53, v73
  v_add_f32 v54, v54, v74
  v_add_f32 v55, v55, v75
  v_add_f32 v56, v56, v76
  v_add_f32 v57, v57, v77
  v_add_f32 v58, v58, v78
  v_add_f32 v59, v59, v79
  v_add_f32 v60, v60, v80
  v_add_f32 v61, v61, v81
  v_add_f32 v62, v62, v82
  v_add_f32 v63, v63, v83
  v_add_f32 v64, v64, v84
  v_add_f32 v65, v65, v85
  v_add_f32 v66, v66, v86
  v_add_f32 v67, v67, v87
  v_add_f32 v48, v48, v56
  v_add_f32 v49, v49, v57
  v_add_f32 v50, v50, v58
  v_add_f32 v51, v51, v59
  v_add_f32 v52, v52, v60
  v_add_f32 v53, v53, v61
  v_add_f32 v54, v54, v62
  v_add_f32 v55, v55, v63
  v_add_f32 v48, v48, v52
  v_add_f32 v49, v49, v53
  v_add_f32 v50, v50, v54
  v_add_f32 v51, v51, v55
  v_add_f32 v48, v48, v64
  v_add_f32 v49, v49, v65
  v_add_f32 v50, v50, v66
  v_add_f32 v51, v51, v67
  v_mov_b32 v52, v48
  v_mov_b32 v53, v49
  v_mov_b32 v54, v50
  v_mov_b32 v55, v51
  s_nop 0
  v_permlane32_swap_b32 v48, v52
  v_permlane32_swap_b32 v49, v53
  v_permlane32_swap_b32 v50, v54
  v_permlane32_swap_b32 v51, v55
  s_nop 0
  v_add_f32 v48, v48, v52
  v_add_f32 v49, v49, v53
  v_add_f32 v50, v50, v54
  v_add_f32 v51, v51, v55
  ds_write_b128 v20, v[48:51]
  s_waitcnt lgkmcnt(0)
  s_waitcnt vmcnt(11)
  s_barrier
  s_waitcnt vmcnt(0)
  s_endpgm
s4_gu_tb_5:
  s_bfe_u32 s3, s10, 0x10001
  s_lshl_b32 s3, s3, 2
  s_lshr_b32 s38, s11, 3
  s_add_u32 s3, s3, s38
  s_mul_i32 s38, s3, 276480
  s_and_b32 s3, s11, 7
  s_mul_i32 s3, s3, 16384
  s_add_u32 s38, s38, s3
  s_add_u32 s38, s38, 0x1872000
  v_min_u32 v40, 63, v0
  v_lshlrev_b32 v40, 7, v40
  buffer_load_dword v44, v40, s[12:15], s38 offen
  s_waitcnt vmcnt(55)
  s_barrier
  s_waitcnt vmcnt(44)
  s_barrier
  s_waitcnt vmcnt(33)
  s_barrier
  s_waitcnt vmcnt(22)
  s_barrier
  s_waitcnt vmcnt(1)
  v_add_f32 v48, v48, v68
  v_add_f32 v49, v49, v69
  v_add_f32 v50, v50, v70
  v_add_f32 v51, v51, v71
  v_add_f32 v52, v52, v72
  v_add_f32 v53, v53, v73
  v_add_f32 v54, v54, v74
  v_add_f32 v55, v55, v75
  v_add_f32 v56, v56, v76
  v_add_f32 v57, v57, v77
  v_add_f32 v58, v58, v78
  v_add_f32 v59, v59, v79
  v_add_f32 v60, v60, v80
  v_add_f32 v61, v61, v81
  v_add_f32 v62, v62, v82
  v_add_f32 v63, v63, v83
  v_add_f32 v64, v64, v84
  v_add_f32 v65, v65, v85
  v_add_f32 v66, v66, v86
  v_add_f32 v67, v67, v87
  v_add_f32 v48, v48, v56
  v_add_f32 v49, v49, v57
  v_add_f32 v50, v50, v58
  v_add_f32 v51, v51, v59
  v_add_f32 v52, v52, v60
  v_add_f32 v53, v53, v61
  v_add_f32 v54, v54, v62
  v_add_f32 v55, v55, v63
  v_add_f32 v48, v48, v52
  v_add_f32 v49, v49, v53
  v_add_f32 v50, v50, v54
  v_add_f32 v51, v51, v55
  v_add_f32 v48, v48, v64
  v_add_f32 v49, v49, v65
  v_add_f32 v50, v50, v66
  v_add_f32 v51, v51, v67
  v_mov_b32 v52, v48
  v_mov_b32 v53, v49
  v_mov_b32 v54, v50
  v_mov_b32 v55, v51
  s_nop 0
  v_permlane32_swap_b32 v48, v52
  v_permlane32_swap_b32 v49, v53
  v_permlane32_swap_b32 v50, v54
  v_permlane32_swap_b32 v51, v55
  s_nop 0
  v_add_f32 v48, v48, v52
  v_add_f32 v49, v49, v53
  v_add_f32 v50, v50, v54
  v_add_f32 v51, v51, v55
  ds_write_b128 v20, v[48:51]
  s_waitcnt lgkmcnt(0)
  s_waitcnt vmcnt(11)
  s_barrier
  s_waitcnt vmcnt(0)
  s_endpgm
s4_gu_c_2:
  v_and_b32 v2, 15, v0
  v_lshrrev_b32 v3, 4, v0
  v_mov_b32 v4, v1
  v_add_u32 v5, 0x10000, v1
  v_add_u32 v6, 0x20000, v1
  s_mul_i32 s3, s26, 2048
  v_add_u32 v7, s3, v4
  v_add_u32 v8, s3, v5
  v_add_u32 v9, s3, v6
  s_lshl_b32 s3, s26, 1
  s_add_u32 s24, s24, s3
  s_lshl_b32 s37, s24, 10
  s_add_u32 s37, s37, 0x1a90000
  v_lshlrev_b32 v20, 6, v2
  v_lshl_add_u32 v20, v3, 4, v20
  s_mul_i32 s41, s33, 27
  s_mul_i32 s3, s34, 7
  s_add_u32 s41, s41, s3
  s_mul_i32 s40, s24, 55296
  s_add_u32 s40, s40, 0xc80000
  v_add_u32 v10, 55296, v1
  v_lshlrev_b32 v21, 4, v3
  v_add_u32 v21, 157696, v21
  s_mul_i32 s44, s25, 3072
  s_add_u32 s44, s44, s40
  s_mul_i32 s3, s33, 3
  s_add_u32 s3, s3, s34
  s_lshl_b32 s3, s3, 9
  s_add_u32 s45, s3, s40
  s_add_u32 s45, s45, 49152
  v_and_b32 v11, 1, v3
  v_mul_u32_u24 v11, 55296, v11
  v_lshl_add_u32 v11, v2, 4, v11
  v_lshrrev_b32 v12, 1, v3
  v_lshl_add_u32 v11, v12, 8, v11
  s_waitcnt lgkmcnt(0)
  s_mov_b32 s12, s8
  s_and_b32 s13, s9, 0xffff
  s_mov_b32 s14, 0x1b00000
  s_mov_b32 s15, 0x00020000
  s_barrier
  ds_read_b128 v[176:179], v7 offset:11264
  ds_read_b128 v[180:183], v7 offset:12288
  ds_read_b128 v[144:147], v4 offset:0
  ds_read_b128 v[148:151], v4 offset:1024
  ds_read_b128 v[152:155], v4 offset:2048
  ds_read_b128 v[156:159], v4 offset:3072
  ds_read_b128 v[160:163], v4 offset:4096
  ds_read_b128 v[164:167], v4 offset:5120
  s_waitcnt lgkmcnt(5)
  v_mfma_f32_16x16x32_bf16 v[32:35], v[144:147], v[176:179], 0
  v_mfma_f32_16x16x32_bf16 v[36:39], v[144:147], v[180:183], 0
  ds_read_b128 v[168:171], v4 offset:6144
  s_waitcnt lgkmcnt(5)
  v_mfma_f32_16x16x32_bf16 v[40:43], v[148:151], v[176:179], 0
  v_mfma_f32_16x16x32_bf16 v[44:47], v[148:151], v[180:183], 0
  ds_read_b128 v[172:175], v4 offset:7168
  s_waitcnt lgkmcnt(5)
  v_mfma_f32_16x16x32_bf16 v[48:51], v[152:155], v[176:179], 0
  v_mfma_f32_16x16x32_bf16 v[52:55], v[152:155], v[180:183], 0
  ds_read_b128 v[144:147], v4 offset:8192
  s_waitcnt lgkmcnt(5)
  v_mfma_f32_16x16x32_bf16 v[56:59], v[156:159], v[176:179], 0
  v_mfma_f32_16x16x32_bf16 v[60:63], v[156:159], v[180:183], 0
  ds_read_b128 v[148:151], v4 offset:9216
  s_waitcnt lgkmcnt(5)
  v_mfma_f32_16x16x32_bf16 v[64:67], v[160:163], v[176:179], 0
  v_mfma_f32_16x16x32_bf16 v[68:71], v[160:163], v[180:183], 0
  ds_read_b128 v[152:155], v4 offset:10240
  s_waitcnt lgkmcnt(5)
  v_mfma_f32_16x16x32_bf16 v[72:75], v[164:167], v[176:179], 0
  v_mfma_f32_16x16x32_bf16 v[76:79], v[164:167], v[180:183], 0
  ds_read_b128 v[156:159], v4 offset:19456
  s_waitcnt lgkmcnt(5)
  v_mfma_f32_16x16x32_bf16 v[80:83], v[168:171], v[176:179], 0
  v_mfma_f32_16x16x32_bf16 v[84:87], v[168:171], v[180:183], 0
  ds_read_b128 v[160:163], v4 offset:20480
  s_waitcnt lgkmcnt(5)
  v_mfma_f32_16x16x32_bf16 v[88:91], v[172:175], v[176:179], 0
  v_mfma_f32_16x16x32_bf16 v[92:95], v[172:175], v[180:183], 0
  ds_read_b128 v[164:167], v4 offset:21504
  s_waitcnt lgkmcnt(5)
  v_mfma_f32_16x16x32_bf16 v[96:99], v[144:147], v[176:179], 0
  v_mfma_f32_16x16x32_bf16 v[100:103], v[144:147], v[180:183], 0
  s_barrier
  ds_read_b128 v[184:187], v7 offset:33792
  s_waitcnt lgkmcnt(5)
  v_mfma_f32_16x16x32_bf16 v[104:107], v[148:151], v[176:179], 0
  v_mfma_f32_16x16x32_bf16 v[108:111], v[148:151], v[180:183], 0
  ds_read_b128 v[188:191], v7 offset:34816
  s_waitcnt lgkmcnt(5)
  v_mfma_f32_16x16x32_bf16 v[112:115], v[152:155], v[176:179], 0
  v_mfma_f32_16x16x32_bf16 v[116:119], v[152:155], v[180:183], 0
  ds_read_b128 v[168:171], v4 offset:22528
  s_waitcnt lgkmcnt(5)
  v_mfma_f32_16x16x32_bf16 v[120:123], v[156:159], v[176:179], 0
  v_mfma_f32_16x16x32_bf16 v[124:127], v[156:159], v[180:183], 0
  ds_read_b128 v[172:175], v4 offset:23552
  s_waitcnt lgkmcnt(5)
  v_mfma_f32_16x16x32_bf16 v[128:131], v[160:163], v[176:179], 0
  v_mfma_f32_16x16x32_bf16 v[132:135], v[160:163], v[180:183], 0
  ds_read_b128 v[144:147], v4 offset:24576
  s_waitcnt lgkmcnt(5)
  v_mfma_f32_16x16x32_bf16 v[136:139], v[164:167], v[176:179], 0
  v_mfma_f32_16x16x32_bf16 v[140:143], v[164:167], v[180:183], 0
  ds_read_b128 v[148:151], v4 offset:25600
  ds_read_b128 v[152:155], v4 offset:26624
  ds_read_b128 v[156:159], v4 offset:27648
  s_waitcnt lgkmcnt(5)
  v_mfma_f32_16x16x32_bf16 v[32:35], v[168:171], v[184:187], v[32:35]
  v_mfma_f32_16x16x32_bf16 v[36:39], v[168:171], v[188:191], v[36:39]
  ds_read_b128 v[160:163], v4 offset:28672
  s_waitcnt lgkmcnt(5)
  v_mfma_f32_16x16x32_bf16 v[40:43], v[172:175], v[184:187], v[40:43]
  v_mfma_f32_16x16x32_bf16 v[44:47], v[172:175], v[188:191], v[44:47]
  ds_read_b128 v[164:167], v4 offset:29696
  s_waitcnt lgkmcnt(5)
  v_mfma_f32_16x16x32_bf16 v[48:51], v[144:147], v[184:187], v[48:51]
  v_mfma_f32_16x16x32_bf16 v[52:55], v[144:147], v[188:191], v[52:55]
  ds_read_b128 v[168:171], v4 offset:30720
  s_waitcnt lgkmcnt(5)
  v_mfma_f32_16x16x32_bf16 v[56:59], v[148:151], v[184:187], v[56:59]
  v_mfma_f32_16x16x32_bf16 v[60:63], v[148:151], v[188:191], v[60:63]
  ds_read_b128 v[172:175], v4 offset:31744
  s_waitcnt lgkmcnt(5)
  v_mfma_f32_16x16x32_bf16 v[64:67], v[152:155], v[184:187], v[64:67]
  v_mfma_f32_16x16x32_bf16 v[68:71], v[152:155], v[188:191], v[68:71]
  ds_read_b128 v[144:147], v4 offset:32768
  s_waitcnt lgkmcnt(5)
  v_mfma_f32_16x16x32_bf16 v[72:75], v[156:159], v[184:187], v[72:75]
  v_mfma_f32_16x16x32_bf16 v[76:79], v[156:159], v[188:191], v[76:79]
  ds_read_b128 v[148:151], v4 offset:41984
  s_waitcnt lgkmcnt(5)
  v_mfma_f32_16x16x32_bf16 v[80:83], v[160:163], v[184:187], v[80:83]
  v_mfma_f32_16x16x32_bf16 v[84:87], v[160:163], v[188:191], v[84:87]
  ds_read_b128 v[152:155], v4 offset:43008
  s_waitcnt lgkmcnt(5)
  v_mfma_f32_16x16x32_bf16 v[88:91], v[164:167], v[184:187], v[88:91]
  v_mfma_f32_16x16x32_bf16 v[92:95], v[164:167], v[188:191], v[92:95]
  ds_read_b128 v[156:159], v4 offset:44032
  s_waitcnt lgkmcnt(5)
  v_mfma_f32_16x16x32_bf16 v[96:99], v[168:171], v[184:187], v[96:99]
  v_mfma_f32_16x16x32_bf16 v[100:103], v[168:171], v[188:191], v[100:103]
  s_barrier
  ds_read_b128 v[192:195], v7 offset:56320
  s_waitcnt lgkmcnt(5)
  v_mfma_f32_16x16x32_bf16 v[104:107], v[172:175], v[184:187], v[104:107]
  v_mfma_f32_16x16x32_bf16 v[108:111], v[172:175], v[188:191], v[108:111]
  ds_read_b128 v[196:199], v7 offset:57344
  s_waitcnt lgkmcnt(5)
  v_mfma_f32_16x16x32_bf16 v[112:115], v[144:147], v[184:187], v[112:115]
  v_mfma_f32_16x16x32_bf16 v[116:119], v[144:147], v[188:191], v[116:119]
  ds_read_b128 v[160:163], v4 offset:45056
  s_waitcnt lgkmcnt(5)
  v_mfma_f32_16x16x32_bf16 v[120:123], v[148:151], v[184:187], v[120:123]
  v_mfma_f32_16x16x32_bf16 v[124:127], v[148:151], v[188:191], v[124:127]
  ds_read_b128 v[164:167], v4 offset:46080
  s_waitcnt lgkmcnt(5)
  v_mfma_f32_16x16x32_bf16 v[128:131], v[152:155], v[184:187], v[128:131]
  v_mfma_f32_16x16x32_bf16 v[132:135], v[152:155], v[188:191], v[132:135]
  ds_read_b128 v[168:171], v4 offset:47104
  s_waitcnt lgkmcnt(5)
  v_mfma_f32_16x16x32_bf16 v[136:139], v[156:159], v[184:187], v[136:139]
  v_mfma_f32_16x16x32_bf16 v[140:143], v[156:159], v[188:191], v[140:143]
  ds_read_b128 v[172:175], v4 offset:48128
  ds_read_b128 v[144:147], v4 offset:49152
  ds_read_b128 v[148:151], v4 offset:50176
  s_waitcnt lgkmcnt(5)
  v_mfma_f32_16x16x32_bf16 v[32:35], v[160:163], v[192:195], v[32:35]
  v_mfma_f32_16x16x32_bf16 v[36:39], v[160:163], v[196:199], v[36:39]
  ds_read_b128 v[152:155], v4 offset:51200
  s_waitcnt lgkmcnt(5)
  v_mfma_f32_16x16x32_bf16 v[40:43], v[164:167], v[192:195], v[40:43]
  v_mfma_f32_16x16x32_bf16 v[44:47], v[164:167], v[196:199], v[44:47]
  ds_read_b128 v[156:159], v4 offset:52224
  s_waitcnt lgkmcnt(5)
  v_mfma_f32_16x16x32_bf16 v[48:51], v[168:171], v[192:195], v[48:51]
  v_mfma_f32_16x16x32_bf16 v[52:55], v[168:171], v[196:199], v[52:55]
  buffer_load_dwordx4 v[208:211], v20, s[12:15], s37 offen offset:0
  ds_read_b128 v[160:163], v4 offset:53248
  s_waitcnt lgkmcnt(5)
  v_mfma_f32_16x16x32_bf16 v[56:59], v[172:175], v[192:195], v[56:59]
  v_mfma_f32_16x16x32_bf16 v[60:63], v[172:175], v[196:199], v[60:63]
  ds_read_b128 v[164:167], v4 offset:54272
  s_waitcnt lgkmcnt(5)
  v_mfma_f32_16x16x32_bf16 v[64:67], v[144:147], v[192:195], v[64:67]
  v_mfma_f32_16x16x32_bf16 v[68:71], v[144:147], v[196:199], v[68:71]
  ds_read_b128 v[168:171], v4 offset:55296
  s_waitcnt lgkmcnt(5)
  v_mfma_f32_16x16x32_bf16 v[72:75], v[148:151], v[192:195], v[72:75]
  v_mfma_f32_16x16x32_bf16 v[76:79], v[148:151], v[196:199], v[76:79]
  ds_read_b128 v[172:175], v4 offset:64512
  s_waitcnt lgkmcnt(5)
  v_mfma_f32_16x16x32_bf16 v[80:83], v[152:155], v[192:195], v[80:83]
  v_mfma_f32_16x16x32_bf16 v[84:87], v[152:155], v[196:199], v[84:87]
  ds_read_b128 v[144:147], v5 offset:0
  s_waitcnt lgkmcnt(5)
  v_mfma_f32_16x16x32_bf16 v[88:91], v[156:159], v[192:195], v[88:91]
  v_mfma_f32_16x16x32_bf16 v[92:95], v[156:159], v[196:199], v[92:95]
  ds_read_b128 v[148:151], v5 offset:1024
  s_waitcnt lgkmcnt(5)
  v_mfma_f32_16x16x32_bf16 v[96:99], v[160:163], v[192:195], v[96:99]
  v_mfma_f32_16x16x32_bf16 v[100:103], v[160:163], v[196:199], v[100:103]
  buffer_load_dwordx4 v[212:215], v20, s[12:15], s37 offen offset:1024
  s_barrier
  ds_read_b128 v[200:203], v8 offset:13312
  s_waitcnt lgkmcnt(5)
  v_mfma_f32_16x16x32_bf16 v[104:107], v[164:167], v[192:195], v[104:107]
  v_mfma_f32_16x16x32_bf16 v[108:111], v[164:167], v[196:199], v[108:111]
  ds_read_b128 v[204:207], v8 offset:14336
  s_waitcnt lgkmcnt(5)
  v_mfma_f32_16x16x32_bf16 v[112:115], v[168:171], v[192:195], v[112:115]
  v_mfma_f32_16x16x32_bf16 v[116:119], v[168:171], v[196:199], v[116:119]
  ds_read_b128 v[152:155], v5 offset:2048
  s_waitcnt lgkmcnt(5)
  v_mfma_f32_16x16x32_bf16 v[120:123], v[172:175], v[192:195], v[120:123]
  v_mfma_f32_16x16x32_bf16 v[124:127], v[172:175], v[196:199], v[124:127]
  ds_read_b128 v[156:159], v5 offset:3072
  s_waitcnt lgkmcnt(5)
  v_mfma_f32_16x16x32_bf16 v[128:131], v[144:147], v[192:195], v[128:131]
  v_mfma_f32_16x16x32_bf16 v[132:135], v[144:147], v[196:199], v[132:135]
  ds_read_b128 v[160:163], v5 offset:4096
  s_waitcnt lgkmcnt(5)
  v_mfma_f32_16x16x32_bf16 v[136:139], v[148:151], v[192:195], v[136:139]
  v_mfma_f32_16x16x32_bf16 v[140:143], v[148:151], v[196:199], v[140:143]
  ds_read_b128 v[164:167], v5 offset:5120
  ds_read_b128 v[168:171], v5 offset:6144
  ds_read_b128 v[172:175], v5 offset:7168
  s_waitcnt lgkmcnt(5)
  v_mfma_f32_16x16x32_bf16 v[32:35], v[152:155], v[200:203], v[32:35]
  v_mfma_f32_16x16x32_bf16 v[36:39], v[152:155], v[204:207], v[36:39]
  ds_read_b128 v[144:147], v5 offset:8192
  s_waitcnt lgkmcnt(5)
  v_mfma_f32_16x16x32_bf16 v[40:43], v[156:159], v[200:203], v[40:43]
  v_mfma_f32_16x16x32_bf16 v[44:47], v[156:159], v[204:207], v[44:47]
  ds_read_b128 v[148:151], v5 offset:9216
  s_waitcnt lgkmcnt(5)
  v_mfma_f32_16x16x32_bf16 v[48:51], v[160:163], v[200:203], v[48:51]
  v_mfma_f32_16x16x32_bf16 v[52:55], v[160:163], v[204:207], v[52:55]
  ds_read_b128 v[152:155], v5 offset:10240
  s_waitcnt lgkmcnt(5)
  v_mfma_f32_16x16x32_bf16 v[56:59], v[164:167], v[200:203], v[56:59]
  v_mfma_f32_16x16x32_bf16 v[60:63], v[164:167], v[204:207], v[60:63]
  ds_read_b128 v[156:159], v5 offset:11264
  s_waitcnt lgkmcnt(5)
  v_mfma_f32_16x16x32_bf16 v[64:67], v[168:171], v[200:203], v[64:67]
  v_mfma_f32_16x16x32_bf16 v[68:71], v[168:171], v[204:207], v[68:71]
  ds_read_b128 v[160:163], v5 offset:12288
  s_waitcnt lgkmcnt(5)
  v_mfma_f32_16x16x32_bf16 v[72:75], v[172:175], v[200:203], v[72:75]
  v_mfma_f32_16x16x32_bf16 v[76:79], v[172:175], v[204:207], v[76:79]
  ds_read_b128 v[164:167], v5 offset:21504
  s_waitcnt lgkmcnt(5)
  v_mfma_f32_16x16x32_bf16 v[80:83], v[144:147], v[200:203], v[80:83]
  v_mfma_f32_16x16x32_bf16 v[84:87], v[144:147], v[204:207], v[84:87]
  ds_read_b128 v[168:171], v5 offset:22528
  s_waitcnt lgkmcnt(5)
  v_mfma_f32_16x16x32_bf16 v[88:91], v[148:151], v[200:203], v[88:91]
  v_mfma_f32_16x16x32_bf16 v[92:95], v[148:151], v[204:207], v[92:95]
  ds_read_b128 v[172:175], v5 offset:23552
  s_waitcnt lgkmcnt(5)
  v_mfma_f32_16x16x32_bf16 v[96:99], v[152:155], v[200:203], v[96:99]
  v_mfma_f32_16x16x32_bf16 v[100:103], v[152:155], v[204:207], v[100:103]
  s_barrier
  ds_read_b128 v[176:179], v8 offset:35840
  s_waitcnt lgkmcnt(5)
  v_mfma_f32_16x16x32_bf16 v[104:107], v[156:159], v[200:203], v[104:107]
  v_mfma_f32_16x16x32_bf16 v[108:111], v[156:159], v[204:207], v[108:111]
  ds_read_b128 v[180:183], v8 offset:36864
  s_waitcnt lgkmcnt(5)
  v_mfma_f32_16x16x32_bf16 v[112:115], v[160:163], v[200:203], v[112:115]
  v_mfma_f32_16x16x32_bf16 v[116:119], v[160:163], v[204:207], v[116:119]
  ds_read_b128 v[144:147], v5 offset:24576
  s_waitcnt lgkmcnt(5)
  v_mfma_f32_16x16x32_bf16 v[120:123], v[164:167], v[200:203], v[120:123]
  v_mfma_f32_16x16x32_bf16 v[124:127], v[164:167], v[204:207], v[124:127]
  ds_read_b128 v[148:151], v5 offset:25600
  s_waitcnt lgkmcnt(5)
  v_mfma_f32_16x16x32_bf16 v[128:131], v[168:171], v[200:203], v[128:131]
  v_mfma_f32_16x16x32_bf16 v[132:135], v[168:171], v[204:207], v[132:135]
  ds_read_b128 v[152:155], v5 offset:26624
  s_waitcnt lgkmcnt(5)
  v_mfma_f32_16x16x32_bf16 v[136:139], v[172:175], v[200:203], v[136:139]
  v_mfma_f32_16x16x32_bf16 v[140:143], v[172:175], v[204:207], v[140:143]
  ds_read_b128 v[156:159], v5 offset:27648
  ds_read_b128 v[160:163], v5 offset:28672
  ds_read_b128 v[164:167], v5 offset:29696
  s_waitcnt lgkmcnt(5)
  v_mfma_f32_16x16x32_bf16 v[32:35], v[144:147], v[176:179], v[32:35]
  v_mfma_f32_16x16x32_bf16 v[36:39], v[144:147], v[180:183], v[36:39]
  ds_read_b128 v[168:171], v5 offset:30720
  s_waitcnt lgkmcnt(5)
  v_mfma_f32_16x16x32_bf16 v[40:43], v[148:151], v[176:179], v[40:43]
  v_mfma_f32_16x16x32_bf16 v[44:47], v[148:151], v[180:183], v[44:47]
  ds_read_b128 v[172:175], v5 offset:31744
  s_waitcnt lgkmcnt(5)
  v_mfma_f32_16x16x32_bf16 v[48:51], v[152:155], v[176:179], v[48:51]
  v_mfma_f32_16x16x32_bf16 v[52:55], v[152:155], v[180:183], v[52:55]
  ds_read_b128 v[144:147], v5 offset:32768
  s_waitcnt lgkmcnt(5)
  v_mfma_f32_16x16x32_bf16 v[56:59], v[156:159], v[176:179], v[56:59]
  v_mfma_f32_16x16x32_bf16 v[60:63], v[156:159], v[180:183], v[60:63]
  ds_read_b128 v[148:151], v5 offset:33792
  s_waitcnt lgkmcnt(5)
  v_mfma_f32_16x16x32_bf16 v[64:67], v[160:163], v[176:179], v[64:67]
  v_mfma_f32_16x16x32_bf16 v[68:71], v[160:163], v[180:183], v[68:71]
  ds_read_b128 v[152:155], v5 offset:34816
  s_waitcnt lgkmcnt(5)
  v_mfma_f32_16x16x32_bf16 v[72:75], v[164:167], v[176:179], v[72:75]
  v_mfma_f32_16x16x32_bf16 v[76:79], v[164:167], v[180:183], v[76:79]
  ds_read_b128 v[156:159], v5 offset:44032
  s_waitcnt lgkmcnt(5)
  v_mfma_f32_16x16x32_bf16 v[80:83], v[168:171], v[176:179], v[80:83]
  v_mfma_f32_16x16x32_bf16 v[84:87], v[168:171], v[180:183], v[84:87]
  ds_read_b128 v[160:163], v5 offset:45056
  s_waitcnt lgkmcnt(5)
  v_mfma_f32_16x16x32_bf16 v[88:91], v[172:175], v[176:179], v[88:91]
  v_mfma_f32_16x16x32_bf16 v[92:95], v[172:175], v[180:183], v[92:95]
  ds_read_b128 v[164:167], v5 offset:46080
  s_waitcnt lgkmcnt(5)
  v_mfma_f32_16x16x32_bf16 v[96:99], v[144:147], v[176:179], v[96:99]
  v_mfma_f32_16x16x32_bf16 v[100:103], v[144:147], v[180:183], v[100:103]
  s_barrier
  ds_read_b128 v[184:187], v8 offset:58368
  s_waitcnt lgkmcnt(5)
  v_mfma_f32_16x16x32_bf16 v[104:107], v[148:151], v[176:179], v[104:107]
  v_mfma_f32_16x16x32_bf16 v[108:111], v[148:151], v[180:183], v[108:111]
  ds_read_b128 v[188:191], v8 offset:59392
  s_waitcnt lgkmcnt(5)
  v_mfma_f32_16x16x32_bf16 v[112:115], v[152:155], v[176:179], v[112:115]
  v_mfma_f32_16x16x32_bf16 v[116:119], v[152:155], v[180:183], v[116:119]
  ds_read_b128 v[168:171], v5 offset:47104
  s_waitcnt lgkmcnt(5)
  v_mfma_f32_16x16x32_bf16 v[120:123], v[156:159], v[176:179], v[120:123]
  v_mfma_f32_16x16x32_bf16 v[124:127], v[156:159], v[180:183], v[124:127]
  ds_read_b128 v[172:175], v5 offset:48128
  s_waitcnt lgkmcnt(5)
  v_mfma_f32_16x16x32_bf16 v[128:131], v[160:163], v[176:179], v[128:131]
  v_mfma_f32_16x16x32_bf16 v[132:135], v[160:163], v[180:183], v[132:135]
  ds_read_b128 v[144:147], v5 offset:49152
  s_waitcnt lgkmcnt(5)
  v_mfma_f32_16x16x32_bf16 v[136:139], v[164:167], v[176:179], v[136:139]
  v_mfma_f32_16x16x32_bf16 v[140:143], v[164:167], v[180:183], v[140:143]
  ds_read_b128 v[148:151], v5 offset:50176
  ds_read_b128 v[152:155], v5 offset:51200
  ds_read_b128 v[156:159], v5 offset:52224
  s_waitcnt lgkmcnt(5)
  v_mfma_f32_16x16x32_bf16 v[32:35], v[168:171], v[184:187], v[32:35]
  v_mfma_f32_16x16x32_bf16 v[36:39], v[168:171], v[188:191], v[36:39]
  ds_read_b128 v[160:163], v5 offset:53248
  s_waitcnt lgkmcnt(5)
  v_mfma_f32_16x16x32_bf16 v[40:43], v[172:175], v[184:187], v[40:43]
  v_mfma_f32_16x16x32_bf16 v[44:47], v[172:175], v[188:191], v[44:47]
  ds_read_b128 v[164:167], v5 offset:54272
  s_waitcnt lgkmcnt(5)
  v_mfma_f32_16x16x32_bf16 v[48:51], v[144:147], v[184:187], v[48:51]
  v_mfma_f32_16x16x32_bf16 v[52:55], v[144:147], v[188:191], v[52:55]
  ds_read_b128 v[168:171], v5 offset:55296
  s_waitcnt lgkmcnt(5)
  v_mfma_f32_16x16x32_bf16 v[56:59], v[148:151], v[184:187], v[56:59]
  v_mfma_f32_16x16x32_bf16 v[60:63], v[148:151], v[188:191], v[60:63]
  ds_read_b128 v[172:175], v5 offset:56320
  s_waitcnt lgkmcnt(5)
  v_mfma_f32_16x16x32_bf16 v[64:67], v[152:155], v[184:187], v[64:67]
  v_mfma_f32_16x16x32_bf16 v[68:71], v[152:155], v[188:191], v[68:71]
  ds_read_b128 v[144:147], v5 offset:57344
  s_waitcnt lgkmcnt(5)
  v_mfma_f32_16x16x32_bf16 v[72:75], v[156:159], v[184:187], v[72:75]
  v_mfma_f32_16x16x32_bf16 v[76:79], v[156:159], v[188:191], v[76:79]
  ds_read_b128 v[148:151], v6 offset:1024
  s_waitcnt lgkmcnt(5)
  v_mfma_f32_16x16x32_bf16 v[80:83], v[160:163], v[184:187], v[80:83]
  v_mfma_f32_16x16x32_bf16 v[84:87], v[160:163], v[188:191], v[84:87]
  ds_read_b128 v[152:155], v6 offset:2048
  s_waitcnt lgkmcnt(5)
  v_mfma_f32_16x16x32_bf16 v[88:91], v[164:167], v[184:187], v[88:91]
  v_mfma_f32_16x16x32_bf16 v[92:95], v[164:167], v[188:191], v[92:95]
  ds_read_b128 v[156:159], v6 offset:3072
  s_waitcnt lgkmcnt(5)
  v_mfma_f32_16x16x32_bf16 v[96:99], v[168:171], v[184:187], v[96:99]
  v_mfma_f32_16x16x32_bf16 v[100:103], v[168:171], v[188:191], v[100:103]
  s_barrier
  ds_read_b128 v[192:195], v9 offset:15360
  s_waitcnt lgkmcnt(5)
  v_mfma_f32_16x16x32_bf16 v[104:107], v[172:175], v[184:187], v[104:107]
  v_mfma_f32_16x16x32_bf16 v[108:111], v[172:175], v[188:191], v[108:111]
  ds_read_b128 v[196:199], v9 offset:16384
  s_waitcnt lgkmcnt(5)
  v_mfma_f32_16x16x32_bf16 v[112:115], v[144:147], v[184:187], v[112:115]
  v_mfma_f32_16x16x32_bf16 v[116:119], v[144:147], v[188:191], v[116:119]
  ds_read_b128 v[160:163], v6 offset:4096
  s_waitcnt lgkmcnt(5)
  v_mfma_f32_16x16x32_bf16 v[120:123], v[148:151], v[184:187], v[120:123]
  v_mfma_f32_16x16x32_bf16 v[124:127], v[148:151], v[188:191], v[124:127]
  ds_read_b128 v[164:167], v6 offset:5120
  s_waitcnt lgkmcnt(5)
  v_mfma_f32_16x16x32_bf16 v[128:131], v[152:155], v[184:187], v[128:131]
  v_mfma_f32_16x16x32_bf16 v[132:135], v[152:155], v[188:191], v[132:135]
  ds_read_b128 v[168:171], v6 offset:6144
  s_waitcnt lgkmcnt(5)
  v_mfma_f32_16x16x32_bf16 v[136:139], v[156:159], v[184:187], v[136:139]
  v_mfma_f32_16x16x32_bf16 v[140:143], v[156:159], v[188:191], v[140:143]
  ds_read_b128 v[172:175], v6 offset:7168
  ds_read_b128 v[144:147], v6 offset:8192
  ds_read_b128 v[148:151], v6 offset:9216
  s_waitcnt lgkmcnt(5)
  v_mfma_f32_16x16x32_bf16 v[32:35], v[160:163], v[192:195], v[32:35]
  v_mfma_f32_16x16x32_bf16 v[36:39], v[160:163], v[196:199], v[36:39]
  ds_read_b128 v[152:155], v6 offset:10240
  s_waitcnt lgkmcnt(5)
  v_mfma_f32_16x16x32_bf16 v[40:43], v[164:167], v[192:195], v[40:43]
  v_mfma_f32_16x16x32_bf16 v[44:47], v[164:167], v[196:199], v[44:47]
  ds_read_b128 v[156:159], v6 offset:11264
  s_waitcnt lgkmcnt(5)
  v_mfma_f32_16x16x32_bf16 v[48:51], v[168:171], v[192:195], v[48:51]
  v_mfma_f32_16x16x32_bf16 v[52:55], v[168:171], v[196:199], v[52:55]
  ds_read_b128 v[160:163], v6 offset:12288
  s_waitcnt lgkmcnt(5)
  v_mfma_f32_16x16x32_bf16 v[56:59], v[172:175], v[192:195], v[56:59]
  v_mfma_f32_16x16x32_bf16 v[60:63], v[172:175], v[196:199], v[60:63]
  ds_read_b128 v[164:167], v6 offset:13312
  s_waitcnt lgkmcnt(5)
  v_mfma_f32_16x16x32_bf16 v[64:67], v[144:147], v[192:195], v[64:67]
  v_mfma_f32_16x16x32_bf16 v[68:71], v[144:147], v[196:199], v[68:71]
  ds_read_b128 v[168:171], v6 offset:14336
  s_waitcnt lgkmcnt(5)
  v_mfma_f32_16x16x32_bf16 v[72:75], v[148:151], v[192:195], v[72:75]
  v_mfma_f32_16x16x32_bf16 v[76:79], v[148:151], v[196:199], v[76:79]
  ds_read_b128 v[172:175], v6 offset:23552
  s_waitcnt lgkmcnt(5)
  v_mfma_f32_16x16x32_bf16 v[80:83], v[152:155], v[192:195], v[80:83]
  v_mfma_f32_16x16x32_bf16 v[84:87], v[152:155], v[196:199], v[84:87]
  ds_read_b128 v[144:147], v6 offset:24576
  s_waitcnt lgkmcnt(5)
  v_mfma_f32_16x16x32_bf16 v[88:91], v[156:159], v[192:195], v[88:91]
  v_mfma_f32_16x16x32_bf16 v[92:95], v[156:159], v[196:199], v[92:95]
  ds_read_b128 v[148:151], v6 offset:25600
  s_waitcnt lgkmcnt(5)
  v_mfma_f32_16x16x32_bf16 v[96:99], v[160:163], v[192:195], v[96:99]
  v_mfma_f32_16x16x32_bf16 v[100:103], v[160:163], v[196:199], v[100:103]
  s_barrier
  ds_read_b128 v[200:203], v7 offset:11264
  s_waitcnt lgkmcnt(5)
  v_mfma_f32_16x16x32_bf16 v[104:107], v[164:167], v[192:195], v[104:107]
  v_mfma_f32_16x16x32_bf16 v[108:111], v[164:167], v[196:199], v[108:111]
  ds_read_b128 v[204:207], v7 offset:12288
  s_waitcnt lgkmcnt(5)
  v_mfma_f32_16x16x32_bf16 v[112:115], v[168:171], v[192:195], v[112:115]
  v_mfma_f32_16x16x32_bf16 v[116:119], v[168:171], v[196:199], v[116:119]
  ds_read_b128 v[152:155], v4 offset:0
  s_waitcnt lgkmcnt(5)
  v_mfma_f32_16x16x32_bf16 v[120:123], v[172:175], v[192:195], v[120:123]
  v_mfma_f32_16x16x32_bf16 v[124:127], v[172:175], v[196:199], v[124:127]
  ds_read_b128 v[156:159], v4 offset:1024
  s_waitcnt lgkmcnt(5)
  v_mfma_f32_16x16x32_bf16 v[128:131], v[144:147], v[192:195], v[128:131]
  v_mfma_f32_16x16x32_bf16 v[132:135], v[144:147], v[196:199], v[132:135]
  ds_read_b128 v[160:163], v4 offset:2048
  s_waitcnt lgkmcnt(5)
  v_mfma_f32_16x16x32_bf16 v[136:139], v[148:151], v[192:195], v[136:139]
  v_mfma_f32_16x16x32_bf16 v[140:143], v[148:151], v[196:199], v[140:143]
  ds_read_b128 v[164:167], v4 offset:3072
  ds_read_b128 v[168:171], v4 offset:4096
  ds_read_b128 v[172:175], v4 offset:5120
  s_waitcnt lgkmcnt(5)
  v_mfma_f32_16x16x32_bf16 v[32:35], v[152:155], v[200:203], v[32:35]
  v_mfma_f32_16x16x32_bf16 v[36:39], v[152:155], v[204:207], v[36:39]
  ds_read_b128 v[144:147], v4 offset:6144
  s_waitcnt lgkmcnt(5)
  v_mfma_f32_16x16x32_bf16 v[40:43], v[156:159], v[200:203], v[40:43]
  v_mfma_f32_16x16x32_bf16 v[44:47], v[156:159], v[204:207], v[44:47]
  ds_read_b128 v[148:151], v4 offset:7168
  s_waitcnt lgkmcnt(5)
  v_mfma_f32_16x16x32_bf16 v[48:51], v[160:163], v[200:203], v[48:51]
  v_mfma_f32_16x16x32_bf16 v[52:55], v[160:163], v[204:207], v[52:55]
  ds_read_b128 v[152:155], v4 offset:8192
  s_waitcnt lgkmcnt(5)
  v_mfma_f32_16x16x32_bf16 v[56:59], v[164:167], v[200:203], v[56:59]
  v_mfma_f32_16x16x32_bf16 v[60:63], v[164:167], v[204:207], v[60:63]
  ds_read_b128 v[156:159], v4 offset:9216
  s_waitcnt lgkmcnt(5)
  v_mfma_f32_16x16x32_bf16 v[64:67], v[168:171], v[200:203], v[64:67]
  v_mfma_f32_16x16x32_bf16 v[68:71], v[168:171], v[204:207], v[68:71]
  ds_read_b128 v[160:163], v4 offset:10240
  s_waitcnt lgkmcnt(5)
  v_mfma_f32_16x16x32_bf16 v[72:75], v[172:175], v[200:203], v[72:75]
  v_mfma_f32_16x16x32_bf16 v[76:79], v[172:175], v[204:207], v[76:79]
  ds_read_b128 v[164:167], v4 offset:19456
  s_waitcnt lgkmcnt(5)
  v_mfma_f32_16x16x32_bf16 v[80:83], v[144:147], v[200:203], v[80:83]
  v_mfma_f32_16x16x32_bf16 v[84:87], v[144:147], v[204:207], v[84:87]
  ds_read_b128 v[168:171], v4 offset:20480
  s_waitcnt lgkmcnt(5)
  v_mfma_f32_16x16x32_bf16 v[88:91], v[148:151], v[200:203], v[88:91]
  v_mfma_f32_16x16x32_bf16 v[92:95], v[148:151], v[204:207], v[92:95]
  ds_read_b128 v[172:175], v4 offset:21504
  s_waitcnt lgkmcnt(5)
  v_mfma_f32_16x16x32_bf16 v[96:99], v[152:155], v[200:203], v[96:99]
  v_mfma_f32_16x16x32_bf16 v[100:103], v[152:155], v[204:207], v[100:103]
  s_barrier
  ds_read_b128 v[176:179], v7 offset:33792
  s_waitcnt lgkmcnt(5)
  v_mfma_f32_16x16x32_bf16 v[104:107], v[156:159], v[200:203], v[104:107]
  v_mfma_f32_16x16x32_bf16 v[108:111], v[156:159], v[204:207], v[108:111]
  ds_read_b128 v[180:183], v7 offset:34816
  s_waitcnt lgkmcnt(5)
  v_mfma_f32_16x16x32_bf16 v[112:115], v[160:163], v[200:203], v[112:115]
  v_mfma_f32_16x16x32_bf16 v[116:119], v[160:163], v[204:207], v[116:119]
  ds_read_b128 v[144:147], v4 offset:22528
  s_waitcnt lgkmcnt(5)
  v_mfma_f32_16x16x32_bf16 v[120:123], v[164:167], v[200:203], v[120:123]
  v_mfma_f32_16x16x32_bf16 v[124:127], v[164:167], v[204:207], v[124:127]
  ds_read_b128 v[148:151], v4 offset:23552
  s_waitcnt lgkmcnt(5)
  v_mfma_f32_16x16x32_bf16 v[128:131], v[168:171], v[200:203], v[128:131]
  v_mfma_f32_16x16x32_bf16 v[132:135], v[168:171], v[204:207], v[132:135]
  ds_read_b128 v[152:155], v4 offset:24576
  s_waitcnt lgkmcnt(5)
  v_mfma_f32_16x16x32_bf16 v[136:139], v[172:175], v[200:203], v[136:139]
  v_mfma_f32_16x16x32_bf16 v[140:143], v[172:175], v[204:207], v[140:143]
  ds_read_b128 v[156:159], v4 offset:25600
  ds_read_b128 v[160:163], v4 offset:26624
  ds_read_b128 v[164:167], v4 offset:27648
  s_waitcnt lgkmcnt(5)
  v_mfma_f32_16x16x32_bf16 v[32:35], v[144:147], v[176:179], v[32:35]
  v_mfma_f32_16x16x32_bf16 v[36:39], v[144:147], v[180:183], v[36:39]
  ds_read_b128 v[168:171], v4 offset:28672
  s_waitcnt lgkmcnt(5)
  v_mfma_f32_16x16x32_bf16 v[40:43], v[148:151], v[176:179], v[40:43]
  v_mfma_f32_16x16x32_bf16 v[44:47], v[148:151], v[180:183], v[44:47]
  ds_read_b128 v[172:175], v4 offset:29696
  s_waitcnt lgkmcnt(5)
  v_mfma_f32_16x16x32_bf16 v[48:51], v[152:155], v[176:179], v[48:51]
  v_mfma_f32_16x16x32_bf16 v[52:55], v[152:155], v[180:183], v[52:55]
  ds_read_b128 v[144:147], v4 offset:30720
  s_waitcnt lgkmcnt(5)
  v_mfma_f32_16x16x32_bf16 v[56:59], v[156:159], v[176:179], v[56:59]
  v_mfma_f32_16x16x32_bf16 v[60:63], v[156:159], v[180:183], v[60:63]
  ds_read_b128 v[148:151], v4 offset:31744
  s_waitcnt lgkmcnt(5)
  v_mfma_f32_16x16x32_bf16 v[64:67], v[160:163], v[176:179], v[64:67]
  v_mfma_f32_16x16x32_bf16 v[68:71], v[160:163], v[180:183], v[68:71]
  ds_read_b128 v[152:155], v4 offset:32768
  s_waitcnt lgkmcnt(5)
  v_mfma_f32_16x16x32_bf16 v[72:75], v[164:167], v[176:179], v[72:75]
  v_mfma_f32_16x16x32_bf16 v[76:79], v[164:167], v[180:183], v[76:79]
  ds_read_b128 v[156:159], v4 offset:41984
  s_waitcnt lgkmcnt(5)
  v_mfma_f32_16x16x32_bf16 v[80:83], v[168:171], v[176:179], v[80:83]
  v_mfma_f32_16x16x32_bf16 v[84:87], v[168:171], v[180:183], v[84:87]
  ds_read_b128 v[160:163], v4 offset:43008
  s_waitcnt lgkmcnt(5)
  v_mfma_f32_16x16x32_bf16 v[88:91], v[172:175], v[176:179], v[88:91]
  v_mfma_f32_16x16x32_bf16 v[92:95], v[172:175], v[180:183], v[92:95]
  ds_read_b128 v[164:167], v4 offset:44032
  s_waitcnt lgkmcnt(5)
  v_mfma_f32_16x16x32_bf16 v[96:99], v[144:147], v[176:179], v[96:99]
  v_mfma_f32_16x16x32_bf16 v[100:103], v[144:147], v[180:183], v[100:103]
  s_waitcnt vmcnt(0)
  v_add_f32 v22, v208, v210
  v_add_f32 v23, v212, v214
  v_mov_b32 v24, v22
  v_mov_b32 v25, v23
  s_nop 0
  v_permlane16_swap_b32 v22, v24
  v_permlane16_swap_b32 v23, v25
  s_nop 0
  v_add_f32 v22, v22, v24
  v_add_f32 v23, v23, v25
  v_mov_b32 v24, v22
  v_mov_b32 v25, v23
  s_nop 0
  v_permlane32_swap_b32 v22, v24
  v_permlane32_swap_b32 v23, v25
  s_nop 0
  v_add_f32 v22, v22, v24
  v_add_f32 v23, v23, v25
  v_mul_f32 v22, 0xbacccccd, v22
  v_mul_f32 v23, 0xbacccccd, v23
  s_barrier
  ds_read_b128 v[184:187], v7 offset:56320
  s_waitcnt lgkmcnt(5)
  v_mfma_f32_16x16x32_bf16 v[104:107], v[148:151], v[176:179], v[104:107]
  v_mfma_f32_16x16x32_bf16 v[108:111], v[148:151], v[180:183], v[108:111]
  ds_read_b128 v[188:191], v7 offset:57344
  s_waitcnt lgkmcnt(5)
  v_mfma_f32_16x16x32_bf16 v[112:115], v[152:155], v[176:179], v[112:115]
  v_mfma_f32_16x16x32_bf16 v[116:119], v[152:155], v[180:183], v[116:119]
  ds_read_b128 v[168:171], v4 offset:45056
  s_waitcnt lgkmcnt(5)
  v_mfma_f32_16x16x32_bf16 v[120:123], v[156:159], v[176:179], v[120:123]
  v_mfma_f32_16x16x32_bf16 v[124:127], v[156:159], v[180:183], v[124:127]
  ds_read_b128 v[172:175], v4 offset:46080
  s_waitcnt lgkmcnt(5)
  v_mfma_f32_16x16x32_bf16 v[128:131], v[160:163], v[176:179], v[128:131]
  v_mfma_f32_16x16x32_bf16 v[132:135], v[160:163], v[180:183], v[132:135]
  ds_read_b128 v[144:147], v4 offset:47104
  s_waitcnt lgkmcnt(5)
  v_mfma_f32_16x16x32_bf16 v[136:139], v[164:167], v[176:179], v[136:139]
  v_mfma_f32_16x16x32_bf16 v[140:143], v[164:167], v[180:183], v[140:143]
  ds_read_b128 v[148:151], v4 offset:48128
  ds_read_b128 v[152:155], v4 offset:49152
  ds_read_b128 v[156:159], v4 offset:50176
  s_waitcnt lgkmcnt(5)
  v_mfma_f32_16x16x32_bf16 v[32:35], v[168:171], v[184:187], v[32:35]
  v_mfma_f32_16x16x32_bf16 v[36:39], v[168:171], v[188:191], v[36:39]
  ds_read_b128 v[160:163], v4 offset:51200
  s_waitcnt lgkmcnt(5)
  v_mfma_f32_16x16x32_bf16 v[40:43], v[172:175], v[184:187], v[40:43]
  v_mfma_f32_16x16x32_bf16 v[44:47], v[172:175], v[188:191], v[44:47]
  ds_read_b128 v[164:167], v4 offset:52224
  s_waitcnt lgkmcnt(5)
  v_mfma_f32_16x16x32_bf16 v[48:51], v[144:147], v[184:187], v[48:51]
  v_mfma_f32_16x16x32_bf16 v[52:55], v[144:147], v[188:191], v[52:55]
  ds_read_b128 v[168:171], v4 offset:53248
  s_waitcnt lgkmcnt(5)
  v_mfma_f32_16x16x32_bf16 v[56:59], v[148:151], v[184:187], v[56:59]
  v_mfma_f32_16x16x32_bf16 v[60:63], v[148:151], v[188:191], v[60:63]
  ds_read_b128 v[172:175], v4 offset:54272
  s_waitcnt lgkmcnt(5)
  v_mfma_f32_16x16x32_bf16 v[64:67], v[152:155], v[184:187], v[64:67]
  v_mfma_f32_16x16x32_bf16 v[68:71], v[152:155], v[188:191], v[68:71]
  ds_read_b128 v[144:147], v4 offset:55296
  s_waitcnt lgkmcnt(5)
  v_mfma_f32_16x16x32_bf16 v[72:75], v[156:159], v[184:187], v[72:75]
  v_mfma_f32_16x16x32_bf16 v[76:79], v[156:159], v[188:191], v[76:79]
  ds_read_b128 v[148:151], v4 offset:64512
  s_waitcnt lgkmcnt(5)
  v_mfma_f32_16x16x32_bf16 v[80:83], v[160:163], v[184:187], v[80:83]
  v_mfma_f32_16x16x32_bf16 v[84:87], v[160:163], v[188:191], v[84:87]
  ds_read_b128 v[152:155], v5 offset:0
  s_waitcnt lgkmcnt(5)
  v_mfma_f32_16x16x32_bf16 v[88:91], v[164:167], v[184:187], v[88:91]
  v_mfma_f32_16x16x32_bf16 v[92:95], v[164:167], v[188:191], v[92:95]
  ds_read_b128 v[156:159], v5 offset:1024
  s_waitcnt lgkmcnt(5)
  v_mfma_f32_16x16x32_bf16 v[96:99], v[168:171], v[184:187], v[96:99]
  v_mfma_f32_16x16x32_bf16 v[100:103], v[168:171], v[188:191], v[100:103]
  s_barrier
  ds_read_b128 v[192:195], v8 offset:13312
  s_waitcnt lgkmcnt(5)
  v_mfma_f32_16x16x32_bf16 v[104:107], v[172:175], v[184:187], v[104:107]
  v_mfma_f32_16x16x32_bf16 v[108:111], v[172:175], v[188:191], v[108:111]
  ds_read_b128 v[196:199], v8 offset:14336
  s_waitcnt lgkmcnt(5)
  v_mfma_f32_16x16x32_bf16 v[112:115], v[144:147], v[184:187], v[112:115]
  v_mfma_f32_16x16x32_bf16 v[116:119], v[144:147], v[188:191], v[116:119]
  ds_read_b128 v[160:163], v5 offset:2048
  s_waitcnt lgkmcnt(5)
  v_mfma_f32_16x16x32_bf16 v[120:123], v[148:151], v[184:187], v[120:123]
  v_mfma_f32_16x16x32_bf16 v[124:127], v[148:151], v[188:191], v[124:127]
  ds_read_b128 v[164:167], v5 offset:3072
  s_waitcnt lgkmcnt(5)
  v_mfma_f32_16x16x32_bf16 v[128:131], v[152:155], v[184:187], v[128:131]
  v_mfma_f32_16x16x32_bf16 v[132:135], v[152:155], v[188:191], v[132:135]
  ds_read_b128 v[168:171], v5 offset:4096
  s_waitcnt lgkmcnt(5)
  v_mfma_f32_16x16x32_bf16 v[136:139], v[156:159], v[184:187], v[136:139]
  v_mfma_f32_16x16x32_bf16 v[140:143], v[156:159], v[188:191], v[140:143]
  ds_read_b128 v[172:175], v5 offset:5120
  ds_read_b128 v[144:147], v5 offset:6144
  ds_read_b128 v[148:151], v5 offset:7168
  s_waitcnt lgkmcnt(5)
  v_mfma_f32_16x16x32_bf16 v[32:35], v[160:163], v[192:195], v[32:35]
  v_mfma_f32_16x16x32_bf16 v[36:39], v[160:163], v[196:199], v[36:39]
  ds_read_b128 v[152:155], v5 offset:8192
  s_waitcnt lgkmcnt(5)
  v_mfma_f32_16x16x32_bf16 v[40:43], v[164:167], v[192:195], v[40:43]
  v_mfma_f32_16x16x32_bf16 v[44:47], v[164:167], v[196:199], v[44:47]
  ds_read_b128 v[156:159], v5 offset:9216
  s_waitcnt lgkmcnt(5)
  v_mfma_f32_16x16x32_bf16 v[48:51], v[168:171], v[192:195], v[48:51]
  v_mfma_f32_16x16x32_bf16 v[52:55], v[168:171], v[196:199], v[52:55]
  ds_read_b128 v[160:163], v5 offset:10240
  s_waitcnt lgkmcnt(5)
  v_mfma_f32_16x16x32_bf16 v[56:59], v[172:175], v[192:195], v[56:59]
  v_mfma_f32_16x16x32_bf16 v[60:63], v[172:175], v[196:199], v[60:63]
  ds_read_b128 v[164:167], v5 offset:11264
  s_waitcnt lgkmcnt(5)
  v_mfma_f32_16x16x32_bf16 v[64:67], v[144:147], v[192:195], v[64:67]
  v_mfma_f32_16x16x32_bf16 v[68:71], v[144:147], v[196:199], v[68:71]
  ds_read_b128 v[168:171], v5 offset:12288
  s_waitcnt lgkmcnt(5)
  v_mfma_f32_16x16x32_bf16 v[72:75], v[148:151], v[192:195], v[72:75]
  v_mfma_f32_16x16x32_bf16 v[76:79], v[148:151], v[196:199], v[76:79]
  ds_read_b128 v[172:175], v5 offset:21504
  s_waitcnt lgkmcnt(5)
  v_mfma_f32_16x16x32_bf16 v[80:83], v[152:155], v[192:195], v[80:83]
  v_mfma_f32_16x16x32_bf16 v[84:87], v[152:155], v[196:199], v[84:87]
  ds_read_b128 v[144:147], v5 offset:22528
  s_waitcnt lgkmcnt(5)
  v_mfma_f32_16x16x32_bf16 v[88:91], v[156:159], v[192:195], v[88:91]
  v_mfma_f32_16x16x32_bf16 v[92:95], v[156:159], v[196:199], v[92:95]
  ds_read_b128 v[148:151], v5 offset:23552
  s_waitcnt lgkmcnt(5)
  v_mfma_f32_16x16x32_bf16 v[96:99], v[160:163], v[192:195], v[96:99]
  v_mfma_f32_16x16x32_bf16 v[100:103], v[160:163], v[196:199], v[100:103]
  s_barrier
  ds_read_b128 v[200:203], v8 offset:35840
  s_waitcnt lgkmcnt(5)
  v_mfma_f32_16x16x32_bf16 v[104:107], v[164:167], v[192:195], v[104:107]
  v_mfma_f32_16x16x32_bf16 v[108:111], v[164:167], v[196:199], v[108:111]
  ds_read_b128 v[204:207], v8 offset:36864
  s_waitcnt lgkmcnt(5)
  v_mfma_f32_16x16x32_bf16 v[112:115], v[168:171], v[192:195], v[112:115]
  v_mfma_f32_16x16x32_bf16 v[116:119], v[168:171], v[196:199], v[116:119]
  ds_read_b128 v[152:155], v5 offset:24576
  s_waitcnt lgkmcnt(5)
  v_mfma_f32_16x16x32_bf16 v[120:123], v[172:175], v[192:195], v[120:123]
  v_mfma_f32_16x16x32_bf16 v[124:127], v[172:175], v[196:199], v[124:127]
  ds_read_b128 v[156:159], v5 offset:25600
  s_waitcnt lgkmcnt(5)
  v_mfma_f32_16x16x32_bf16 v[128:131], v[144:147], v[192:195], v[128:131]
  v_mfma_f32_16x16x32_bf16 v[132:135], v[144:147], v[196:199], v[132:135]
  ds_read_b128 v[160:163], v5 offset:26624
  s_waitcnt lgkmcnt(5)
  v_mfma_f32_16x16x32_bf16 v[136:139], v[148:151], v[192:195], v[136:139]
  v_mfma_f32_16x16x32_bf16 v[140:143], v[148:151], v[196:199], v[140:143]
  ds_read_b128 v[164:167], v5 offset:27648
  ds_read_b128 v[168:171], v5 offset:28672
  ds_read_b128 v[172:175], v5 offset:29696
  s_waitcnt lgkmcnt(5)
  v_mfma_f32_16x16x32_bf16 v[32:35], v[152:155], v[200:203], v[32:35]
  v_mfma_f32_16x16x32_bf16 v[36:39], v[152:155], v[204:207], v[36:39]
  ds_read_b128 v[144:147], v5 offset:30720
  s_waitcnt lgkmcnt(5)
  v_mfma_f32_16x16x32_bf16 v[40:43], v[156:159], v[200:203], v[40:43]
  v_mfma_f32_16x16x32_bf16 v[44:47], v[156:159], v[204:207], v[44:47]
  ds_read_b128 v[148:151], v5 offset:31744
  s_waitcnt lgkmcnt(5)
  v_mfma_f32_16x16x32_bf16 v[48:51], v[160:163], v[200:203], v[48:51]
  v_mfma_f32_16x16x32_bf16 v[52:55], v[160:163], v[204:207], v[52:55]
  ds_read_b128 v[152:155], v5 offset:32768
  s_waitcnt lgkmcnt(5)
  v_mfma_f32_16x16x32_bf16 v[56:59], v[164:167], v[200:203], v[56:59]
  v_mfma_f32_16x16x32_bf16 v[60:63], v[164:167], v[204:207], v[60:63]
  ds_read_b128 v[156:159], v5 offset:33792
  s_waitcnt lgkmcnt(5)
  v_mfma_f32_16x16x32_bf16 v[64:67], v[168:171], v[200:203], v[64:67]
  v_mfma_f32_16x16x32_bf16 v[68:71], v[168:171], v[204:207], v[68:71]
  ds_read_b128 v[160:163], v5 offset:34816
  s_waitcnt lgkmcnt(5)
  v_mfma_f32_16x16x32_bf16 v[72:75], v[172:175], v[200:203], v[72:75]
  v_mfma_f32_16x16x32_bf16 v[76:79], v[172:175], v[204:207], v[76:79]
  ds_read_b128 v[164:167], v5 offset:44032
  s_waitcnt lgkmcnt(5)
  v_mfma_f32_16x16x32_bf16 v[80:83], v[144:147], v[200:203], v[80:83]
  v_mfma_f32_16x16x32_bf16 v[84:87], v[144:147], v[204:207], v[84:87]
  ds_read_b128 v[168:171], v5 offset:45056
  s_waitcnt lgkmcnt(5)
  v_mfma_f32_16x16x32_bf16 v[88:91], v[148:151], v[200:203], v[88:91]
  v_mfma_f32_16x16x32_bf16 v[92:95], v[148:151], v[204:207], v[92:95]
  ds_read_b128 v[172:175], v5 offset:46080
  s_waitcnt lgkmcnt(5)
  v_mfma_f32_16x16x32_bf16 v[96:99], v[152:155], v[200:203], v[96:99]
  v_mfma_f32_16x16x32_bf16 v[100:103], v[152:155], v[204:207], v[100:103]
  s_barrier
  ds_read_b128 v[176:179], v8 offset:58368
  s_waitcnt lgkmcnt(5)
  v_mfma_f32_16x16x32_bf16 v[104:107], v[156:159], v[200:203], v[104:107]
  v_mfma_f32_16x16x32_bf16 v[108:111], v[156:159], v[204:207], v[108:111]
  ds_read_b128 v[180:183], v8 offset:59392
  s_waitcnt lgkmcnt(5)
  v_mfma_f32_16x16x32_bf16 v[112:115], v[160:163], v[200:203], v[112:115]
  v_mfma_f32_16x16x32_bf16 v[116:119], v[160:163], v[204:207], v[116:119]
  ds_read_b128 v[144:147], v5 offset:47104
  s_waitcnt lgkmcnt(5)
  v_mfma_f32_16x16x32_bf16 v[120:123], v[164:167], v[200:203], v[120:123]
  v_mfma_f32_16x16x32_bf16 v[124:127], v[164:167], v[204:207], v[124:127]
  ds_read_b128 v[148:151], v5 offset:48128
  s_waitcnt lgkmcnt(5)
  v_mfma_f32_16x16x32_bf16 v[128:131], v[168:171], v[200:203], v[128:131]
  v_mfma_f32_16x16x32_bf16 v[132:135], v[168:171], v[204:207], v[132:135]
  ds_read_b128 v[152:155], v5 offset:49152
  s_waitcnt lgkmcnt(5)
  v_mfma_f32_16x16x32_bf16 v[136:139], v[172:175], v[200:203], v[136:139]
  v_mfma_f32_16x16x32_bf16 v[140:143], v[172:175], v[204:207], v[140:143]
  ds_read_b128 v[156:159], v5 offset:50176
  ds_read_b128 v[160:163], v5 offset:51200
  ds_read_b128 v[164:167], v5 offset:52224
  s_waitcnt lgkmcnt(5)
  v_mfma_f32_16x16x32_bf16 v[32:35], v[144:147], v[176:179], v[32:35]
  v_mfma_f32_16x16x32_bf16 v[36:39], v[144:147], v[180:183], v[36:39]
  ds_read_b128 v[168:171], v5 offset:53248
  s_waitcnt lgkmcnt(5)
  v_mfma_f32_16x16x32_bf16 v[40:43], v[148:151], v[176:179], v[40:43]
  v_mfma_f32_16x16x32_bf16 v[44:47], v[148:151], v[180:183], v[44:47]
  ds_read_b128 v[172:175], v5 offset:54272
  s_waitcnt lgkmcnt(5)
  v_mfma_f32_16x16x32_bf16 v[48:51], v[152:155], v[176:179], v[48:51]
  v_mfma_f32_16x16x32_bf16 v[52:55], v[152:155], v[180:183], v[52:55]
  ds_read_b128 v[144:147], v5 offset:55296
  s_waitcnt lgkmcnt(5)
  v_mfma_f32_16x16x32_bf16 v[56:59], v[156:159], v[176:179], v[56:59]
  v_mfma_f32_16x16x32_bf16 v[60:63], v[156:159], v[180:183], v[60:63]
  ds_read_b128 v[148:151], v5 offset:56320
  s_waitcnt lgkmcnt(5)
  v_mfma_f32_16x16x32_bf16 v[64:67], v[160:163], v[176:179], v[64:67]
  v_mfma_f32_16x16x32_bf16 v[68:71], v[160:163], v[180:183], v[68:71]
  ds_read_b128 v[152:155], v5 offset:57344
  s_waitcnt lgkmcnt(5)
  v_mfma_f32_16x16x32_bf16 v[72:75], v[164:167], v[176:179], v[72:75]
  v_mfma_f32_16x16x32_bf16 v[76:79], v[164:167], v[180:183], v[76:79]
  ds_read_b128 v[156:159], v6 offset:1024
  s_waitcnt lgkmcnt(5)
  v_mfma_f32_16x16x32_bf16 v[80:83], v[168:171], v[176:179], v[80:83]
  v_mfma_f32_16x16x32_bf16 v[84:87], v[168:171], v[180:183], v[84:87]
  ds_read_b128 v[160:163], v6 offset:2048
  s_waitcnt lgkmcnt(5)
  v_mfma_f32_16x16x32_bf16 v[88:91], v[172:175], v[176:179], v[88:91]
  v_mfma_f32_16x16x32_bf16 v[92:95], v[172:175], v[180:183], v[92:95]
  ds_read_b128 v[164:167], v6 offset:3072
  s_waitcnt lgkmcnt(5)
  v_mfma_f32_16x16x32_bf16 v[96:99], v[144:147], v[176:179], v[96:99]
  v_mfma_f32_16x16x32_bf16 v[100:103], v[144:147], v[180:183], v[100:103]
  s_barrier
  ds_read_b128 v[184:187], v9 offset:15360
  s_waitcnt lgkmcnt(5)
  v_mfma_f32_16x16x32_bf16 v[104:107], v[148:151], v[176:179], v[104:107]
  v_mfma_f32_16x16x32_bf16 v[108:111], v[148:151], v[180:183], v[108:111]
  ds_read_b128 v[188:191], v9 offset:16384
  s_waitcnt lgkmcnt(5)
  v_mfma_f32_16x16x32_bf16 v[112:115], v[152:155], v[176:179], v[112:115]
  v_mfma_f32_16x16x32_bf16 v[116:119], v[152:155], v[180:183], v[116:119]
  ds_read_b128 v[168:171], v6 offset:4096
  s_waitcnt lgkmcnt(5)
  v_mfma_f32_16x16x32_bf16 v[120:123], v[156:159], v[176:179], v[120:123]
  v_mfma_f32_16x16x32_bf16 v[124:127], v[156:159], v[180:183], v[124:127]
  ds_read_b128 v[172:175], v6 offset:5120
  s_waitcnt lgkmcnt(5)
  v_mfma_f32_16x16x32_bf16 v[128:131], v[160:163], v[176:179], v[128:131]
  v_mfma_f32_16x16x32_bf16 v[132:135], v[160:163], v[180:183], v[132:135]
  ds_read_b128 v[144:147], v6 offset:6144
  s_waitcnt lgkmcnt(5)
  v_mfma_f32_16x16x32_bf16 v[136:139], v[164:167], v[176:179], v[136:139]
  v_mfma_f32_16x16x32_bf16 v[140:143], v[164:167], v[180:183], v[140:143]
  ds_read_b128 v[148:151], v6 offset:7168
  ds_read_b128 v[152:155], v6 offset:8192
  ds_read_b128 v[156:159], v6 offset:9216
  s_waitcnt lgkmcnt(5)
  v_mfma_f32_16x16x32_bf16 v[32:35], v[168:171], v[184:187], v[32:35]
  v_mfma_f32_16x16x32_bf16 v[36:39], v[168:171], v[188:191], v[36:39]
  ds_read_b128 v[160:163], v6 offset:10240
  s_waitcnt lgkmcnt(5)
  v_mfma_f32_16x16x32_bf16 v[40:43], v[172:175], v[184:187], v[40:43]
  v_mfma_f32_16x16x32_bf16 v[44:47], v[172:175], v[188:191], v[44:47]
  ds_read_b128 v[164:167], v6 offset:11264
  s_waitcnt lgkmcnt(5)
  v_mfma_f32_16x16x32_bf16 v[48:51], v[144:147], v[184:187], v[48:51]
  v_mfma_f32_16x16x32_bf16 v[52:55], v[144:147], v[188:191], v[52:55]
  ds_read_b128 v[168:171], v6 offset:12288
  s_waitcnt lgkmcnt(5)
  v_mfma_f32_16x16x32_bf16 v[56:59], v[148:151], v[184:187], v[56:59]
  v_mfma_f32_16x16x32_bf16 v[60:63], v[148:151], v[188:191], v[60:63]
  ds_read_b128 v[172:175], v6 offset:13312
  s_waitcnt lgkmcnt(5)
  v_mfma_f32_16x16x32_bf16 v[64:67], v[152:155], v[184:187], v[64:67]
  v_mfma_f32_16x16x32_bf16 v[68:71], v[152:155], v[188:191], v[68:71]
  ds_read_b128 v[144:147], v6 offset:14336
  s_waitcnt lgkmcnt(5)
  v_mfma_f32_16x16x32_bf16 v[72:75], v[156:159], v[184:187], v[72:75]
  v_mfma_f32_16x16x32_bf16 v[76:79], v[156:159], v[188:191], v[76:79]
  ds_read_b128 v[148:151], v6 offset:23552
  s_waitcnt lgkmcnt(5)
  v_mfma_f32_16x16x32_bf16 v[80:83], v[160:163], v[184:187], v[80:83]
  v_mfma_f32_16x16x32_bf16 v[84:87], v[160:163], v[188:191], v[84:87]
  ds_read_b128 v[152:155], v6 offset:24576
  s_waitcnt lgkmcnt(5)
  v_mfma_f32_16x16x32_bf16 v[88:91], v[164:167], v[184:187], v[88:91]
  v_mfma_f32_16x16x32_bf16 v[92:95], v[164:167], v[188:191], v[92:95]
  ds_read_b128 v[156:159], v6 offset:25600
  s_waitcnt lgkmcnt(5)
  v_mfma_f32_16x16x32_bf16 v[96:99], v[168:171], v[184:187], v[96:99]
  v_mfma_f32_16x16x32_bf16 v[100:103], v[168:171], v[188:191], v[100:103]
  s_barrier
  ds_read_b128 v[192:195], v7 offset:11264
  s_waitcnt lgkmcnt(5)
  v_mfma_f32_16x16x32_bf16 v[104:107], v[172:175], v[184:187], v[104:107]
  v_mfma_f32_16x16x32_bf16 v[108:111], v[172:175], v[188:191], v[108:111]
  ds_read_b128 v[196:199], v7 offset:12288
  s_waitcnt lgkmcnt(5)
  v_mfma_f32_16x16x32_bf16 v[112:115], v[144:147], v[184:187], v[112:115]
  v_mfma_f32_16x16x32_bf16 v[116:119], v[144:147], v[188:191], v[116:119]
  ds_read_b128 v[160:163], v4 offset:0
  s_waitcnt lgkmcnt(5)
  v_mfma_f32_16x16x32_bf16 v[120:123], v[148:151], v[184:187], v[120:123]
  v_mfma_f32_16x16x32_bf16 v[124:127], v[148:151], v[188:191], v[124:127]
  ds_read_b128 v[164:167], v4 offset:1024
  s_waitcnt lgkmcnt(5)
  v_mfma_f32_16x16x32_bf16 v[128:131], v[152:155], v[184:187], v[128:131]
  v_mfma_f32_16x16x32_bf16 v[132:135], v[152:155], v[188:191], v[132:135]
  ds_read_b128 v[168:171], v4 offset:2048
  s_waitcnt lgkmcnt(5)
  v_mfma_f32_16x16x32_bf16 v[136:139], v[156:159], v[184:187], v[136:139]
  v_mfma_f32_16x16x32_bf16 v[140:143], v[156:159], v[188:191], v[140:143]
  ds_read_b128 v[172:175], v4 offset:3072
  ds_read_b128 v[144:147], v4 offset:4096
  ds_read_b128 v[148:151], v4 offset:5120
  s_waitcnt lgkmcnt(5)
  v_mfma_f32_16x16x32_bf16 v[32:35], v[160:163], v[192:195], v[32:35]
  v_mfma_f32_16x16x32_bf16 v[36:39], v[160:163], v[196:199], v[36:39]
  ds_read_b128 v[152:155], v4 offset:6144
  s_waitcnt lgkmcnt(5)
  v_mfma_f32_16x16x32_bf16 v[40:43], v[164:167], v[192:195], v[40:43]
  v_mfma_f32_16x16x32_bf16 v[44:47], v[164:167], v[196:199], v[44:47]
  ds_read_b128 v[156:159], v4 offset:7168
  s_waitcnt lgkmcnt(5)
  v_mfma_f32_16x16x32_bf16 v[48:51], v[168:171], v[192:195], v[48:51]
  v_mfma_f32_16x16x32_bf16 v[52:55], v[168:171], v[196:199], v[52:55]
  ds_read_b128 v[160:163], v4 offset:8192
  s_waitcnt lgkmcnt(5)
  v_mfma_f32_16x16x32_bf16 v[56:59], v[172:175], v[192:195], v[56:59]
  v_mfma_f32_16x16x32_bf16 v[60:63], v[172:175], v[196:199], v[60:63]
  ds_read_b128 v[164:167], v4 offset:9216
  s_waitcnt lgkmcnt(5)
  v_mfma_f32_16x16x32_bf16 v[64:67], v[144:147], v[192:195], v[64:67]
  v_mfma_f32_16x16x32_bf16 v[68:71], v[144:147], v[196:199], v[68:71]
  ds_read_b128 v[168:171], v4 offset:10240
  s_waitcnt lgkmcnt(5)
  v_mfma_f32_16x16x32_bf16 v[72:75], v[148:151], v[192:195], v[72:75]
  v_mfma_f32_16x16x32_bf16 v[76:79], v[148:151], v[196:199], v[76:79]
  ds_read_b128 v[172:175], v4 offset:19456
  s_waitcnt lgkmcnt(5)
  v_mfma_f32_16x16x32_bf16 v[80:83], v[152:155], v[192:195], v[80:83]
  v_mfma_f32_16x16x32_bf16 v[84:87], v[152:155], v[196:199], v[84:87]
  ds_read_b128 v[144:147], v4 offset:20480
  s_waitcnt lgkmcnt(5)
  v_mfma_f32_16x16x32_bf16 v[88:91], v[156:159], v[192:195], v[88:91]
  v_mfma_f32_16x16x32_bf16 v[92:95], v[156:159], v[196:199], v[92:95]
  ds_read_b128 v[148:151], v4 offset:21504
  s_waitcnt lgkmcnt(5)
  v_mfma_f32_16x16x32_bf16 v[96:99], v[160:163], v[192:195], v[96:99]
  v_mfma_f32_16x16x32_bf16 v[100:103], v[160:163], v[196:199], v[100:103]
  s_barrier
  ds_read_b128 v[200:203], v7 offset:33792
  s_waitcnt lgkmcnt(5)
  v_mfma_f32_16x16x32_bf16 v[104:107], v[164:167], v[192:195], v[104:107]
  v_mfma_f32_16x16x32_bf16 v[108:111], v[164:167], v[196:199], v[108:111]
  ds_read_b128 v[204:207], v7 offset:34816
  s_waitcnt lgkmcnt(5)
  v_mfma_f32_16x16x32_bf16 v[112:115], v[168:171], v[192:195], v[112:115]
  v_mfma_f32_16x16x32_bf16 v[116:119], v[168:171], v[196:199], v[116:119]
  ds_read_b128 v[152:155], v4 offset:22528
  s_waitcnt lgkmcnt(5)
  v_mfma_f32_16x16x32_bf16 v[120:123], v[172:175], v[192:195], v[120:123]
  v_mfma_f32_16x16x32_bf16 v[124:127], v[172:175], v[196:199], v[124:127]
  ds_read_b128 v[156:159], v4 offset:23552
  s_waitcnt lgkmcnt(5)
  v_mfma_f32_16x16x32_bf16 v[128:131], v[144:147], v[192:195], v[128:131]
  v_mfma_f32_16x16x32_bf16 v[132:135], v[144:147], v[196:199], v[132:135]
  ds_read_b128 v[160:163], v4 offset:24576
  s_waitcnt lgkmcnt(5)
  v_mfma_f32_16x16x32_bf16 v[136:139], v[148:151], v[192:195], v[136:139]
  v_mfma_f32_16x16x32_bf16 v[140:143], v[148:151], v[196:199], v[140:143]
  ds_read_b128 v[164:167], v4 offset:25600
  ds_read_b128 v[168:171], v4 offset:26624
  ds_read_b128 v[172:175], v4 offset:27648
  s_waitcnt lgkmcnt(5)
  v_mfma_f32_16x16x32_bf16 v[32:35], v[152:155], v[200:203], v[32:35]
  v_mfma_f32_16x16x32_bf16 v[36:39], v[152:155], v[204:207], v[36:39]
  ds_read_b128 v[144:147], v4 offset:28672
  s_waitcnt lgkmcnt(5)
  v_mfma_f32_16x16x32_bf16 v[40:43], v[156:159], v[200:203], v[40:43]
  v_mfma_f32_16x16x32_bf16 v[44:47], v[156:159], v[204:207], v[44:47]
  ds_read_b128 v[148:151], v4 offset:29696
  s_waitcnt lgkmcnt(5)
  v_mfma_f32_16x16x32_bf16 v[48:51], v[160:163], v[200:203], v[48:51]
  v_mfma_f32_16x16x32_bf16 v[52:55], v[160:163], v[204:207], v[52:55]
  ds_read_b128 v[152:155], v4 offset:30720
  s_waitcnt lgkmcnt(5)
  v_mfma_f32_16x16x32_bf16 v[56:59], v[164:167], v[200:203], v[56:59]
  v_mfma_f32_16x16x32_bf16 v[60:63], v[164:167], v[204:207], v[60:63]
  ds_read_b128 v[156:159], v4 offset:31744
  s_waitcnt lgkmcnt(5)
  v_mfma_f32_16x16x32_bf16 v[64:67], v[168:171], v[200:203], v[64:67]
  v_mfma_f32_16x16x32_bf16 v[68:71], v[168:171], v[204:207], v[68:71]
  ds_read_b128 v[160:163], v4 offset:32768
  s_waitcnt lgkmcnt(5)
  v_mfma_f32_16x16x32_bf16 v[72:75], v[172:175], v[200:203], v[72:75]
  v_mfma_f32_16x16x32_bf16 v[76:79], v[172:175], v[204:207], v[76:79]
  ds_read_b128 v[164:167], v4 offset:41984
  s_waitcnt lgkmcnt(5)
  v_mfma_f32_16x16x32_bf16 v[80:83], v[144:147], v[200:203], v[80:83]
  v_mfma_f32_16x16x32_bf16 v[84:87], v[144:147], v[204:207], v[84:87]
  ds_read_b128 v[168:171], v4 offset:43008
  s_waitcnt lgkmcnt(5)
  v_mfma_f32_16x16x32_bf16 v[88:91], v[148:151], v[200:203], v[88:91]
  v_mfma_f32_16x16x32_bf16 v[92:95], v[148:151], v[204:207], v[92:95]
  ds_read_b128 v[172:175], v4 offset:44032
  s_waitcnt lgkmcnt(5)
  v_mfma_f32_16x16x32_bf16 v[96:99], v[152:155], v[200:203], v[96:99]
  v_mfma_f32_16x16x32_bf16 v[100:103], v[152:155], v[204:207], v[100:103]
  s_barrier
  ds_read_b128 v[176:179], v7 offset:56320
  s_waitcnt lgkmcnt(5)
  v_mfma_f32_16x16x32_bf16 v[104:107], v[156:159], v[200:203], v[104:107]
  v_mfma_f32_16x16x32_bf16 v[108:111], v[156:159], v[204:207], v[108:111]
  ds_read_b128 v[180:183], v7 offset:57344
  s_waitcnt lgkmcnt(5)
  v_mfma_f32_16x16x32_bf16 v[112:115], v[160:163], v[200:203], v[112:115]
  v_mfma_f32_16x16x32_bf16 v[116:119], v[160:163], v[204:207], v[116:119]
  ds_read_b128 v[144:147], v4 offset:45056
  s_waitcnt lgkmcnt(5)
  v_mfma_f32_16x16x32_bf16 v[120:123], v[164:167], v[200:203], v[120:123]
  v_mfma_f32_16x16x32_bf16 v[124:127], v[164:167], v[204:207], v[124:127]
  ds_read_b128 v[148:151], v4 offset:52224
  s_waitcnt lgkmcnt(5)
  v_mfma_f32_16x16x32_bf16 v[128:131], v[168:171], v[200:203], v[128:131]
  v_mfma_f32_16x16x32_bf16 v[132:135], v[168:171], v[204:207], v[132:135]
  s_barrier
  ds_read_b128 v[184:187], v8 offset:13312
  s_waitcnt lgkmcnt(5)
  v_mfma_f32_16x16x32_bf16 v[136:139], v[172:175], v[200:203], v[136:139]
  v_mfma_f32_16x16x32_bf16 v[140:143], v[172:175], v[204:207], v[140:143]
  ds_read_b128 v[188:191], v8 offset:14336
  ds_read_b128 v[152:155], v5 offset:2048
  ds_read_b128 v[156:159], v5 offset:9216
  s_waitcnt lgkmcnt(5)
  v_mfma_f32_16x16x32_bf16 v[32:35], v[144:147], v[176:179], v[32:35]
  v_mfma_f32_16x16x32_bf16 v[36:39], v[144:147], v[180:183], v[36:39]
  s_barrier
  ds_read_b128 v[192:195], v8 offset:35840
  s_waitcnt lgkmcnt(5)
  v_mfma_f32_16x16x32_bf16 v[88:91], v[148:151], v[176:179], v[88:91]
  v_mfma_f32_16x16x32_bf16 v[92:95], v[148:151], v[180:183], v[92:95]
  ds_read_b128 v[196:199], v8 offset:36864
  ds_read_b128 v[160:163], v5 offset:24576
  ds_read_b128 v[164:167], v5 offset:31744
  s_waitcnt lgkmcnt(5)
  v_mfma_f32_16x16x32_bf16 v[32:35], v[152:155], v[184:187], v[32:35]
  v_mfma_f32_16x16x32_bf16 v[36:39], v[152:155], v[188:191], v[36:39]
  s_barrier
  ds_read_b128 v[200:203], v8 offset:58368
  s_waitcnt lgkmcnt(5)
  v_mfma_f32_16x16x32_bf16 v[88:91], v[156:159], v[184:187], v[88:91]
  v_mfma_f32_16x16x32_bf16 v[92:95], v[156:159], v[188:191], v[92:95]
  ds_read_b128 v[204:207], v8 offset:59392
  ds_read_b128 v[168:171], v5 offset:47104
  ds_read_b128 v[172:175], v5 offset:54272
  s_waitcnt lgkmcnt(5)
  v_mfma_f32_16x16x32_bf16 v[32:35], v[160:163], v[192:195], v[32:35]
  v_mfma_f32_16x16x32_bf16 v[36:39], v[160:163], v[196:199], v[36:39]
  ds_read_b128 v[144:147], v4 offset:46080
  s_waitcnt lgkmcnt(5)
  v_mfma_f32_16x16x32_bf16 v[88:91], v[164:167], v[192:195], v[88:91]
  v_mfma_f32_16x16x32_bf16 v[92:95], v[164:167], v[196:199], v[92:95]
  ds_read_b128 v[208:211], v21 offset:0
  ds_read_b128 v[212:215], v21 offset:448
  ds_read_b128 v[148:151], v4 offset:53248
  ds_read_b128 v[152:155], v5 offset:3072
  ds_read_b128 v[156:159], v5 offset:10240
  s_waitcnt lgkmcnt(7)
  v_mfma_f32_16x16x32_bf16 v[32:35], v[168:171], v[200:203], v[32:35]
  v_mfma_f32_16x16x32_bf16 v[36:39], v[168:171], v[204:207], v[36:39]
  ds_read_b128 v[160:163], v5 offset:25600
  s_waitcnt lgkmcnt(7)
  v_mfma_f32_16x16x32_bf16 v[88:91], v[172:175], v[200:203], v[88:91]
  v_mfma_f32_16x16x32_bf16 v[92:95], v[172:175], v[204:207], v[92:95]
  ds_read_b128 v[164:167], v5 offset:32768
  s_waitcnt lgkmcnt(7)
  v_mfma_f32_16x16x32_bf16 v[40:43], v[144:147], v[176:179], v[40:43]
  v_mfma_f32_16x16x32_bf16 v[44:47], v[144:147], v[180:183], v[44:47]
  s_waitcnt lgkmcnt(5)
  v_fma_f32 v32, v208, v22, v32
  v_fma_f32 v33, v209, v22, v33
  ds_read_b128 v[168:171], v5 offset:48128
  s_waitcnt lgkmcnt(5)
  v_mfma_f32_16x16x32_bf16 v[96:99], v[148:151], v[176:179], v[96:99]
  v_fma_f32 v34, v210, v22, v34
  v_fma_f32 v35, v211, v22, v35
  v_mfma_f32_16x16x32_bf16 v[100:103], v[148:151], v[180:183], v[100:103]
  v_max_f32 v32, 0, v32
  v_max_f32 v33, 0, v33
  v_max_f32 v34, 0, v34
  ds_read_b128 v[172:175], v5 offset:55296
  s_waitcnt lgkmcnt(5)
  v_mfma_f32_16x16x32_bf16 v[40:43], v[152:155], v[184:187], v[40:43]
  v_max_f32 v35, 0, v35
  v_fma_f32 v36, v208, v23, v36
  v_mfma_f32_16x16x32_bf16 v[44:47], v[152:155], v[188:191], v[44:47]
  v_fma_f32 v37, v209, v23, v37
  v_fma_f32 v38, v210, v23, v38
  v_fma_f32 v39, v211, v23, v39
  ds_read_b128 v[144:147], v4 offset:47104
  s_waitcnt lgkmcnt(5)
  v_mfma_f32_16x16x32_bf16 v[96:99], v[156:159], v[184:187], v[96:99]
  v_max_f32 v36, 0, v36
  v_max_f32 v37, 0, v37
  v_mfma_f32_16x16x32_bf16 v[100:103], v[156:159], v[188:191], v[100:103]
  v_max_f32 v38, 0, v38
  v_max_f32 v39, 0, v39
  ds_read_b128 v[148:151], v4 offset:54272
  s_waitcnt lgkmcnt(5)
  v_mfma_f32_16x16x32_bf16 v[40:43], v[160:163], v[192:195], v[40:43]
  v_fma_f32 v88, v212, v22, v88
  v_fma_f32 v89, v213, v22, v89
  v_fma_f32 v90, v214, v22, v90
  v_mfma_f32_16x16x32_bf16 v[44:47], v[160:163], v[196:199], v[44:47]
  v_fma_f32 v91, v215, v22, v91
  v_mul_f32 v32, v32, v88
  ds_read_b128 v[152:155], v5 offset:4096
  s_waitcnt lgkmcnt(5)
  v_mfma_f32_16x16x32_bf16 v[96:99], v[164:167], v[192:195], v[96:99]
  v_mul_f32 v33, v33, v89
  v_mul_f32 v34, v34, v90
  v_mul_f32 v35, v35, v91
  v_mfma_f32_16x16x32_bf16 v[100:103], v[164:167], v[196:199], v[100:103]
  v_cvt_pk_bf16_f32 v32, v32, v33
  v_cvt_pk_bf16_f32 v33, v34, v35
  ds_read_b128 v[216:219], v21 offset:64
  ds_read_b128 v[220:223], v21 offset:512
  ds_read_b128 v[156:159], v5 offset:11264
  s_waitcnt lgkmcnt(7)
  v_mfma_f32_16x16x32_bf16 v[40:43], v[168:171], v[200:203], v[40:43]
  v_fma_f32 v92, v212, v23, v92
  v_fma_f32 v93, v213, v23, v93
  v_mfma_f32_16x16x32_bf16 v[44:47], v[168:171], v[204:207], v[44:47]
  v_fma_f32 v94, v214, v23, v94
  v_fma_f32 v95, v215, v23, v95
  v_mul_f32 v36, v36, v92
  ds_read_b128 v[160:163], v5 offset:26624
  s_waitcnt lgkmcnt(7)
  v_mfma_f32_16x16x32_bf16 v[96:99], v[172:175], v[200:203], v[96:99]
  v_mul_f32 v37, v37, v93
  v_mul_f32 v38, v38, v94
  v_mfma_f32_16x16x32_bf16 v[100:103], v[172:175], v[204:207], v[100:103]
  v_mul_f32 v39, v39, v95
  v_cvt_pk_bf16_f32 v36, v36, v37
  v_cvt_pk_bf16_f32 v37, v38, v39
  ds_read_b128 v[164:167], v5 offset:33792
  s_waitcnt lgkmcnt(7)
  v_mfma_f32_16x16x32_bf16 v[48:51], v[144:147], v[176:179], v[48:51]
  v_mfma_f32_16x16x32_bf16 v[52:55], v[144:147], v[180:183], v[52:55]
  s_waitcnt lgkmcnt(3)
  v_fma_f32 v40, v216, v22, v40
  v_fma_f32 v41, v217, v22, v41
  ds_read_b128 v[168:171], v5 offset:49152
  v_mfma_f32_16x16x32_bf16 v[104:107], v[148:151], v[176:179], v[104:107]
  v_fma_f32 v42, v218, v22, v42
  v_fma_f32 v43, v219, v22, v43
  v_max_f32 v40, 0, v40
  v_mfma_f32_16x16x32_bf16 v[108:111], v[148:151], v[180:183], v[108:111]
  v_max_f32 v41, 0, v41
  v_max_f32 v42, 0, v42
  ds_read_b128 v[172:175], v5 offset:56320
  v_mfma_f32_16x16x32_bf16 v[48:51], v[152:155], v[184:187], v[48:51]
  v_max_f32 v43, 0, v43
  v_fma_f32 v44, v216, v23, v44
  v_fma_f32 v45, v217, v23, v45
  v_mfma_f32_16x16x32_bf16 v[52:55], v[152:155], v[188:191], v[52:55]
  v_fma_f32 v46, v218, v23, v46
  v_fma_f32 v47, v219, v23, v47
  ds_read_b128 v[144:147], v4 offset:48128
  s_waitcnt lgkmcnt(5)
  v_mfma_f32_16x16x32_bf16 v[104:107], v[156:159], v[184:187], v[104:107]
  v_max_f32 v44, 0, v44
  v_max_f32 v45, 0, v45
  v_max_f32 v46, 0, v46
  v_mfma_f32_16x16x32_bf16 v[108:111], v[156:159], v[188:191], v[108:111]
  v_max_f32 v47, 0, v47
  v_fma_f32 v96, v220, v22, v96
  ds_read_b128 v[148:151], v4 offset:55296
  s_waitcnt lgkmcnt(5)
  v_mfma_f32_16x16x32_bf16 v[48:51], v[160:163], v[192:195], v[48:51]
  v_fma_f32 v97, v221, v22, v97
  v_fma_f32 v98, v222, v22, v98
  v_fma_f32 v99, v223, v22, v99
  v_mfma_f32_16x16x32_bf16 v[52:55], v[160:163], v[196:199], v[52:55]
  v_mul_f32 v40, v40, v96
  v_mul_f32 v41, v41, v97
  ds_read_b128 v[152:155], v5 offset:5120
  s_waitcnt lgkmcnt(5)
  v_mfma_f32_16x16x32_bf16 v[104:107], v[164:167], v[192:195], v[104:107]
  v_mul_f32 v42, v42, v98
  v_mul_f32 v43, v43, v99
  v_cvt_pk_bf16_f32 v34, v40, v41
  v_mfma_f32_16x16x32_bf16 v[108:111], v[164:167], v[196:199], v[108:111]
  v_cvt_pk_bf16_f32 v35, v42, v43
  buffer_store_dwordx4 v[32:35], v1, s[12:15], s44 offen offset:0 sc0 sc1
  ds_read_b128 v[208:211], v21 offset:128
  ds_read_b128 v[212:215], v21 offset:576
  ds_read_b128 v[156:159], v5 offset:12288
  s_waitcnt lgkmcnt(7)
  v_mfma_f32_16x16x32_bf16 v[48:51], v[168:171], v[200:203], v[48:51]
  v_fma_f32 v100, v220, v23, v100
  v_fma_f32 v101, v221, v23, v101
  v_fma_f32 v102, v222, v23, v102
  v_mfma_f32_16x16x32_bf16 v[52:55], v[168:171], v[204:207], v[52:55]
  v_fma_f32 v103, v223, v23, v103
  v_mul_f32 v44, v44, v100
  ds_read_b128 v[160:163], v5 offset:27648
  s_waitcnt lgkmcnt(7)
  v_mfma_f32_16x16x32_bf16 v[104:107], v[172:175], v[200:203], v[104:107]
  v_mul_f32 v45, v45, v101
  v_mul_f32 v46, v46, v102
  v_mul_f32 v47, v47, v103
  v_mfma_f32_16x16x32_bf16 v[108:111], v[172:175], v[204:207], v[108:111]
  v_cvt_pk_bf16_f32 v38, v44, v45
  v_cvt_pk_bf16_f32 v39, v46, v47
  buffer_store_dwordx4 v[36:39], v10, s[12:15], s44 offen offset:0 sc0 sc1
  ds_read_b128 v[164:167], v5 offset:34816
  s_waitcnt lgkmcnt(7)
  v_mfma_f32_16x16x32_bf16 v[56:59], v[144:147], v[176:179], v[56:59]
  v_mfma_f32_16x16x32_bf16 v[60:63], v[144:147], v[180:183], v[60:63]
  s_waitcnt lgkmcnt(3)
  v_fma_f32 v48, v208, v22, v48
  v_fma_f32 v49, v209, v22, v49
  ds_read_b128 v[168:171], v5 offset:50176
  v_mfma_f32_16x16x32_bf16 v[112:115], v[148:151], v[176:179], v[112:115]
  v_fma_f32 v50, v210, v22, v50
  v_fma_f32 v51, v211, v22, v51
  v_mfma_f32_16x16x32_bf16 v[116:119], v[148:151], v[180:183], v[116:119]
  v_max_f32 v48, 0, v48
  v_max_f32 v49, 0, v49
  v_max_f32 v50, 0, v50
  ds_read_b128 v[172:175], v5 offset:57344
  v_mfma_f32_16x16x32_bf16 v[56:59], v[152:155], v[184:187], v[56:59]
  v_max_f32 v51, 0, v51
  v_fma_f32 v52, v208, v23, v52
  v_mfma_f32_16x16x32_bf16 v[60:63], v[152:155], v[188:191], v[60:63]
  v_fma_f32 v53, v209, v23, v53
  v_fma_f32 v54, v210, v23, v54
  v_fma_f32 v55, v211, v23, v55
  ds_read_b128 v[144:147], v4 offset:49152
  s_waitcnt lgkmcnt(5)
  v_mfma_f32_16x16x32_bf16 v[112:115], v[156:159], v[184:187], v[112:115]
  v_max_f32 v52, 0, v52
  v_max_f32 v53, 0, v53
  v_mfma_f32_16x16x32_bf16 v[116:119], v[156:159], v[188:191], v[116:119]
  v_max_f32 v54, 0, v54
  v_max_f32 v55, 0, v55
  ds_read_b128 v[148:151], v4 offset:64512
  s_waitcnt lgkmcnt(5)
  v_mfma_f32_16x16x32_bf16 v[56:59], v[160:163], v[192:195], v[56:59]
  v_fma_f32 v104, v212, v22, v104
  v_fma_f32 v105, v213, v22, v105
  v_fma_f32 v106, v214, v22, v106
  v_mfma_f32_16x16x32_bf16 v[60:63], v[160:163], v[196:199], v[60:63]
  v_fma_f32 v107, v215, v22, v107
  v_mul_f32 v48, v48, v104
  ds_read_b128 v[152:155], v5 offset:6144
  s_waitcnt lgkmcnt(5)
  v_mfma_f32_16x16x32_bf16 v[112:115], v[164:167], v[192:195], v[112:115]
  v_mul_f32 v49, v49, v105
  v_mul_f32 v50, v50, v106
  v_mul_f32 v51, v51, v107
  v_mfma_f32_16x16x32_bf16 v[116:119], v[164:167], v[196:199], v[116:119]
  v_cvt_pk_bf16_f32 v48, v48, v49
  v_cvt_pk_bf16_f32 v49, v50, v51
  ds_read_b128 v[216:219], v21 offset:192
  ds_read_b128 v[220:223], v21 offset:640
  ds_read_b128 v[156:159], v5 offset:21504
  s_waitcnt lgkmcnt(7)
  v_mfma_f32_16x16x32_bf16 v[56:59], v[168:171], v[200:203], v[56:59]
  v_fma_f32 v108, v212, v23, v108
  v_fma_f32 v109, v213, v23, v109
  v_mfma_f32_16x16x32_bf16 v[60:63], v[168:171], v[204:207], v[60:63]
  v_fma_f32 v110, v214, v23, v110
  v_fma_f32 v111, v215, v23, v111
  v_mul_f32 v52, v52, v108
  ds_read_b128 v[160:163], v5 offset:28672
  s_waitcnt lgkmcnt(7)
  v_mfma_f32_16x16x32_bf16 v[112:115], v[172:175], v[200:203], v[112:115]
  v_mul_f32 v53, v53, v109
  v_mul_f32 v54, v54, v110
  v_mfma_f32_16x16x32_bf16 v[116:119], v[172:175], v[204:207], v[116:119]
  v_mul_f32 v55, v55, v111
  v_cvt_pk_bf16_f32 v52, v52, v53
  v_cvt_pk_bf16_f32 v53, v54, v55
  ds_read_b128 v[164:167], v5 offset:44032
  s_waitcnt lgkmcnt(7)
  v_mfma_f32_16x16x32_bf16 v[64:67], v[144:147], v[176:179], v[64:67]
  v_mfma_f32_16x16x32_bf16 v[68:71], v[144:147], v[180:183], v[68:71]
  s_waitcnt lgkmcnt(3)
  v_fma_f32 v56, v216, v22, v56
  v_fma_f32 v57, v217, v22, v57
  ds_read_b128 v[168:171], v5 offset:51200
  v_mfma_f32_16x16x32_bf16 v[120:123], v[148:151], v[176:179], v[120:123]
  v_fma_f32 v58, v218, v22, v58
  v_fma_f32 v59, v219, v22, v59
  v_max_f32 v56, 0, v56
  v_mfma_f32_16x16x32_bf16 v[124:127], v[148:151], v[180:183], v[124:127]
  v_max_f32 v57, 0, v57
  v_max_f32 v58, 0, v58
  ds_read_b128 v[172:175], v6 offset:1024
  v_mfma_f32_16x16x32_bf16 v[64:67], v[152:155], v[184:187], v[64:67]
  v_max_f32 v59, 0, v59
  v_fma_f32 v60, v216, v23, v60
  v_fma_f32 v61, v217, v23, v61
  v_mfma_f32_16x16x32_bf16 v[68:71], v[152:155], v[188:191], v[68:71]
  v_fma_f32 v62, v218, v23, v62
  v_fma_f32 v63, v219, v23, v63
  ds_read_b128 v[144:147], v4 offset:50176
  s_waitcnt lgkmcnt(5)
  v_mfma_f32_16x16x32_bf16 v[120:123], v[156:159], v[184:187], v[120:123]
  v_max_f32 v60, 0, v60
  v_max_f32 v61, 0, v61
  v_max_f32 v62, 0, v62
  v_mfma_f32_16x16x32_bf16 v[124:127], v[156:159], v[188:191], v[124:127]
  v_max_f32 v63, 0, v63
  v_fma_f32 v112, v220, v22, v112
  ds_read_b128 v[148:151], v5 offset:0
  s_waitcnt lgkmcnt(5)
  v_mfma_f32_16x16x32_bf16 v[64:67], v[160:163], v[192:195], v[64:67]
  v_fma_f32 v113, v221, v22, v113
  v_fma_f32 v114, v222, v22, v114
  v_fma_f32 v115, v223, v22, v115
  v_mfma_f32_16x16x32_bf16 v[68:71], v[160:163], v[196:199], v[68:71]
  v_mul_f32 v56, v56, v112
  v_mul_f32 v57, v57, v113
  ds_read_b128 v[152:155], v5 offset:7168
  s_waitcnt lgkmcnt(5)
  v_mfma_f32_16x16x32_bf16 v[120:123], v[164:167], v[192:195], v[120:123]
  v_mul_f32 v58, v58, v114
  v_mul_f32 v59, v59, v115
  v_cvt_pk_bf16_f32 v50, v56, v57
  v_mfma_f32_16x16x32_bf16 v[124:127], v[164:167], v[196:199], v[124:127]
  v_cvt_pk_bf16_f32 v51, v58, v59
  buffer_store_dwordx4 v[48:51], v1, s[12:15], s44 offen offset:1024 sc0 sc1
  ds_read_b128 v[208:211], v21 offset:256
  ds_read_b128 v[212:215], v21 offset:704
  ds_read_b128 v[156:159], v5 offset:22528
  s_waitcnt lgkmcnt(7)
  v_mfma_f32_16x16x32_bf16 v[64:67], v[168:171], v[200:203], v[64:67]
  v_fma_f32 v116, v220, v23, v116
  v_fma_f32 v117, v221, v23, v117
  v_fma_f32 v118, v222, v23, v118
  v_mfma_f32_16x16x32_bf16 v[68:71], v[168:171], v[204:207], v[68:71]
  v_fma_f32 v119, v223, v23, v119
  v_mul_f32 v60, v60, v116
  ds_read_b128 v[160:163], v5 offset:29696
  s_waitcnt lgkmcnt(7)
  v_mfma_f32_16x16x32_bf16 v[120:123], v[172:175], v[200:203], v[120:123]
  v_mul_f32 v61, v61, v117
  v_mul_f32 v62, v62, v118
  v_mul_f32 v63, v63, v119
  v_mfma_f32_16x16x32_bf16 v[124:127], v[172:175], v[204:207], v[124:127]
  v_cvt_pk_bf16_f32 v54, v60, v61
  v_cvt_pk_bf16_f32 v55, v62, v63
  buffer_store_dwordx4 v[52:55], v10, s[12:15], s44 offen offset:1024 sc0 sc1
  ds_read_b128 v[164:167], v5 offset:45056
  s_waitcnt lgkmcnt(7)
  v_mfma_f32_16x16x32_bf16 v[72:75], v[144:147], v[176:179], v[72:75]
  v_mfma_f32_16x16x32_bf16 v[76:79], v[144:147], v[180:183], v[76:79]
  s_waitcnt lgkmcnt(3)
  v_fma_f32 v64, v208, v22, v64
  v_fma_f32 v65, v209, v22, v65
  ds_read_b128 v[168:171], v5 offset:52224
  v_mfma_f32_16x16x32_bf16 v[128:131], v[148:151], v[176:179], v[128:131]
  v_fma_f32 v66, v210, v22, v66
  v_fma_f32 v67, v211, v22, v67
  v_mfma_f32_16x16x32_bf16 v[132:135], v[148:151], v[180:183], v[132:135]
  v_max_f32 v64, 0, v64
  v_max_f32 v65, 0, v65
  v_max_f32 v66, 0, v66
  ds_read_b128 v[172:175], v6 offset:2048
  v_mfma_f32_16x16x32_bf16 v[72:75], v[152:155], v[184:187], v[72:75]
  v_max_f32 v67, 0, v67
  v_fma_f32 v68, v208, v23, v68
  v_mfma_f32_16x16x32_bf16 v[76:79], v[152:155], v[188:191], v[76:79]
  v_fma_f32 v69, v209, v23, v69
  v_fma_f32 v70, v210, v23, v70
  v_fma_f32 v71, v211, v23, v71
  ds_read_b128 v[144:147], v4 offset:51200
  s_waitcnt lgkmcnt(5)
  v_mfma_f32_16x16x32_bf16 v[128:131], v[156:159], v[184:187], v[128:131]
  v_max_f32 v68, 0, v68
  v_max_f32 v69, 0, v69
  v_mfma_f32_16x16x32_bf16 v[132:135], v[156:159], v[188:191], v[132:135]
  v_max_f32 v70, 0, v70
  v_max_f32 v71, 0, v71
  ds_read_b128 v[148:151], v5 offset:1024
  s_waitcnt lgkmcnt(5)
  v_mfma_f32_16x16x32_bf16 v[72:75], v[160:163], v[192:195], v[72:75]
  v_fma_f32 v120, v212, v22, v120
  v_fma_f32 v121, v213, v22, v121
  v_fma_f32 v122, v214, v22, v122
  v_mfma_f32_16x16x32_bf16 v[76:79], v[160:163], v[196:199], v[76:79]
  v_fma_f32 v123, v215, v22, v123
  v_mul_f32 v64, v64, v120
  ds_read_b128 v[152:155], v5 offset:8192
  s_waitcnt lgkmcnt(5)
  v_mfma_f32_16x16x32_bf16 v[128:131], v[164:167], v[192:195], v[128:131]
  v_mul_f32 v65, v65, v121
  v_mul_f32 v66, v66, v122
  v_mul_f32 v67, v67, v123
  v_mfma_f32_16x16x32_bf16 v[132:135], v[164:167], v[196:199], v[132:135]
  v_cvt_pk_bf16_f32 v64, v64, v65
  v_cvt_pk_bf16_f32 v65, v66, v67
  ds_read_b128 v[216:219], v21 offset:320
  ds_read_b128 v[220:223], v21 offset:768
  ds_read_b128 v[156:159], v5 offset:23552
  s_waitcnt lgkmcnt(7)
  v_mfma_f32_16x16x32_bf16 v[72:75], v[168:171], v[200:203], v[72:75]
  v_fma_f32 v124, v212, v23, v124
  v_fma_f32 v125, v213, v23, v125
  v_mfma_f32_16x16x32_bf16 v[76:79], v[168:171], v[204:207], v[76:79]
  v_fma_f32 v126, v214, v23, v126
  v_fma_f32 v127, v215, v23, v127
  v_mul_f32 v68, v68, v124
  ds_read_b128 v[160:163], v5 offset:30720
  s_waitcnt lgkmcnt(7)
  v_mfma_f32_16x16x32_bf16 v[128:131], v[172:175], v[200:203], v[128:131]
  v_mul_f32 v69, v69, v125
  v_mul_f32 v70, v70, v126
  v_mfma_f32_16x16x32_bf16 v[132:135], v[172:175], v[204:207], v[132:135]
  v_mul_f32 v71, v71, v127
  v_cvt_pk_bf16_f32 v68, v68, v69
  v_cvt_pk_bf16_f32 v69, v70, v71
  ds_read_b128 v[164:167], v5 offset:46080
  s_waitcnt lgkmcnt(7)
  v_mfma_f32_16x16x32_bf16 v[80:83], v[144:147], v[176:179], v[80:83]
  v_mfma_f32_16x16x32_bf16 v[84:87], v[144:147], v[180:183], v[84:87]
  s_waitcnt lgkmcnt(3)
  v_fma_f32 v72, v216, v22, v72
  v_fma_f32 v73, v217, v22, v73
  ds_read_b128 v[168:171], v5 offset:53248
  v_mfma_f32_16x16x32_bf16 v[136:139], v[148:151], v[176:179], v[136:139]
  v_fma_f32 v74, v218, v22, v74
  v_fma_f32 v75, v219, v22, v75
  v_max_f32 v72, 0, v72
  v_mfma_f32_16x16x32_bf16 v[140:143], v[148:151], v[180:183], v[140:143]
  v_max_f32 v73, 0, v73
  v_max_f32 v74, 0, v74
  ds_read_b128 v[172:175], v6 offset:3072
  v_mfma_f32_16x16x32_bf16 v[80:83], v[152:155], v[184:187], v[80:83]
  v_max_f32 v75, 0, v75
  v_fma_f32 v76, v216, v23, v76
  v_fma_f32 v77, v217, v23, v77
  v_mfma_f32_16x16x32_bf16 v[84:87], v[152:155], v[188:191], v[84:87]
  v_fma_f32 v78, v218, v23, v78
  v_fma_f32 v79, v219, v23, v79
  s_waitcnt lgkmcnt(4)
  v_mfma_f32_16x16x32_bf16 v[136:139], v[156:159], v[184:187], v[136:139]
  v_max_f32 v76, 0, v76
  v_max_f32 v77, 0, v77
  v_max_f32 v78, 0, v78
  v_mfma_f32_16x16x32_bf16 v[140:143], v[156:159], v[188:191], v[140:143]
  v_max_f32 v79, 0, v79
  v_fma_f32 v128, v220, v22, v128
  s_waitcnt lgkmcnt(3)
  v_mfma_f32_16x16x32_bf16 v[80:83], v[160:163], v[192:195], v[80:83]
  v_fma_f32 v129, v221, v22, v129
  v_fma_f32 v130, v222, v22, v130
  v_fma_f32 v131, v223, v22, v131
  v_mfma_f32_16x16x32_bf16 v[84:87], v[160:163], v[196:199], v[84:87]
  v_mul_f32 v72, v72, v128
  v_mul_f32 v73, v73, v129
  s_waitcnt lgkmcnt(2)
  v_mfma_f32_16x16x32_bf16 v[136:139], v[164:167], v[192:195], v[136:139]
  v_mul_f32 v74, v74, v130
  v_mul_f32 v75, v75, v131
  v_cvt_pk_bf16_f32 v66, v72, v73
  v_mfma_f32_16x16x32_bf16 v[140:143], v[164:167], v[196:199], v[140:143]
  v_cvt_pk_bf16_f32 v67, v74, v75
  buffer_store_dwordx4 v[64:67], v1, s[12:15], s44 offen offset:2048 sc0 sc1
  ds_read_b128 v[208:211], v21 offset:384
  ds_read_b128 v[212:215], v21 offset:832
  s_waitcnt lgkmcnt(3)
  v_mfma_f32_16x16x32_bf16 v[80:83], v[168:171], v[200:203], v[80:83]
  v_fma_f32 v132, v220, v23, v132
  v_fma_f32 v133, v221, v23, v133
  v_fma_f32 v134, v222, v23, v134
  v_mfma_f32_16x16x32_bf16 v[84:87], v[168:171], v[204:207], v[84:87]
  v_fma_f32 v135, v223, v23, v135
  v_mul_f32 v76, v76, v132
  s_waitcnt lgkmcnt(2)
  v_mfma_f32_16x16x32_bf16 v[136:139], v[172:175], v[200:203], v[136:139]
  v_mul_f32 v77, v77, v133
  v_mul_f32 v78, v78, v134
  v_mul_f32 v79, v79, v135
  v_mfma_f32_16x16x32_bf16 v[140:143], v[172:175], v[204:207], v[140:143]
  v_cvt_pk_bf16_f32 v70, v76, v77
  v_cvt_pk_bf16_f32 v71, v78, v79
  buffer_store_dwordx4 v[68:71], v10, s[12:15], s44 offen offset:2048 sc0 sc1
  s_cmp_eq_u32 s34, 3
  s_cbranch_scc1 s4_gu_e2_6
  s_waitcnt lgkmcnt(0)
  s_nop 2
  v_pk_fma_f32 v[80:81], v[208:209], v[22:23], v[80:81] op_sel:[0,0,0] op_sel_hi:[1,0,1]
  v_pk_fma_f32 v[82:83], v[210:211], v[22:23], v[82:83] op_sel:[0,0,0] op_sel_hi:[1,0,1]
  v_max_f32 v80, 0, v80
  v_max_f32 v81, 0, v81
  v_max_f32 v82, 0, v82
  v_max_f32 v83, 0, v83
  v_pk_fma_f32 v[84:85], v[208:209], v[22:23], v[84:85] op_sel:[0,1,0] op_sel_hi:[1,1,1]
  v_pk_fma_f32 v[86:87], v[210:211], v[22:23], v[86:87] op_sel:[0,1,0] op_sel_hi:[1,1,1]
  v_max_f32 v84, 0, v84
  v_max_f32 v85, 0, v85
  v_max_f32 v86, 0, v86
  v_max_f32 v87, 0, v87
  v_pk_fma_f32 v[136:137], v[212:213], v[22:23], v[136:137] op_sel:[0,0,0] op_sel_hi:[1,0,1]
  v_pk_fma_f32 v[138:139], v[214:215], v[22:23], v[138:139] op_sel:[0,0,0] op_sel_hi:[1,0,1]
  v_pk_mul_f32 v[80:81], v[80:81], v[136:137]
  v_pk_mul_f32 v[82:83], v[82:83], v[138:139]
  v_cvt_pk_bf16_f32 v80, v80, v81
  v_cvt_pk_bf16_f32 v81, v82, v83
  v_pk_fma_f32 v[140:141], v[212:213], v[22:23], v[140:141] op_sel:[0,1,0] op_sel_hi:[1,1,1]
  v_pk_fma_f32 v[142:143], v[214:215], v[22:23], v[142:143] op_sel:[0,1,0] op_sel_hi:[1,1,1]
  v_pk_mul_f32 v[84:85], v[84:85], v[140:141]
  v_pk_mul_f32 v[86:87], v[86:87], v[142:143]
  v_cvt_pk_bf16_f32 v82, v84, v85
  v_cvt_pk_bf16_f32 v83, v86, v87
  s_nop 0
  v_permlane16_swap_b32 v80, v82
  v_permlane16_swap_b32 v81, v83
  s_nop 0
  buffer_store_dwordx4 v[80:83], v11, s[12:15], s45 offen sc0 sc1
s4_gu_e2_6:
s4_gu_end_1:
  s_endpgm
.globl s5_dn_kernel
.p2align 8
.type s5_dn_kernel,@function
s5_dn_kernel:
  s_cmp_ge_u32 s2, 256
  s_cbranch_scc1 s5_dn_end_1
  s_load_dwordx2 s[8:9], s[0:1], 72
  s_load_dwordx2 s[4:5], s[0:1], 56
  v_lshrrev_b32 v1, 6, v0
  v_and_b32 v0, 63, v0
  v_readfirstlane_b32 s26, v1
  v_lshlrev_b32 v1, 4, v0
  s_and_b32 s10, s2, 7
  s_lshr_b32 s11, s2, 3
  s_and_b32 s3, s10, 1
  s_lshl_b32 s24, s3, 1
  s_lshr_b32 s3, s10, 2
  s_add_u32 s24, s24, s3
  s_lshl_b32 s24, s24, 3
  s_and_b32 s3, s11, 7
  s_add_u32 s24, s24, s3
  s_lshl_b32 s24, s24, 2
  s_bfe_u32 s25, s10, 0x10001
  s_lshl_b32 s25, s25, 2
  s_lshr_b32 s3, s11, 3
  s_add_u32 s25, s25, s3
  s_cmp_lt_u32 s26, 4
  s_cbranch_scc1 s5_dn_c_2
  s_mul_i32 s28, s25, 276480
  s_add_u32 s28, s28, 0x1870000
  s_mul_i32 s30, s24, 55296
  s_add_u32 s30, s30, 0xc80000
  s_mov_b32 s57, s30
  s_cmp_eq_u32 s26, 5
  s_cbranch_scc1 s5_dn_sb_3
  v_add_u32 v8, 0, v1
  v_add_u32 v9, 0, v1
  v_add_u32 v10, 0, v1
  v_add_u32 v11, 0, v1
  v_add_u32 v12, 4096, v1
  v_add_u32 v13, 4096, v1
  v_add_u32 v14, 4096, v1
  v_add_u32 v15, 4096, v1
  v_add_u32 v16, 8192, v1
  s_mov_b32 s30, s28
  s_mov_b32 s27, 10240
  s_mov_b32 s29, 0
  s_branch s5_dn_sj_4
s5_dn_sb_3:
  v_add_u32 v8, 0, v1
  v_add_u32 v9, 0, v1
  v_add_u32 v10, 53248, v1
  v_add_u32 v11, 53248, v1
  v_add_u32 v12, 110592, v1
  v_add_u32 v13, 110592, v1
  v_add_u32 v14, 163840, v1
  v_add_u32 v15, 163840, v1
  v_add_u32 v16, 9216, v1
  s_mov_b32 s27, 2048
  s_mov_b32 s29, 9216
s5_dn_sj_4:
  s_waitcnt lgkmcnt(0)
  s_mov_b32 s12, s8
  s_and_b32 s13, s9, 0xffff
  s_mov_b32 s14, 0x1b00000
  s_mov_b32 s15, 0x00020000
  s_add_u32 m0, s29, 0
  s_nop 0
  buffer_load_dwordx4 v8, s[12:15], s30 offen offset:0 lds
  buffer_load_dwordx4 v9, s[12:15], s30 offen offset:1024 lds
  buffer_load_dwordx4 v10, s[12:15], s30 offen offset:2048 lds
  buffer_load_dwordx4 v11, s[12:15], s30 offen offset:3072 lds
  s_add_u32 m0, s29, 4096
  s_nop 0
  buffer_load_dwordx4 v12, s[12:15], s30 offen offset:0 lds
  buffer_load_dwordx4 v13, s[12:15], s30 offen offset:1024 lds
  buffer_load_dwordx4 v14, s[12:15], s30 offen offset:2048 lds
  buffer_load_dwordx4 v15, s[12:15], s30 offen offset:3072 lds
  s_add_u32 m0, s29, 8192
  s_nop 0
  buffer_load_dwordx4 v16, s[12:15], s28 offen offset:0 lds
  s_add_u32 m0, s29, 18432
  s_add_u32 s30, s30, s27
  s_add_u32 s28, s28, 10240
  buffer_load_dwordx4 v8, s[12:15], s30 offen offset:0 lds
  buffer_load_dwordx4 v9, s[12:15], s30 offen offset:1024 lds
  buffer_load_dwordx4 v10, s[12:15], s30 offen offset:2048 lds
  buffer_load_dwordx4 v11, s[12:15], s30 offen offset:3072 lds
  s_add_u32 m0, s29, 22528
  s_nop 0
  buffer_load_dwordx4 v12, s[12:15], s30 offen offset:0 lds
  buffer_load_dwordx4 v13, s[12:15], s30 offen offset:1024 lds
  buffer_load_dwordx4 v14, s[12:15], s30 offen offset:2048 lds
  buffer_load_dwordx4 v15, s[12:15], s30 offen offset:3072 lds
  s_add_u32 m0, s29, 26624
  s_nop 0
  buffer_load_dwordx4 v16, s[12:15], s28 offen offset:0 lds
  s_add_u32 m0, s29, 36864
  s_add_u32 s30, s30, s27
  s_add_u32 s28, s28, 10240
  buffer_load_dwordx4 v8, s[12:15], s30 offen offset:0 lds
  buffer_load_dwordx4 v9, s[12:15], s30 offen offset:1024 lds
  buffer_load_dwordx4 v10, s[12:15], s30 offen offset:2048 lds
  buffer_load_dwordx4 v11, s[12:15], s30 offen offset:3072 lds
  s_add_u32 m0, s29, 40960
  s_nop 0
  buffer_load_dwordx4 v12, s[12:15], s30 offen offset:0 lds
  buffer_load_dwordx4 v13, s[12:15], s30 offen offset:1024 lds
  buffer_load_dwordx4 v14, s[12:15], s30 offen offset:2048 lds
  buffer_load_dwordx4 v15, s[12:15], s30 offen offset:3072 lds
  s_add_u32 m0, s29, 45056
  s_nop 0
  buffer_load_dwordx4 v16, s[12:15], s28 offen offset:0 lds
  s_waitcnt vmcnt(18)
  s_barrier
  s_add_u32 m0, s29, 55296
  s_add_u32 s30, s30, s27
  s_add_u32 s28, s28, 10240
  buffer_load_dwordx4 v8, s[12:15], s30 offen offset:0 lds
  buffer_load_dwordx4 v9, s[12:15], s30 offen offset:1024 lds
  buffer_load_dwordx4 v10, s[12:15], s30 offen offset:2048 lds
  buffer_load_dwordx4 v11, s[12:15], s30 offen offset:3072 lds
  s_add_u32 m0, s29, 59392
  s_nop 0
  buffer_load_dwordx4 v12, s[12:15], s30 offen offset:0 lds
  buffer_load_dwordx4 v13, s[12:15], s30 offen offset:1024 lds
  buffer_load_dwordx4 v14, s[12:15], s30 offen offset:2048 lds
  buffer_load_dwordx4 v15, s[12:15], s30 offen offset:3072 lds
  s_add_u32 m0, s29, 63488
  s_nop 0
  buffer_load_dwordx4 v16, s[12:15], s28 offen offset:0 lds
  s_waitcnt vmcnt(18)
  s_barrier
  s_add_u32 m0, s29, 73728
  s_add_u32 s30, s30, s27
  s_add_u32 s28, s28, 10240
  buffer_load_dwordx4 v8, s[12:15], s30 offen offset:0 lds
  buffer_load_dwordx4 v9, s[12:15], s30 offen offset:1024 lds
  buffer_load_dwordx4 v10, s[12:15], s30 offen offset:2048 lds
  buffer_load_dwordx4 v11, s[12:15], s30 offen offset:3072 lds
  s_add_u32 m0, s29, 77824
  s_nop 0
  buffer_load_dwordx4 v12, s[12:15], s30 offen offset:0 lds
  buffer_load_dwordx4 v13, s[12:15], s30 offen offset:1024 lds
  buffer_load_dwordx4 v14, s[12:15], s30 offen offset:2048 lds
  buffer_load_dwordx4 v15, s[12:15], s30 offen offset:3072 lds
  s_add_u32 m0, s29, 81920
  s_nop 0
  buffer_load_dwordx4 v16, s[12:15], s28 offen offset:0 lds
  s_add_u32 m0, s29, 92160
  s_add_u32 s30, s30, s27
  s_add_u32 s28, s28, 10240
  buffer_load_dwordx4 v8, s[12:15], s30 offen offset:0 lds
  buffer_load_dwordx4 v9, s[12:15], s30 offen offset:1024 lds
  buffer_load_dwordx4 v10, s[12:15], s30 offen offset:2048 lds
  buffer_load_dwordx4 v11, s[12:15], s30 offen offset:3072 lds
  s_add_u32 m0, s29, 96256
  s_nop 0
  buffer_load_dwordx4 v12, s[12:15], s30 offen offset:0 lds
  buffer_load_dwordx4 v13, s[12:15], s30 offen offset:1024 lds
  buffer_load_dwordx4 v14, s[12:15], s30 offen offset:2048 lds
  buffer_load_dwordx4 v15, s[12:15], s30 offen offset:3072 lds
  s_add_u32 m0, s29, 100352
  s_nop 0
  buffer_load_dwordx4 v16, s[12:15], s28 offen offset:0 lds
  s_waitcnt vmcnt(27)
  s_barrier
  s_add_u32 m0, s29, 110592
  s_add_u32 s30, s30, s27
  s_add_u32 s28, s28, 10240
  buffer_load_dwordx4 v8, s[12:15], s30 offen offset:0 lds
  buffer_load_dwordx4 v9, s[12:15], s30 offen offset:1024 lds
  buffer_load_dwordx4 v10, s[12:15], s30 offen offset:2048 lds
  buffer_load_dwordx4 v11, s[12:15], s30 offen offset:3072 lds
  s_add_u32 m0, s29, 114688
  s_nop 0
  buffer_load_dwordx4 v12, s[12:15], s30 offen offset:0 lds
  buffer_load_dwordx4 v13, s[12:15], s30 offen offset:1024 lds
  buffer_load_dwordx4 v14, s[12:15], s30 offen offset:2048 lds
  buffer_load_dwordx4 v15, s[12:15], s30 offen offset:3072 lds
  s_add_u32 m0, s29, 118784
  s_nop 0
  buffer_load_dwordx4 v16, s[12:15], s28 offen offset:0 lds
  s_waitcnt vmcnt(27)
  s_barrier
  s_add_u32 m0, s29, 129024
  s_add_u32 s30, s30, s27
  s_add_u32 s28, s28, 10240
  buffer_load_dwordx4 v8, s[12:15], s30 offen offset:0 lds
  buffer_load_dwordx4 v9, s[12:15], s30 offen offset:1024 lds
  buffer_load_dwordx4 v10, s[12:15], s30 offen offset:2048 lds
  buffer_load_dwordx4 v11, s[12:15], s30 offen offset:3072 lds
  s_add_u32 m0, s29, 133120
  s_nop 0
  buffer_load_dwordx4 v12, s[12:15], s30 offen offset:0 lds
  buffer_load_dwordx4 v13, s[12:15], s30 offen offset:1024 lds
  buffer_load_dwordx4 v14, s[12:15], s30 offen offset:2048 lds
  buffer_load_dwordx4 v15, s[12:15], s30 offen offset:3072 lds
  s_add_u32 m0, s29, 137216
  s_nop 0
  buffer_load_dwordx4 v16, s[12:15], s28 offen offset:0 lds
  s_add_u32 m0, s29, 0
  s_add_u32 s30, s30, s27
  s_add_u32 s28, s28, 10240
  buffer_load_dwordx4 v8, s[12:15], s30 offen offset:0 lds
  buffer_load_dwordx4 v9, s[12:15], s30 offen offset:1024 lds
  buffer_load_dwordx4 v10, s[12:15], s30 offen offset:2048 lds
  buffer_load_dwordx4 v11, s[12:15], s30 offen offset:3072 lds
  s_add_u32 m0, s29, 4096
  s_nop 0
  buffer_load_dwordx4 v12, s[12:15], s30 offen offset:0 lds
  buffer_load_dwordx4 v13, s[12:15], s30 offen offset:1024 lds
  buffer_load_dwordx4 v14, s[12:15], s30 offen offset:2048 lds
  buffer_load_dwordx4 v15, s[12:15], s30 offen offset:3072 lds
  s_add_u32 m0, s29, 8192
  s_nop 0
  buffer_load_dwordx4 v16, s[12:15], s28 offen offset:0 lds
  s_waitcnt vmcnt(36)
  s_barrier
  s_add_u32 m0, s29, 18432
  s_add_u32 s30, s30, s27
  s_add_u32 s28, s28, 10240
  buffer_load_dwordx4 v8, s[12:15], s30 offen offset:0 lds
  buffer_load_dwordx4 v9, s[12:15], s30 offen offset:1024 lds
  buffer_load_dwordx4 v10, s[12:15], s30 offen offset:2048 lds
  buffer_load_dwordx4 v11, s[12:15], s30 offen offset:3072 lds
  s_add_u32 m0, s29, 22528
  s_nop 0
  buffer_load_dwordx4 v12, s[12:15], s30 offen offset:0 lds
  buffer_load_dwordx4 v13, s[12:15], s30 offen offset:1024 lds
  buffer_load_dwordx4 v14, s[12:15], s30 offen offset:2048 lds
  buffer_load_dwordx4 v15, s[12:15], s30 offen offset:3072 lds
  s_add_u32 m0, s29, 26624
  s_nop 0
  buffer_load_dwordx4 v16, s[12:15], s28 offen offset:0 lds
  s_waitcnt vmcnt(36)
  s_barrier
  s_add_u32 m0, s29, 36864
  s_add_u32 s30, s30, s27
  s_add_u32 s28, s28, 10240
  buffer_load_dwordx4 v8, s[12:15], s30 offen offset:0 lds
  buffer_load_dwordx4 v9, s[12:15], s30 offen offset:1024 lds
  buffer_load_dwordx4 v10, s[12:15], s30 offen offset:2048 lds
  buffer_load_dwordx4 v11, s[12:15], s30 offen offset:3072 lds
  s_add_u32 m0, s29, 40960
  s_nop 0
  buffer_load_dwordx4 v12, s[12:15], s30 offen offset:0 lds
  buffer_load_dwordx4 v13, s[12:15], s30 offen offset:1024 lds
  buffer_load_dwordx4 v14, s[12:15], s30 offen offset:2048 lds
  buffer_load_dwordx4 v15, s[12:15], s30 offen offset:3072 lds
  s_add_u32 m0, s29, 45056
  s_nop 0
  buffer_load_dwordx4 v16, s[12:15], s28 offen offset:0 lds
  s_waitcnt vmcnt(36)
  s_barrier
  s_add_u32 m0, s29, 55296
  s_add_u32 s30, s30, s27
  s_add_u32 s28, s28, 10240
  buffer_load_dwordx4 v8, s[12:15], s30 offen offset:0 lds
  buffer_load_dwordx4 v9, s[12:15], s30 offen offset:1024 lds
  buffer_load_dwordx4 v10, s[12:15], s30 offen offset:2048 lds
  buffer_load_dwordx4 v11, s[12:15], s30 offen offset:3072 lds
  s_add_u32 m0, s29, 59392
  s_nop 0
  buffer_load_dwordx4 v12, s[12:15], s30 offen offset:0 lds
  buffer_load_dwordx4 v13, s[12:15], s30 offen offset:1024 lds
  buffer_load_dwordx4 v14, s[12:15], s30 offen offset:2048 lds
  buffer_load_dwordx4 v15, s[12:15], s30 offen offset:3072 lds
  s_add_u32 m0, s29, 63488
  s_nop 0
  buffer_load_dwordx4 v16, s[12:15], s28 offen offset:0 lds
  s_waitcnt vmcnt(36)
  s_barrier
  s_add_u32 m0, s29, 73728
  s_add_u32 s30, s30, s27
  s_add_u32 s28, s28, 10240
  buffer_load_dwordx4 v8, s[12:15], s30 offen offset:0 lds
  buffer_load_dwordx4 v9, s[12:15], s30 offen offset:1024 lds
  buffer_load_dwordx4 v10, s[12:15], s30 offen offset:2048 lds
  buffer_load_dwordx4 v11, s[12:15], s30 offen offset:3072 lds
  s_add_u32 m0, s29, 77824
  s_nop 0
  buffer_load_dwordx4 v12, s[12:15], s30 offen offset:0 lds
  buffer_load_dwordx4 v13, s[12:15], s30 offen offset:1024 lds
  buffer_load_dwordx4 v14, s[12:15], s30 offen offset:2048 lds
  buffer_load_dwordx4 v15, s[12:15], s30 offen offset:3072 lds
  s_add_u32 m0, s29, 81920
  s_nop 0
  buffer_load_dwordx4 v16, s[12:15], s28 offen offset:0 lds
  s_waitcnt vmcnt(36)
  s_barrier
  s_add_u32 m0, s29, 92160
  s_add_u32 s30, s30, s27
  s_add_u32 s28, s28, 10240
  buffer_load_dwordx4 v8, s[12:15], s30 offen offset:0 lds
  buffer_load_dwordx4 v9, s[12:15], s30 offen offset:1024 lds
  buffer_load_dwordx4 v10, s[12:15], s30 offen offset:2048 lds
  buffer_load_dwordx4 v11, s[12:15], s30 offen offset:3072 lds
  s_add_u32 m0, s29, 96256
  s_nop 0
  buffer_load_dwordx4 v12, s[12:15], s30 offen offset:0 lds
  buffer_load_dwordx4 v13, s[12:15], s30 offen offset:1024 lds
  buffer_load_dwordx4 v14, s[12:15], s30 offen offset:2048 lds
  buffer_load_dwordx4 v15, s[12:15], s30 offen offset:3072 lds
  s_add_u32 m0, s29, 100352
  s_nop 0
  buffer_load_dwordx4 v16, s[12:15], s28 offen offset:0 lds
  s_waitcnt vmcnt(36)
  s_barrier
  s_add_u32 m0, s29, 110592
  s_add_u32 s30, s30, s27
  s_add_u32 s28, s28, 10240
  buffer_load_dwordx4 v8, s[12:15], s30 offen offset:0 lds
  buffer_load_dwordx4 v9, s[12:15], s30 offen offset:1024 lds
  buffer_load_dwordx4 v10, s[12:15], s30 offen offset:2048 lds
  buffer_load_dwordx4 v11, s[12:15], s30 offen offset:3072 lds
  s_add_u32 m0, s29, 114688
  s_nop 0
  buffer_load_dwordx4 v12, s[12:15], s30 offen offset:0 lds
  buffer_load_dwordx4 v13, s[12:15], s30 offen offset:1024 lds
  buffer_load_dwordx4 v14, s[12:15], s30 offen offset:2048 lds
  buffer_load_dwordx4 v15, s[12:15], s30 offen offset:3072 lds
  s_add_u32 m0, s29, 118784
  s_nop 0
  buffer_load_dwordx4 v16, s[12:15], s28 offen offset:0 lds
  s_waitcnt vmcnt(36)
  s_barrier
  s_add_u32 m0, s29, 129024
  s_add_u32 s30, s30, s27
  s_add_u32 s28, s28, 10240
  buffer_load_dwordx4 v8, s[12:15], s30 offen offset:0 lds
  buffer_load_dwordx4 v9, s[12:15], s30 offen offset:1024 lds
  buffer_load_dwordx4 v10, s[12:15], s30 offen offset:2048 lds
  buffer_load_dwordx4 v11, s[12:15], s30 offen offset:3072 lds
  s_add_u32 m0, s29, 133120
  s_nop 0
  buffer_load_dwordx4 v12, s[12:15], s30 offen offset:0 lds
  buffer_load_dwordx4 v13, s[12:15], s30 offen offset:1024 lds
  buffer_load_dwordx4 v14, s[12:15], s30 offen offset:2048 lds
  buffer_load_dwordx4 v15, s[12:15], s30 offen offset:3072 lds
  s_add_u32 m0, s29, 137216
  s_nop 0
  buffer_load_dwordx4 v16, s[12:15], s28 offen offset:0 lds
  s_waitcnt vmcnt(36)
  s_barrier
  s_add_u32 m0, s29, 0
  s_add_u32 s30, s30, s27
  s_add_u32 s28, s28, 10240
  buffer_load_dwordx4 v8, s[12:15], s30 offen offset:0 lds
  buffer_load_dwordx4 v9, s[12:15], s30 offen offset:1024 lds
  buffer_load_dwordx4 v10, s[12:15], s30 offen offset:2048 lds
  buffer_load_dwordx4 v11, s[12:15], s30 offen offset:3072 lds
  s_add_u32 m0, s29, 4096
  s_nop 0
  buffer_load_dwordx4 v12, s[12:15], s30 offen offset:0 lds
  buffer_load_dwordx4 v13, s[12:15], s30 offen offset:1024 lds
  buffer_load_dwordx4 v14, s[12:15], s30 offen offset:2048 lds
  buffer_load_dwordx4 v15, s[12:15], s30 offen offset:3072 lds
  s_add_u32 m0, s29, 8192
  s_nop 0
  buffer_load_dwordx4 v16, s[12:15], s28 offen offset:0 lds
  s_waitcnt vmcnt(36)
  s_barrier
  s_add_u32 m0, s29, 18432
  s_add_u32 s30, s30, s27
  s_add_u32 s28, s28, 10240
  buffer_load_dwordx4 v8, s[12:15], s30 offen offset:0 lds
  buffer_load_dwordx4 v9, s[12:15], s30 offen offset:1024 lds
  buffer_load_dwordx4 v10, s[12:15], s30 offen offset:2048 lds
  buffer_load_dwordx4 v11, s[12:15], s30 offen offset:3072 lds
  s_add_u32 m0, s29, 22528
  s_nop 0
  buffer_load_dwordx4 v12, s[12:15], s30 offen offset:0 lds
  buffer_load_dwordx4 v13, s[12:15], s30 offen offset:1024 lds
  buffer_load_dwordx4 v14, s[12:15], s30 offen offset:2048 lds
  buffer_load_dwordx4 v15, s[12:15], s30 offen offset:3072 lds
  s_add_u32 m0, s29, 26624
  s_nop 0
  buffer_load_dwordx4 v16, s[12:15], s28 offen offset:0 lds
  s_waitcnt vmcnt(36)
  s_barrier
  s_add_u32 m0, s29, 36864
  s_add_u32 s30, s30, s27
  s_add_u32 s28, s28, 10240
  buffer_load_dwordx4 v8, s[12:15], s30 offen offset:0 lds
  buffer_load_dwordx4 v9, s[12:15], s30 offen offset:1024 lds
  buffer_load_dwordx4 v10, s[12:15], s30 offen offset:2048 lds
  buffer_load_dwordx4 v11, s[12:15], s30 offen offset:3072 lds
  s_add_u32 m0, s29, 40960
  s_nop 0
  buffer_load_dwordx4 v12, s[12:15], s30 offen offset:0 lds
  buffer_load_dwordx4 v13, s[12:15], s30 offen offset:1024 lds
  buffer_load_dwordx4 v14, s[12:15], s30 offen offset:2048 lds
  buffer_load_dwordx4 v15, s[12:15], s30 offen offset:3072 lds
  s_add_u32 m0, s29, 45056
  s_nop 0
  buffer_load_dwordx4 v16, s[12:15], s28 offen offset:0 lds
  s_waitcnt vmcnt(36)
  s_barrier
  s_add_u32 m0, s29, 55296
  s_add_u32 s30, s30, s27
  s_add_u32 s28, s28, 10240
  buffer_load_dwordx4 v8, s[12:15], s30 offen offset:0 lds
  buffer_load_dwordx4 v9, s[12:15], s30 offen offset:1024 lds
  buffer_load_dwordx4 v10, s[12:15], s30 offen offset:2048 lds
  buffer_load_dwordx4 v11, s[12:15], s30 offen offset:3072 lds
  s_add_u32 m0, s29, 59392
  s_nop 0
  buffer_load_dwordx4 v12, s[12:15], s30 offen offset:0 lds
  buffer_load_dwordx4 v13, s[12:15], s30 offen offset:1024 lds
  buffer_load_dwordx4 v14, s[12:15], s30 offen offset:2048 lds
  buffer_load_dwordx4 v15, s[12:15], s30 offen offset:3072 lds
  s_add_u32 m0, s29, 63488
  s_nop 0
  buffer_load_dwordx4 v16, s[12:15], s28 offen offset:0 lds
  s_waitcnt vmcnt(36)
  s_barrier
  s_add_u32 m0, s29, 73728
  s_add_u32 s30, s30, s27
  s_add_u32 s28, s28, 10240
  buffer_load_dwordx4 v8, s[12:15], s30 offen offset:0 lds
  buffer_load_dwordx4 v9, s[12:15], s30 offen offset:1024 lds
  buffer_load_dwordx4 v10, s[12:15], s30 offen offset:2048 lds
  buffer_load_dwordx4 v11, s[12:15], s30 offen offset:3072 lds
  s_add_u32 m0, s29, 77824
  s_nop 0
  buffer_load_dwordx4 v12, s[12:15], s30 offen offset:0 lds
  buffer_load_dwordx4 v13, s[12:15], s30 offen offset:1024 lds
  buffer_load_dwordx4 v14, s[12:15], s30 offen offset:2048 lds
  buffer_load_dwordx4 v15, s[12:15], s30 offen offset:3072 lds
  s_add_u32 m0, s29, 81920
  s_nop 0
  buffer_load_dwordx4 v16, s[12:15], s28 offen offset:0 lds
  s_waitcnt vmcnt(36)
  s_barrier
  s_add_u32 m0, s29, 92160
  s_add_u32 s30, s30, s27
  s_add_u32 s28, s28, 10240
  buffer_load_dwordx4 v8, s[12:15], s30 offen offset:0 lds
  buffer_load_dwordx4 v9, s[12:15], s30 offen offset:1024 lds
  buffer_load_dwordx4 v10, s[12:15], s30 offen offset:2048 lds
  buffer_load_dwordx4 v11, s[12:15], s30 offen offset:3072 lds
  s_add_u32 m0, s29, 96256
  s_nop 0
  buffer_load_dwordx4 v12, s[12:15], s30 offen offset:0 lds
  buffer_load_dwordx4 v13, s[12:15], s30 offen offset:1024 lds
  buffer_load_dwordx4 v14, s[12:15], s30 offen offset:2048 lds
  buffer_load_dwordx4 v15, s[12:15], s30 offen offset:3072 lds
  s_add_u32 m0, s29, 100352
  s_nop 0
  buffer_load_dwordx4 v16, s[12:15], s28 offen offset:0 lds
  s_waitcnt vmcnt(36)
  s_barrier
  s_add_u32 m0, s29, 110592
  s_add_u32 s30, s30, s27
  s_add_u32 s28, s28, 10240
  buffer_load_dwordx4 v8, s[12:15], s30 offen offset:0 lds
  buffer_load_dwordx4 v9, s[12:15], s30 offen offset:1024 lds
  buffer_load_dwordx4 v10, s[12:15], s30 offen offset:2048 lds
  buffer_load_dwordx4 v11, s[12:15], s30 offen offset:3072 lds
  s_add_u32 m0, s29, 114688
  s_nop 0
  buffer_load_dwordx4 v12, s[12:15], s30 offen offset:0 lds
  buffer_load_dwordx4 v13, s[12:15], s30 offen offset:1024 lds
  buffer_load_dwordx4 v14, s[12:15], s30 offen offset:2048 lds
  buffer_load_dwordx4 v15, s[12:15], s30 offen offset:3072 lds
  s_add_u32 m0, s29, 118784
  s_nop 0
  buffer_load_dwordx4 v16, s[12:15], s28 offen offset:0 lds
  s_waitcnt vmcnt(36)
  s_barrier
  s_add_u32 m0, s29, 129024
  s_add_u32 s30, s30, s27
  s_add_u32 s28, s28, 10240
  buffer_load_dwordx4 v8, s[12:15], s30 offen offset:0 lds
  buffer_load_dwordx4 v9, s[12:15], s30 offen offset:1024 lds
  buffer_load_dwordx4 v10, s[12:15], s30 offen offset:2048 lds
  buffer_load_dwordx4 v11, s[12:15], s30 offen offset:3072 lds
  s_add_u32 m0, s29, 133120
  s_nop 0
  buffer_load_dwordx4 v12, s[12:15], s30 offen offset:0 lds
  buffer_load_dwordx4 v13, s[12:15], s30 offen offset:1024 lds
  buffer_load_dwordx4 v14, s[12:15], s30 offen offset:2048 lds
  buffer_load_dwordx4 v15, s[12:15], s30 offen offset:3072 lds
  s_add_u32 m0, s29, 137216
  s_nop 0
  buffer_load_dwordx4 v16, s[12:15], s28 offen offset:0 lds
  s_waitcnt vmcnt(36)
  s_barrier
  s_add_u32 m0, s29, 0
  s_add_u32 s30, s30, s27
  s_add_u32 s28, s28, 10240
  buffer_load_dwordx4 v8, s[12:15], s30 offen offset:0 lds
  buffer_load_dwordx4 v9, s[12:15], s30 offen offset:1024 lds
  buffer_load_dwordx4 v10, s[12:15], s30 offen offset:2048 lds
  buffer_load_dwordx4 v11, s[12:15], s30 offen offset:3072 lds
  s_add_u32 m0, s29, 4096
  s_nop 0
  buffer_load_dwordx4 v12, s[12:15], s30 offen offset:0 lds
  buffer_load_dwordx4 v13, s[12:15], s30 offen offset:1024 lds
  buffer_load_dwordx4 v14, s[12:15], s30 offen offset:2048 lds
  buffer_load_dwordx4 v15, s[12:15], s30 offen offset:3072 lds
  s_add_u32 m0, s29, 8192
  s_nop 0
  buffer_load_dwordx4 v16, s[12:15], s28 offen offset:0 lds
  s_waitcnt vmcnt(36)
  s_barrier
  s_add_u32 m0, s29, 18432
  s_add_u32 s30, s30, s27
  s_add_u32 s28, s28, 10240
  buffer_load_dwordx4 v8, s[12:15], s30 offen offset:0 lds
  buffer_load_dwordx4 v9, s[12:15], s30 offen offset:1024 lds
  buffer_load_dwordx4 v10, s[12:15], s30 offen offset:2048 lds
  buffer_load_dwordx4 v11, s[12:15], s30 offen offset:3072 lds
  s_add_u32 m0, s29, 22528
  s_nop 0
  buffer_load_dwordx4 v12, s[12:15], s30 offen offset:0 lds
  buffer_load_dwordx4 v13, s[12:15], s30 offen offset:1024 lds
  buffer_load_dwordx4 v14, s[12:15], s30 offen offset:2048 lds
  buffer_load_dwordx4 v15, s[12:15], s30 offen offset:3072 lds
  s_add_u32 m0, s29, 26624
  s_nop 0
  buffer_load_dwordx4 v16, s[12:15], s28 offen offset:0 lds
  s_waitcnt vmcnt(36)
  s_barrier
  s_add_u32 m0, s29, 36864
  s_add_u32 s30, s30, s27
  s_add_u32 s28, s28, 10240
  buffer_load_dwordx4 v8, s[12:15], s30 offen offset:0 lds
  buffer_load_dwordx4 v9, s[12:15], s30 offen offset:1024 lds
  buffer_load_dwordx4 v10, s[12:15], s30 offen offset:2048 lds
  buffer_load_dwordx4 v11, s[12:15], s30 offen offset:3072 lds
  s_add_u32 m0, s29, 40960
  s_nop 0
  buffer_load_dwordx4 v12, s[12:15], s30 offen offset:0 lds
  buffer_load_dwordx4 v13, s[12:15], s30 offen offset:1024 lds
  buffer_load_dwordx4 v14, s[12:15], s30 offen offset:2048 lds
  buffer_load_dwordx4 v15, s[12:15], s30 offen offset:3072 lds
  s_add_u32 m0, s29, 45056
  s_nop 0
  buffer_load_dwordx4 v16, s[12:15], s28 offen offset:0 lds
  s_cmp_eq_u32 s26, 5
  s_cbranch_scc1 s5_dn_tb_5
  s_waitcnt vmcnt(36)
  s_barrier
  s_waitcnt vmcnt(27)
  s_barrier
  s_waitcnt vmcnt(18)
  s_barrier
  s_waitcnt vmcnt(9)
  s_barrier
  s_waitcnt vmcnt(0)
  s_barrier
  s_waitcnt vmcnt(0)
  s_endpgm
s5_dn_tb_5:
  s_waitcnt vmcnt(36)
  s_barrier
  s_waitcnt vmcnt(27)
  s_barrier
  s_waitcnt vmcnt(18)
  s_barrier
  s_waitcnt vmcnt(9)
  s_barrier
  s_waitcnt vmcnt(0)
  s_barrier
  s_waitcnt vmcnt(0)
  s_endpgm
s5_dn_c_2:
  v_and_b32 v2, 15, v0
  v_lshrrev_b32 v3, 4, v0
  v_mov_b32 v4, v1
  v_add_u32 v5, 0x10000, v1
  v_add_u32 v6, 0x20000, v1
  s_mul_i32 s3, s26, 2048
  v_add_u32 v7, s3, v4
  v_add_u32 v8, s3, v5
  v_add_u32 v9, s3, v6
  s_add_u32 s24, s24, s26
  s_lshl_b32 s37, s24, 10
  s_add_u32 s37, s37, 0x1a90000
  v_lshlrev_b32 v20, 6, v2
  v_lshl_add_u32 v20, v3, 4, v20
  s_mul_i32 s40, s24, 20
  s_lshl_b32 s40, s40, 10
  s_add_u32 s40, s40, 0xa00000
  s_lshl_b32 s41, s25, 9
  s_add_u32 s41, s41, s40
  s_add_u32 s41, s41, 16384
  s_lshl_b32 s3, s25, 11
  s_add_u32 s40, s40, s3
  v_lshrrev_b32 v19, 1, v3
  v_lshlrev_b32 v19, 8, v19
  v_lshl_add_u32 v19, v2, 4, v19
  v_and_b32 v22, 1, v3
  v_lshl_add_u32 v19, v22, 3, v19
  s_waitcnt lgkmcnt(0)
  s_mov_b32 s12, s8
  s_and_b32 s13, s9, 0xffff
  s_mov_b32 s14, 0x1b00000
  s_mov_b32 s15, 0x00020000
  s_mov_b32 s16, s4
  s_and_b32 s17, s5, 0xffff
  s_mov_b32 s18, 0x280000
  s_mov_b32 s19, 0x00020000
  s_lshl_b32 s3, s24, 4
  v_add_u32 v18, s3, v2
  v_mul_u32_u24 v18, 1280, v18
  s_mul_i32 s3, s25, 160
  v_add_u32 v18, s3, v18
  v_lshl_add_u32 v21, v3, 3, v18
  v_and_b32 v22, 1, v3
  v_lshl_add_u32 v18, v22, 5, v18
  v_lshrrev_b32 v22, 1, v3
  v_lshl_add_u32 v18, v22, 4, v18
  s_barrier
  ds_read_b128 v[84:87], v7 offset:9216
  ds_read_b128 v[52:55], v4 offset:0
  ds_read_b128 v[56:59], v4 offset:1024
  ds_read_b128 v[60:63], v4 offset:2048
  ds_read_b128 v[64:67], v4 offset:3072
  ds_read_b128 v[68:71], v4 offset:4096
  ds_read_b128 v[88:91], v7 offset:10240
  s_waitcnt lgkmcnt(5)
  v_mfma_f32_16x16x32_bf16 v[32:35], v[52:55], v[84:87], 0
  ds_read_b128 v[72:75], v4 offset:5120
  s_waitcnt lgkmcnt(5)
  v_mfma_f32_16x16x32_bf16 v[36:39], v[56:59], v[84:87], 0
  ds_read_b128 v[76:79], v4 offset:6144
  s_waitcnt lgkmcnt(5)
  v_mfma_f32_16x16x32_bf16 v[40:43], v[60:63], v[84:87], 0
  ds_read_b128 v[80:83], v4 offset:7168
  s_waitcnt lgkmcnt(5)
  v_mfma_f32_16x16x32_bf16 v[44:47], v[64:67], v[84:87], 0
  ds_read_b128 v[52:55], v4 offset:8192
  s_waitcnt lgkmcnt(5)
  v_mfma_f32_16x16x32_bf16 v[48:51], v[68:71], v[84:87], 0
  ds_read_b128 v[56:59], v4 offset:17408
  s_barrier
  ds_read_b128 v[92:95], v7 offset:27648
  s_waitcnt lgkmcnt(5)
  v_mfma_f32_16x16x32_bf16 v[32:35], v[72:75], v[88:91], v[32:35]
  ds_read_b128 v[60:63], v4 offset:18432
  s_waitcnt lgkmcnt(5)
  v_mfma_f32_16x16x32_bf16 v[36:39], v[76:79], v[88:91], v[36:39]
  ds_read_b128 v[64:67], v4 offset:19456
  s_waitcnt lgkmcnt(5)
  v_mfma_f32_16x16x32_bf16 v[40:43], v[80:83], v[88:91], v[40:43]
  ds_read_b128 v[68:71], v4 offset:20480
  s_waitcnt lgkmcnt(5)
  v_mfma_f32_16x16x32_bf16 v[44:47], v[52:55], v[88:91], v[44:47]
  ds_read_b128 v[72:75], v4 offset:21504
  s_waitcnt lgkmcnt(5)
  v_mfma_f32_16x16x32_bf16 v[48:51], v[56:59], v[88:91], v[48:51]
  ds_read_b128 v[76:79], v4 offset:22528
  ds_read_b128 v[96:99], v7 offset:28672
  s_waitcnt lgkmcnt(5)
  v_mfma_f32_16x16x32_bf16 v[32:35], v[60:63], v[92:95], v[32:35]
  ds_read_b128 v[80:83], v4 offset:23552
  s_waitcnt lgkmcnt(5)
  v_mfma_f32_16x16x32_bf16 v[36:39], v[64:67], v[92:95], v[36:39]
  ds_read_b128 v[52:55], v4 offset:24576
  s_waitcnt lgkmcnt(5)
  v_mfma_f32_16x16x32_bf16 v[40:43], v[68:71], v[92:95], v[40:43]
  ds_read_b128 v[56:59], v4 offset:25600
  s_waitcnt lgkmcnt(5)
  v_mfma_f32_16x16x32_bf16 v[44:47], v[72:75], v[92:95], v[44:47]
  ds_read_b128 v[60:63], v4 offset:26624
  s_waitcnt lgkmcnt(5)
  v_mfma_f32_16x16x32_bf16 v[48:51], v[76:79], v[92:95], v[48:51]
  ds_read_b128 v[64:67], v4 offset:35840
  s_barrier
  ds_read_b128 v[84:87], v7 offset:46080
  s_waitcnt lgkmcnt(5)
  v_mfma_f32_16x16x32_bf16 v[32:35], v[80:83], v[96:99], v[32:35]
  ds_read_b128 v[68:71], v4 offset:36864
  s_waitcnt lgkmcnt(5)
  v_mfma_f32_16x16x32_bf16 v[36:39], v[52:55], v[96:99], v[36:39]
  ds_read_b128 v[72:75], v4 offset:37888
  s_waitcnt lgkmcnt(5)
  v_mfma_f32_16x16x32_bf16 v[40:43], v[56:59], v[96:99], v[40:43]
  ds_read_b128 v[76:79], v4 offset:38912
  s_waitcnt lgkmcnt(5)
  v_mfma_f32_16x16x32_bf16 v[44:47], v[60:63], v[96:99], v[44:47]
  ds_read_b128 v[80:83], v4 offset:39936
  s_waitcnt lgkmcnt(5)
  v_mfma_f32_16x16x32_bf16 v[48:51], v[64:67], v[96:99], v[48:51]
  ds_read_b128 v[52:55], v4 offset:40960
  ds_read_b128 v[88:91], v7 offset:47104
  s_waitcnt lgkmcnt(5)
  v_mfma_f32_16x16x32_bf16 v[32:35], v[68:71], v[84:87], v[32:35]
  ds_read_b128 v[56:59], v4 offset:41984
  s_waitcnt lgkmcnt(5)
  v_mfma_f32_16x16x32_bf16 v[36:39], v[72:75], v[84:87], v[36:39]
  ds_read_b128 v[60:63], v4 offset:43008
  s_waitcnt lgkmcnt(5)
  v_mfma_f32_16x16x32_bf16 v[40:43], v[76:79], v[84:87], v[40:43]
  ds_read_b128 v[64:67], v4 offset:44032
  s_waitcnt lgkmcnt(5)
  v_mfma_f32_16x16x32_bf16 v[44:47], v[80:83], v[84:87], v[44:47]
  ds_read_b128 v[68:71], v4 offset:45056
  s_waitcnt lgkmcnt(5)
  v_mfma_f32_16x16x32_bf16 v[48:51], v[52:55], v[84:87], v[48:51]
  ds_read_b128 v[72:75], v4 offset:54272
  s_barrier
  buffer_load_dwordx4 v[24:27], v20, s[12:15], s37 offen offset:0
  ds_read_b128 v[92:95], v7 offset:64512
  s_waitcnt lgkmcnt(5)
  v_mfma_f32_16x16x32_bf16 v[32:35], v[56:59], v[88:91], v[32:35]
  ds_read_b128 v[76:79], v4 offset:55296
  s_waitcnt lgkmcnt(5)
  v_mfma_f32_16x16x32_bf16 v[36:39], v[60:63], v[88:91], v[36:39]
  ds_read_b128 v[80:83], v4 offset:56320
  s_waitcnt lgkmcnt(5)
  v_mfma_f32_16x16x32_bf16 v[40:43], v[64:67], v[88:91], v[40:43]
  ds_read_b128 v[52:55], v4 offset:57344
  s_waitcnt lgkmcnt(5)
  v_mfma_f32_16x16x32_bf16 v[44:47], v[68:71], v[88:91], v[44:47]
  ds_read_b128 v[56:59], v4 offset:58368
  s_waitcnt lgkmcnt(5)
  v_mfma_f32_16x16x32_bf16 v[48:51], v[72:75], v[88:91], v[48:51]
  ds_read_b128 v[60:63], v4 offset:59392
  ds_read_b128 v[96:99], v8 offset:0
  s_waitcnt lgkmcnt(5)
  v_mfma_f32_16x16x32_bf16 v[32:35], v[76:79], v[92:95], v[32:35]
  ds_read_b128 v[64:67], v4 offset:60416
  s_waitcnt lgkmcnt(5)
  v_mfma_f32_16x16x32_bf16 v[36:39], v[80:83], v[92:95], v[36:39]
  ds_read_b128 v[68:71], v4 offset:61440
  s_waitcnt lgkmcnt(5)
  v_mfma_f32_16x16x32_bf16 v[40:43], v[52:55], v[92:95], v[40:43]
  ds_read_b128 v[72:75], v4 offset:62464
  s_waitcnt lgkmcnt(5)
  v_mfma_f32_16x16x32_bf16 v[44:47], v[56:59], v[92:95], v[44:47]
  ds_read_b128 v[76:79], v4 offset:63488
  s_waitcnt lgkmcnt(5)
  v_mfma_f32_16x16x32_bf16 v[48:51], v[60:63], v[92:95], v[48:51]
  ds_read_b128 v[80:83], v5 offset:7168
  s_barrier
  ds_read_b128 v[84:87], v8 offset:17408
  s_waitcnt lgkmcnt(5)
  v_mfma_f32_16x16x32_bf16 v[32:35], v[64:67], v[96:99], v[32:35]
  ds_read_b128 v[52:55], v5 offset:8192
  s_waitcnt lgkmcnt(5)
  v_mfma_f32_16x16x32_bf16 v[36:39], v[68:71], v[96:99], v[36:39]
  ds_read_b128 v[56:59], v5 offset:9216
  s_waitcnt lgkmcnt(5)
  v_mfma_f32_16x16x32_bf16 v[40:43], v[72:75], v[96:99], v[40:43]
  ds_read_b128 v[60:63], v5 offset:10240
  s_waitcnt lgkmcnt(5)
  v_mfma_f32_16x16x32_bf16 v[44:47], v[76:79], v[96:99], v[44:47]
  ds_read_b128 v[64:67], v5 offset:11264
  s_waitcnt lgkmcnt(5)
  v_mfma_f32_16x16x32_bf16 v[48:51], v[80:83], v[96:99], v[48:51]
  ds_read_b128 v[68:71], v5 offset:12288
  ds_read_b128 v[88:91], v8 offset:18432
  s_waitcnt lgkmcnt(5)
  v_mfma_f32_16x16x32_bf16 v[32:35], v[52:55], v[84:87], v[32:35]
  ds_read_b128 v[72:75], v5 offset:13312
  s_waitcnt lgkmcnt(5)
  v_mfma_f32_16x16x32_bf16 v[36:39], v[56:59], v[84:87], v[36:39]
  ds_read_b128 v[76:79], v5 offset:14336
  s_waitcnt lgkmcnt(5)
  v_mfma_f32_16x16x32_bf16 v[40:43], v[60:63], v[84:87], v[40:43]
  ds_read_b128 v[80:83], v5 offset:15360
  s_waitcnt lgkmcnt(5)
  v_mfma_f32_16x16x32_bf16 v[44:47], v[64:67], v[84:87], v[44:47]
  ds_read_b128 v[52:55], v5 offset:16384
  s_waitcnt lgkmcnt(5)
  v_mfma_f32_16x16x32_bf16 v[48:51], v[68:71], v[84:87], v[48:51]
  ds_read_b128 v[56:59], v5 offset:25600
  s_barrier
  ds_read_b128 v[92:95], v8 offset:35840
  s_waitcnt lgkmcnt(5)
  v_mfma_f32_16x16x32_bf16 v[32:35], v[72:75], v[88:91], v[32:35]
  ds_read_b128 v[60:63], v5 offset:26624
  s_waitcnt lgkmcnt(5)
  v_mfma_f32_16x16x32_bf16 v[36:39], v[76:79], v[88:91], v[36:39]
  ds_read_b128 v[64:67], v5 offset:27648
  s_waitcnt lgkmcnt(5)
  v_mfma_f32_16x16x32_bf16 v[40:43], v[80:83], v[88:91], v[40:43]
  ds_read_b128 v[68:71], v5 offset:28672
  s_waitcnt lgkmcnt(5)
  v_mfma_f32_16x16x32_bf16 v[44:47], v[52:55], v[88:91], v[44:47]
  ds_read_b128 v[72:75], v5 offset:29696
  s_waitcnt lgkmcnt(5)
  v_mfma_f32_16x16x32_bf16 v[48:51], v[56:59], v[88:91], v[48:51]
  ds_read_b128 v[76:79], v5 offset:30720
  ds_read_b128 v[96:99], v8 offset:36864
  s_waitcnt lgkmcnt(5)
  v_mfma_f32_16x16x32_bf16 v[32:35], v[60:63], v[92:95], v[32:35]
  ds_read_b128 v[80:83], v5 offset:31744
  s_waitcnt lgkmcnt(5)
  v_mfma_f32_16x16x32_bf16 v[36:39], v[64:67], v[92:95], v[36:39]
  ds_read_b128 v[52:55], v5 offset:32768
  s_waitcnt lgkmcnt(5)
  v_mfma_f32_16x16x32_bf16 v[40:43], v[68:71], v[92:95], v[40:43]
  ds_read_b128 v[56:59], v5 offset:33792
  s_waitcnt lgkmcnt(5)
  v_mfma_f32_16x16x32_bf16 v[44:47], v[72:75], v[92:95], v[44:47]
  ds_read_b128 v[60:63], v5 offset:34816
  s_waitcnt lgkmcnt(5)
  v_mfma_f32_16x16x32_bf16 v[48:51], v[76:79], v[92:95], v[48:51]
  ds_read_b128 v[64:67], v5 offset:44032
  s_barrier
  ds_read_b128 v[84:87], v8 offset:54272
  s_waitcnt lgkmcnt(5)
  v_mfma_f32_16x16x32_bf16 v[32:35], v[80:83], v[96:99], v[32:35]
  ds_read_b128 v[68:71], v5 offset:45056
  s_waitcnt lgkmcnt(5)
  v_mfma_f32_16x16x32_bf16 v[36:39], v[52:55], v[96:99], v[36:39]
  ds_read_b128 v[72:75], v5 offset:46080
  s_waitcnt lgkmcnt(5)
  v_mfma_f32_16x16x32_bf16 v[40:43], v[56:59], v[96:99], v[40:43]
  ds_read_b128 v[76:79], v5 offset:47104
  s_waitcnt lgkmcnt(5)
  v_mfma_f32_16x16x32_bf16 v[44:47], v[60:63], v[96:99], v[44:47]
  ds_read_b128 v[80:83], v5 offset:48128
  s_waitcnt lgkmcnt(5)
  v_mfma_f32_16x16x32_bf16 v[48:51], v[64:67], v[96:99], v[48:51]
  ds_read_b128 v[52:55], v5 offset:49152
  ds_read_b128 v[88:91], v8 offset:55296
  s_waitcnt lgkmcnt(5)
  v_mfma_f32_16x16x32_bf16 v[32:35], v[68:71], v[84:87], v[32:35]
  ds_read_b128 v[56:59], v5 offset:50176
  s_waitcnt lgkmcnt(5)
  v_mfma_f32_16x16x32_bf16 v[36:39], v[72:75], v[84:87], v[36:39]
  ds_read_b128 v[60:63], v5 offset:51200
  s_waitcnt lgkmcnt(5)
  v_mfma_f32_16x16x32_bf16 v[40:43], v[76:79], v[84:87], v[40:43]
  ds_read_b128 v[64:67], v5 offset:52224
  s_waitcnt lgkmcnt(5)
  v_mfma_f32_16x16x32_bf16 v[44:47], v[80:83], v[84:87], v[44:47]
  ds_read_b128 v[68:71], v5 offset:53248
  s_waitcnt lgkmcnt(5)
  v_mfma_f32_16x16x32_bf16 v[48:51], v[52:55], v[84:87], v[48:51]
  ds_read_b128 v[72:75], v5 offset:62464
  s_barrier
  ds_read_b128 v[92:95], v9 offset:7168
  s_waitcnt lgkmcnt(5)
  v_mfma_f32_16x16x32_bf16 v[32:35], v[56:59], v[88:91], v[32:35]
  ds_read_b128 v[76:79], v5 offset:63488
  s_waitcnt lgkmcnt(5)
  v_mfma_f32_16x16x32_bf16 v[36:39], v[60:63], v[88:91], v[36:39]
  ds_read_b128 v[80:83], v5 offset:64512
  s_waitcnt lgkmcnt(5)
  v_mfma_f32_16x16x32_bf16 v[40:43], v[64:67], v[88:91], v[40:43]
  ds_read_b128 v[52:55], v6 offset:0
  s_waitcnt lgkmcnt(5)
  v_mfma_f32_16x16x32_bf16 v[44:47], v[68:71], v[88:91], v[44:47]
  ds_read_b128 v[56:59], v6 offset:1024
  s_waitcnt lgkmcnt(5)
  v_mfma_f32_16x16x32_bf16 v[48:51], v[72:75], v[88:91], v[48:51]
  ds_read_b128 v[60:63], v6 offset:2048
  ds_read_b128 v[96:99], v9 offset:8192
  s_waitcnt lgkmcnt(5)
  v_mfma_f32_16x16x32_bf16 v[32:35], v[76:79], v[92:95], v[32:35]
  ds_read_b128 v[64:67], v6 offset:3072
  s_waitcnt lgkmcnt(5)
  v_mfma_f32_16x16x32_bf16 v[36:39], v[80:83], v[92:95], v[36:39]
  ds_read_b128 v[68:71], v6 offset:4096
  s_waitcnt lgkmcnt(5)
  v_mfma_f32_16x16x32_bf16 v[40:43], v[52:55], v[92:95], v[40:43]
  ds_read_b128 v[72:75], v6 offset:5120
  s_waitcnt lgkmcnt(5)
  v_mfma_f32_16x16x32_bf16 v[44:47], v[56:59], v[92:95], v[44:47]
  ds_read_b128 v[76:79], v6 offset:6144
  s_waitcnt lgkmcnt(5)
  v_mfma_f32_16x16x32_bf16 v[48:51], v[60:63], v[92:95], v[48:51]
  ds_read_b128 v[80:83], v6 offset:15360
  s_barrier
  ds_read_b128 v[84:87], v7 offset:9216
  s_waitcnt lgkmcnt(5)
  v_mfma_f32_16x16x32_bf16 v[32:35], v[64:67], v[96:99], v[32:35]
  ds_read_b128 v[52:55], v4 offset:0
  s_waitcnt lgkmcnt(5)
  v_mfma_f32_16x16x32_bf16 v[36:39], v[68:71], v[96:99], v[36:39]
  ds_read_b128 v[56:59], v4 offset:1024
  s_waitcnt lgkmcnt(5)
  v_mfma_f32_16x16x32_bf16 v[40:43], v[72:75], v[96:99], v[40:43]
  ds_read_b128 v[60:63], v4 offset:2048
  s_waitcnt lgkmcnt(5)
  v_mfma_f32_16x16x32_bf16 v[44:47], v[76:79], v[96:99], v[44:47]
  ds_read_b128 v[64:67], v4 offset:3072
  s_waitcnt lgkmcnt(5)
  v_mfma_f32_16x16x32_bf16 v[48:51], v[80:83], v[96:99], v[48:51]
  ds_read_b128 v[68:71], v4 offset:4096
  ds_read_b128 v[88:91], v7 offset:10240
  s_waitcnt lgkmcnt(5)
  v_mfma_f32_16x16x32_bf16 v[32:35], v[52:55], v[84:87], v[32:35]
  ds_read_b128 v[72:75], v4 offset:5120
  s_waitcnt lgkmcnt(5)
  v_mfma_f32_16x16x32_bf16 v[36:39], v[56:59], v[84:87], v[36:39]
  ds_read_b128 v[76:79], v4 offset:6144
  s_waitcnt lgkmcnt(5)
  v_mfma_f32_16x16x32_bf16 v[40:43], v[60:63], v[84:87], v[40:43]
  ds_read_b128 v[80:83], v4 offset:7168
  s_waitcnt lgkmcnt(5)
  v_mfma_f32_16x16x32_bf16 v[44:47], v[64:67], v[84:87], v[44:47]
  ds_read_b128 v[52:55], v4 offset:8192
  s_waitcnt lgkmcnt(5)
  v_mfma_f32_16x16x32_bf16 v[48:51], v[68:71], v[84:87], v[48:51]
  ds_read_b128 v[56:59], v4 offset:17408
  s_barrier
  ds_read_b128 v[92:95], v7 offset:27648
  s_waitcnt lgkmcnt(5)
  v_mfma_f32_16x16x32_bf16 v[32:35], v[72:75], v[88:91], v[32:35]
  ds_read_b128 v[60:63], v4 offset:18432
  s_waitcnt lgkmcnt(5)
  v_mfma_f32_16x16x32_bf16 v[36:39], v[76:79], v[88:91], v[36:39]
  ds_read_b128 v[64:67], v4 offset:19456
  s_waitcnt lgkmcnt(5)
  v_mfma_f32_16x16x32_bf16 v[40:43], v[80:83], v[88:91], v[40:43]
  ds_read_b128 v[68:71], v4 offset:20480
  s_waitcnt lgkmcnt(5)
  v_mfma_f32_16x16x32_bf16 v[44:47], v[52:55], v[88:91], v[44:47]
  ds_read_b128 v[72:75], v4 offset:21504
  s_waitcnt lgkmcnt(5)
  v_mfma_f32_16x16x32_bf16 v[48:51], v[56:59], v[88:91], v[48:51]
  ds_read_b128 v[76:79], v4 offset:22528
  ds_read_b128 v[96:99], v7 offset:28672
  s_waitcnt lgkmcnt(5)
  v_mfma_f32_16x16x32_bf16 v[32:35], v[60:63], v[92:95], v[32:35]
  ds_read_b128 v[80:83], v4 offset:23552
  s_waitcnt lgkmcnt(5)
  v_mfma_f32_16x16x32_bf16 v[36:39], v[64:67], v[92:95], v[36:39]
  ds_read_b128 v[52:55], v4 offset:24576
  s_waitcnt lgkmcnt(5)
  v_mfma_f32_16x16x32_bf16 v[40:43], v[68:71], v[92:95], v[40:43]
  ds_read_b128 v[56:59], v4 offset:25600
  s_waitcnt lgkmcnt(5)
  v_mfma_f32_16x16x32_bf16 v[44:47], v[72:75], v[92:95], v[44:47]
  ds_read_b128 v[60:63], v4 offset:26624
  s_waitcnt lgkmcnt(5)
  v_mfma_f32_16x16x32_bf16 v[48:51], v[76:79], v[92:95], v[48:51]
  ds_read_b128 v[64:67], v4 offset:35840
  s_barrier
  s_waitcnt vmcnt(0)
  v_add_f32 v30, v24, v26
  v_add_f32 v31, v25, v27
  v_mov_b32 v22, v30
  v_mov_b32 v23, v31
  s_nop 0
  v_permlane16_swap_b32 v30, v22
  v_permlane16_swap_b32 v31, v23
  s_nop 0
  v_add_f32 v30, v30, v22
  v_add_f32 v31, v31, v23
  v_mov_b32 v22, v30
  v_mov_b32 v23, v31
  s_nop 0
  v_permlane32_swap_b32 v30, v22
  v_permlane32_swap_b32 v31, v23
  s_nop 0
  v_add_f32 v30, v30, v22
  v_add_f32 v31, v31, v23
  v_mul_f32 v30, 0x3acccccd, v30
  v_mul_f32 v31, 0x3acccccd, v31
  v_fma_f32 v30, -v30, v30, v31
  v_max_f32 v30, 0, v30
  v_add_f32 v30, 0x3727c5ac, v30
  v_rcp_f32 v30, v30
  ds_read_b128 v[84:87], v7 offset:46080
  s_waitcnt lgkmcnt(5)
  v_mfma_f32_16x16x32_bf16 v[32:35], v[80:83], v[96:99], v[32:35]
  ds_read_b128 v[68:71], v4 offset:36864
  s_waitcnt lgkmcnt(5)
  v_mfma_f32_16x16x32_bf16 v[36:39], v[52:55], v[96:99], v[36:39]
  ds_read_b128 v[72:75], v4 offset:37888
  s_waitcnt lgkmcnt(5)
  v_mfma_f32_16x16x32_bf16 v[40:43], v[56:59], v[96:99], v[40:43]
  ds_read_b128 v[76:79], v4 offset:38912
  s_waitcnt lgkmcnt(5)
  v_mfma_f32_16x16x32_bf16 v[44:47], v[60:63], v[96:99], v[44:47]
  ds_read_b128 v[80:83], v4 offset:39936
  s_waitcnt lgkmcnt(5)
  v_mfma_f32_16x16x32_bf16 v[48:51], v[64:67], v[96:99], v[48:51]
  ds_read_b128 v[52:55], v4 offset:40960
  ds_read_b128 v[88:91], v7 offset:47104
  s_waitcnt lgkmcnt(5)
  v_mfma_f32_16x16x32_bf16 v[32:35], v[68:71], v[84:87], v[32:35]
  ds_read_b128 v[56:59], v4 offset:41984
  s_waitcnt lgkmcnt(5)
  v_mfma_f32_16x16x32_bf16 v[36:39], v[72:75], v[84:87], v[36:39]
  ds_read_b128 v[60:63], v4 offset:43008
  s_waitcnt lgkmcnt(5)
  v_mfma_f32_16x16x32_bf16 v[40:43], v[76:79], v[84:87], v[40:43]
  ds_read_b128 v[64:67], v4 offset:44032
  s_waitcnt lgkmcnt(5)
  v_mfma_f32_16x16x32_bf16 v[44:47], v[80:83], v[84:87], v[44:47]
  ds_read_b128 v[68:71], v4 offset:45056
  s_waitcnt lgkmcnt(5)
  v_mfma_f32_16x16x32_bf16 v[48:51], v[52:55], v[84:87], v[48:51]
  ds_read_b128 v[72:75], v4 offset:54272
  s_barrier
  ds_read_b128 v[92:95], v7 offset:64512
  s_waitcnt lgkmcnt(5)
  v_mfma_f32_16x16x32_bf16 v[32:35], v[56:59], v[88:91], v[32:35]
  ds_read_b128 v[76:79], v4 offset:55296
  s_waitcnt lgkmcnt(5)
  v_mfma_f32_16x16x32_bf16 v[36:39], v[60:63], v[88:91], v[36:39]
  ds_read_b128 v[80:83], v4 offset:56320
  s_waitcnt lgkmcnt(5)
  v_mfma_f32_16x16x32_bf16 v[40:43], v[64:67], v[88:91], v[40:43]
  ds_read_b128 v[52:55], v4 offset:57344
  s_waitcnt lgkmcnt(5)
  v_mfma_f32_16x16x32_bf16 v[44:47], v[68:71], v[88:91], v[44:47]
  ds_read_b128 v[56:59], v4 offset:58368
  s_waitcnt lgkmcnt(5)
  v_mfma_f32_16x16x32_bf16 v[48:51], v[72:75], v[88:91], v[48:51]
  ds_read_b128 v[60:63], v4 offset:59392
  ds_read_b128 v[96:99], v8 offset:0
  s_waitcnt lgkmcnt(5)
  v_mfma_f32_16x16x32_bf16 v[32:35], v[76:79], v[92:95], v[32:35]
  ds_read_b128 v[64:67], v4 offset:60416
  s_waitcnt lgkmcnt(5)
  v_mfma_f32_16x16x32_bf16 v[36:39], v[80:83], v[92:95], v[36:39]
  ds_read_b128 v[68:71], v4 offset:61440
  s_waitcnt lgkmcnt(5)
  v_mfma_f32_16x16x32_bf16 v[40:43], v[52:55], v[92:95], v[40:43]
  ds_read_b128 v[72:75], v4 offset:62464
  s_waitcnt lgkmcnt(5)
  v_mfma_f32_16x16x32_bf16 v[44:47], v[56:59], v[92:95], v[44:47]
  ds_read_b128 v[76:79], v4 offset:63488
  s_waitcnt lgkmcnt(5)
  v_mfma_f32_16x16x32_bf16 v[48:51], v[60:63], v[92:95], v[48:51]
  ds_read_b128 v[80:83], v5 offset:7168
  s_barrier
  buffer_load_dwordx4 v[10:13], v1, s[12:15], s40 offen offset:0
  ds_read_b128 v[84:87], v8 offset:17408
  s_waitcnt lgkmcnt(5)
  v_mfma_f32_16x16x32_bf16 v[32:35], v[64:67], v[96:99], v[32:35]
  ds_read_b128 v[52:55], v5 offset:8192
  s_waitcnt lgkmcnt(5)
  v_mfma_f32_16x16x32_bf16 v[36:39], v[68:71], v[96:99], v[36:39]
  ds_read_b128 v[56:59], v5 offset:9216
  s_waitcnt lgkmcnt(5)
  v_mfma_f32_16x16x32_bf16 v[40:43], v[72:75], v[96:99], v[40:43]
  ds_read_b128 v[60:63], v5 offset:10240
  s_waitcnt lgkmcnt(5)
  v_mfma_f32_16x16x32_bf16 v[44:47], v[76:79], v[96:99], v[44:47]
  ds_read_b128 v[64:67], v5 offset:11264
  s_waitcnt lgkmcnt(5)
  v_mfma_f32_16x16x32_bf16 v[48:51], v[80:83], v[96:99], v[48:51]
  ds_read_b128 v[68:71], v5 offset:12288
  ds_read_b128 v[88:91], v8 offset:18432
  s_waitcnt lgkmcnt(5)
  v_mfma_f32_16x16x32_bf16 v[32:35], v[52:55], v[84:87], v[32:35]
  ds_read_b128 v[72:75], v5 offset:13312
  s_waitcnt lgkmcnt(5)
  v_mfma_f32_16x16x32_bf16 v[36:39], v[56:59], v[84:87], v[36:39]
  ds_read_b128 v[76:79], v5 offset:14336
  s_waitcnt lgkmcnt(5)
  v_mfma_f32_16x16x32_bf16 v[40:43], v[60:63], v[84:87], v[40:43]
  ds_read_b128 v[80:83], v5 offset:15360
  s_waitcnt lgkmcnt(5)
  v_mfma_f32_16x16x32_bf16 v[44:47], v[64:67], v[84:87], v[44:47]
  ds_read_b128 v[52:55], v5 offset:16384
  s_waitcnt lgkmcnt(5)
  v_mfma_f32_16x16x32_bf16 v[48:51], v[68:71], v[84:87], v[48:51]
  ds_read_b128 v[56:59], v5 offset:25600
  s_barrier
  buffer_load_dwordx4 v[14:17], v1, s[12:15], s40 offen offset:1024
  ds_read_b128 v[92:95], v8 offset:35840
  s_waitcnt lgkmcnt(5)
  v_mfma_f32_16x16x32_bf16 v[32:35], v[72:75], v[88:91], v[32:35]
  ds_read_b128 v[60:63], v5 offset:26624
  s_waitcnt lgkmcnt(5)
  v_mfma_f32_16x16x32_bf16 v[36:39], v[76:79], v[88:91], v[36:39]
  ds_read_b128 v[64:67], v5 offset:27648
  s_waitcnt lgkmcnt(5)
  v_mfma_f32_16x16x32_bf16 v[40:43], v[80:83], v[88:91], v[40:43]
  ds_read_b128 v[68:71], v5 offset:28672
  s_waitcnt lgkmcnt(5)
  v_mfma_f32_16x16x32_bf16 v[44:47], v[52:55], v[88:91], v[44:47]
  ds_read_b128 v[72:75], v5 offset:29696
  s_waitcnt lgkmcnt(5)
  v_mfma_f32_16x16x32_bf16 v[48:51], v[56:59], v[88:91], v[48:51]
  ds_read_b128 v[76:79], v5 offset:30720
  ds_read_b128 v[96:99], v8 offset:36864
  s_waitcnt lgkmcnt(5)
  v_mfma_f32_16x16x32_bf16 v[32:35], v[60:63], v[92:95], v[32:35]
  ds_read_b128 v[80:83], v5 offset:31744
  s_waitcnt lgkmcnt(5)
  v_mfma_f32_16x16x32_bf16 v[36:39], v[64:67], v[92:95], v[36:39]
  ds_read_b128 v[52:55], v5 offset:32768
  s_waitcnt lgkmcnt(5)
  v_mfma_f32_16x16x32_bf16 v[40:43], v[68:71], v[92:95], v[40:43]
  ds_read_b128 v[56:59], v5 offset:33792
  s_waitcnt lgkmcnt(5)
  v_mfma_f32_16x16x32_bf16 v[44:47], v[72:75], v[92:95], v[44:47]
  ds_read_b128 v[60:63], v5 offset:34816
  s_waitcnt lgkmcnt(5)
  v_mfma_f32_16x16x32_bf16 v[48:51], v[76:79], v[92:95], v[48:51]
  ds_read_b128 v[64:67], v5 offset:44032
  s_barrier
  buffer_load_dwordx2 v[24:25], v19, s[12:15], s41 offen
  ds_read_b128 v[84:87], v8 offset:54272
  s_waitcnt lgkmcnt(5)
  v_mfma_f32_16x16x32_bf16 v[32:35], v[80:83], v[96:99], v[32:35]
  ds_read_b128 v[68:71], v5 offset:45056
  s_waitcnt lgkmcnt(5)
  v_mfma_f32_16x16x32_bf16 v[36:39], v[52:55], v[96:99], v[36:39]
  ds_read_b128 v[72:75], v5 offset:46080
  s_waitcnt lgkmcnt(5)
  v_mfma_f32_16x16x32_bf16 v[40:43], v[56:59], v[96:99], v[40:43]
  ds_read_b128 v[76:79], v5 offset:47104
  s_waitcnt lgkmcnt(5)
  v_mfma_f32_16x16x32_bf16 v[44:47], v[60:63], v[96:99], v[44:47]
  ds_read_b128 v[80:83], v5 offset:48128
  s_waitcnt lgkmcnt(5)
  v_mfma_f32_16x16x32_bf16 v[48:51], v[64:67], v[96:99], v[48:51]
  ds_read_b128 v[52:55], v5 offset:49152
  ds_read_b128 v[88:91], v8 offset:55296
  s_waitcnt lgkmcnt(5)
  v_mfma_f32_16x16x32_bf16 v[32:35], v[68:71], v[84:87], v[32:35]
  ds_read_b128 v[56:59], v5 offset:50176
  s_waitcnt lgkmcnt(5)
  v_mfma_f32_16x16x32_bf16 v[36:39], v[72:75], v[84:87], v[36:39]
  ds_read_b128 v[60:63], v5 offset:51200
  s_waitcnt lgkmcnt(5)
  v_mfma_f32_16x16x32_bf16 v[40:43], v[76:79], v[84:87], v[40:43]
  ds_read_b128 v[64:67], v5 offset:52224
  s_waitcnt lgkmcnt(5)
  v_mfma_f32_16x16x32_bf16 v[44:47], v[80:83], v[84:87], v[44:47]
  ds_read_b128 v[68:71], v5 offset:53248
  s_waitcnt lgkmcnt(5)
  v_mfma_f32_16x16x32_bf16 v[48:51], v[52:55], v[84:87], v[48:51]
  ds_read_b128 v[72:75], v5 offset:62464
  s_barrier
  ds_read_b128 v[92:95], v9 offset:7168
  s_waitcnt lgkmcnt(5)
  v_mfma_f32_16x16x32_bf16 v[32:35], v[56:59], v[88:91], v[32:35]
  ds_read_b128 v[76:79], v5 offset:63488
  s_waitcnt lgkmcnt(5)
  v_mfma_f32_16x16x32_bf16 v[36:39], v[60:63], v[88:91], v[36:39]
  ds_read_b128 v[80:83], v5 offset:64512
  s_waitcnt lgkmcnt(5)
  v_mfma_f32_16x16x32_bf16 v[40:43], v[64:67], v[88:91], v[40:43]
  ds_read_b128 v[52:55], v6 offset:0
  s_waitcnt lgkmcnt(5)
  v_mfma_f32_16x16x32_bf16 v[44:47], v[68:71], v[88:91], v[44:47]
  ds_read_b128 v[56:59], v6 offset:1024
  s_waitcnt lgkmcnt(5)
  v_mfma_f32_16x16x32_bf16 v[48:51], v[72:75], v[88:91], v[48:51]
  ds_read_b128 v[60:63], v6 offset:2048
  ds_read_b128 v[96:99], v9 offset:8192
  s_waitcnt lgkmcnt(5)
  v_mfma_f32_16x16x32_bf16 v[32:35], v[76:79], v[92:95], v[32:35]
  ds_read_b128 v[64:67], v6 offset:3072
  s_waitcnt lgkmcnt(5)
  v_mfma_f32_16x16x32_bf16 v[36:39], v[80:83], v[92:95], v[36:39]
  ds_read_b128 v[68:71], v6 offset:4096
  s_waitcnt lgkmcnt(5)
  v_mfma_f32_16x16x32_bf16 v[40:43], v[52:55], v[92:95], v[40:43]
  ds_read_b128 v[72:75], v6 offset:5120
  s_waitcnt lgkmcnt(5)
  v_mfma_f32_16x16x32_bf16 v[44:47], v[56:59], v[92:95], v[44:47]
  ds_read_b128 v[76:79], v6 offset:6144
  s_waitcnt lgkmcnt(5)
  v_mfma_f32_16x16x32_bf16 v[48:51], v[60:63], v[92:95], v[48:51]
  ds_read_b128 v[80:83], v6 offset:15360
  s_barrier
  ds_read_b128 v[84:87], v7 offset:9216
  s_waitcnt lgkmcnt(5)
  v_mfma_f32_16x16x32_bf16 v[32:35], v[64:67], v[96:99], v[32:35]
  ds_read_b128 v[52:55], v4 offset:0
  s_waitcnt lgkmcnt(5)
  v_mfma_f32_16x16x32_bf16 v[36:39], v[68:71], v[96:99], v[36:39]
  ds_read_b128 v[56:59], v4 offset:1024
  s_waitcnt lgkmcnt(5)
  v_mfma_f32_16x16x32_bf16 v[40:43], v[72:75], v[96:99], v[40:43]
  ds_read_b128 v[60:63], v4 offset:2048
  s_waitcnt lgkmcnt(5)
  v_mfma_f32_16x16x32_bf16 v[44:47], v[76:79], v[96:99], v[44:47]
  ds_read_b128 v[64:67], v4 offset:3072
  s_waitcnt lgkmcnt(5)
  v_mfma_f32_16x16x32_bf16 v[48:51], v[80:83], v[96:99], v[48:51]
  ds_read_b128 v[68:71], v4 offset:4096
  ds_read_b128 v[88:91], v7 offset:10240
  s_waitcnt lgkmcnt(5)
  v_mfma_f32_16x16x32_bf16 v[32:35], v[52:55], v[84:87], v[32:35]
  ds_read_b128 v[72:75], v4 offset:5120
  s_waitcnt lgkmcnt(5)
  v_mfma_f32_16x16x32_bf16 v[36:39], v[56:59], v[84:87], v[36:39]
  ds_read_b128 v[76:79], v4 offset:6144
  s_waitcnt lgkmcnt(5)
  v_mfma_f32_16x16x32_bf16 v[40:43], v[60:63], v[84:87], v[40:43]
  ds_read_b128 v[80:83], v4 offset:7168
  s_waitcnt lgkmcnt(5)
  v_mfma_f32_16x16x32_bf16 v[44:47], v[64:67], v[84:87], v[44:47]
  ds_read_b128 v[52:55], v4 offset:8192
  s_waitcnt lgkmcnt(5)
  v_mfma_f32_16x16x32_bf16 v[48:51], v[68:71], v[84:87], v[48:51]
  ds_read_b128 v[56:59], v4 offset:17408
  s_barrier
  ds_read_b128 v[92:95], v7 offset:27648
  s_waitcnt lgkmcnt(5)
  v_mfma_f32_16x16x32_bf16 v[32:35], v[72:75], v[88:91], v[32:35]
  ds_read_b128 v[60:63], v4 offset:18432
  s_waitcnt lgkmcnt(5)
  v_mfma_f32_16x16x32_bf16 v[36:39], v[76:79], v[88:91], v[36:39]
  ds_read_b128 v[64:67], v4 offset:19456
  s_waitcnt lgkmcnt(5)
  v_mfma_f32_16x16x32_bf16 v[40:43], v[80:83], v[88:91], v[40:43]
  ds_read_b128 v[68:71], v4 offset:20480
  s_waitcnt lgkmcnt(5)
  v_mfma_f32_16x16x32_bf16 v[44:47], v[52:55], v[88:91], v[44:47]
  ds_read_b128 v[72:75], v4 offset:21504
  s_waitcnt lgkmcnt(5)
  v_mfma_f32_16x16x32_bf16 v[48:51], v[56:59], v[88:91], v[48:51]
  ds_read_b128 v[76:79], v4 offset:22528
  ds_read_b128 v[96:99], v7 offset:28672
  s_waitcnt lgkmcnt(5)
  v_mfma_f32_16x16x32_bf16 v[32:35], v[60:63], v[92:95], v[32:35]
  ds_read_b128 v[80:83], v4 offset:23552
  s_waitcnt lgkmcnt(5)
  v_mfma_f32_16x16x32_bf16 v[36:39], v[64:67], v[92:95], v[36:39]
  ds_read_b128 v[52:55], v4 offset:24576
  s_waitcnt lgkmcnt(5)
  v_mfma_f32_16x16x32_bf16 v[40:43], v[68:71], v[92:95], v[40:43]
  ds_read_b128 v[56:59], v4 offset:25600
  s_waitcnt lgkmcnt(5)
  v_mfma_f32_16x16x32_bf16 v[44:47], v[72:75], v[92:95], v[44:47]
  ds_read_b128 v[60:63], v4 offset:26624
  s_waitcnt lgkmcnt(5)
  v_mfma_f32_16x16x32_bf16 v[48:51], v[76:79], v[92:95], v[48:51]
  ds_read_b128 v[64:67], v4 offset:35840
  s_barrier
  ds_read_b128 v[84:87], v7 offset:46080
  s_waitcnt lgkmcnt(5)
  v_mfma_f32_16x16x32_bf16 v[32:35], v[80:83], v[96:99], v[32:35]
  ds_read_b128 v[68:71], v4 offset:36864
  s_waitcnt lgkmcnt(5)
  v_mfma_f32_16x16x32_bf16 v[36:39], v[52:55], v[96:99], v[36:39]
  ds_read_b128 v[72:75], v4 offset:37888
  s_waitcnt lgkmcnt(5)
  v_mfma_f32_16x16x32_bf16 v[40:43], v[56:59], v[96:99], v[40:43]
  ds_read_b128 v[76:79], v4 offset:38912
  s_waitcnt lgkmcnt(5)
  v_mfma_f32_16x16x32_bf16 v[44:47], v[60:63], v[96:99], v[44:47]
  ds_read_b128 v[80:83], v4 offset:39936
  s_waitcnt lgkmcnt(5)
  v_mfma_f32_16x16x32_bf16 v[48:51], v[64:67], v[96:99], v[48:51]
  ds_read_b128 v[52:55], v4 offset:40960
  ds_read_b128 v[88:91], v7 offset:47104
  s_waitcnt lgkmcnt(5)
  v_mfma_f32_16x16x32_bf16 v[32:35], v[68:71], v[84:87], v[32:35]
  ds_read_b128 v[56:59], v4 offset:41984
  s_waitcnt lgkmcnt(5)
  v_mfma_f32_16x16x32_bf16 v[36:39], v[72:75], v[84:87], v[36:39]
  ds_read_b128 v[60:63], v4 offset:43008
  s_waitcnt lgkmcnt(5)
  v_mfma_f32_16x16x32_bf16 v[40:43], v[76:79], v[84:87], v[40:43]
  ds_read_b128 v[64:67], v4 offset:44032
  s_waitcnt lgkmcnt(5)
  v_mfma_f32_16x16x32_bf16 v[44:47], v[80:83], v[84:87], v[44:47]
  ds_read_b128 v[68:71], v4 offset:45056
  s_waitcnt lgkmcnt(5)
  v_mfma_f32_16x16x32_bf16 v[48:51], v[52:55], v[84:87], v[48:51]
  ds_read_b128 v[72:75], v4 offset:54272
  s_barrier
  ds_read_b128 v[92:95], v7 offset:64512
  s_waitcnt lgkmcnt(5)
  v_mfma_f32_16x16x32_bf16 v[32:35], v[56:59], v[88:91], v[32:35]
  ds_read_b128 v[76:79], v4 offset:55296
  s_waitcnt lgkmcnt(5)
  v_mfma_f32_16x16x32_bf16 v[36:39], v[60:63], v[88:91], v[36:39]
  ds_read_b128 v[80:83], v4 offset:56320
  s_waitcnt lgkmcnt(5)
  v_mfma_f32_16x16x32_bf16 v[40:43], v[64:67], v[88:91], v[40:43]
  ds_read_b128 v[52:55], v4 offset:57344
  s_waitcnt lgkmcnt(5)
  v_mfma_f32_16x16x32_bf16 v[44:47], v[68:71], v[88:91], v[44:47]
  ds_read_b128 v[56:59], v4 offset:58368
  s_waitcnt lgkmcnt(5)
  v_mfma_f32_16x16x32_bf16 v[48:51], v[72:75], v[88:91], v[48:51]
  ds_read_b128 v[60:63], v4 offset:59392
  ds_read_b128 v[96:99], v8 offset:0
  s_waitcnt lgkmcnt(5)
  v_mfma_f32_16x16x32_bf16 v[32:35], v[76:79], v[92:95], v[32:35]
  ds_read_b128 v[64:67], v4 offset:60416
  s_waitcnt lgkmcnt(5)
  v_mfma_f32_16x16x32_bf16 v[36:39], v[80:83], v[92:95], v[36:39]
  ds_read_b128 v[68:71], v4 offset:61440
  s_waitcnt lgkmcnt(5)
  v_mfma_f32_16x16x32_bf16 v[40:43], v[52:55], v[92:95], v[40:43]
  ds_read_b128 v[72:75], v4 offset:62464
  s_waitcnt lgkmcnt(5)
  v_mfma_f32_16x16x32_bf16 v[44:47], v[56:59], v[92:95], v[44:47]
  ds_read_b128 v[76:79], v4 offset:63488
  s_waitcnt lgkmcnt(5)
  v_mfma_f32_16x16x32_bf16 v[48:51], v[60:63], v[92:95], v[48:51]
  ds_read_b128 v[80:83], v5 offset:7168
  s_barrier
  ds_read_b128 v[84:87], v8 offset:17408
  s_waitcnt lgkmcnt(5)
  v_mfma_f32_16x16x32_bf16 v[32:35], v[64:67], v[96:99], v[32:35]
  ds_read_b128 v[52:55], v5 offset:8192
  s_waitcnt lgkmcnt(5)
  v_mfma_f32_16x16x32_bf16 v[36:39], v[68:71], v[96:99], v[36:39]
  ds_read_b128 v[56:59], v5 offset:9216
  s_waitcnt lgkmcnt(5)
  v_mfma_f32_16x16x32_bf16 v[40:43], v[72:75], v[96:99], v[40:43]
  ds_read_b128 v[60:63], v5 offset:10240
  s_waitcnt lgkmcnt(5)
  v_mfma_f32_16x16x32_bf16 v[44:47], v[76:79], v[96:99], v[44:47]
  ds_read_b128 v[64:67], v5 offset:11264
  s_waitcnt lgkmcnt(5)
  v_mfma_f32_16x16x32_bf16 v[48:51], v[80:83], v[96:99], v[48:51]
  ds_read_b128 v[68:71], v5 offset:12288
  ds_read_b128 v[88:91], v8 offset:18432
  s_waitcnt lgkmcnt(5)
  v_mfma_f32_16x16x32_bf16 v[32:35], v[52:55], v[84:87], v[32:35]
  ds_read_b128 v[72:75], v5 offset:13312
  s_waitcnt lgkmcnt(5)
  v_mfma_f32_16x16x32_bf16 v[36:39], v[56:59], v[84:87], v[36:39]
  ds_read_b128 v[76:79], v5 offset:14336
  s_waitcnt lgkmcnt(5)
  v_mfma_f32_16x16x32_bf16 v[40:43], v[60:63], v[84:87], v[40:43]
  ds_read_b128 v[80:83], v5 offset:15360
  s_waitcnt lgkmcnt(5)
  v_mfma_f32_16x16x32_bf16 v[44:47], v[64:67], v[84:87], v[44:47]
  ds_read_b128 v[52:55], v5 offset:16384
  s_waitcnt lgkmcnt(5)
  v_mfma_f32_16x16x32_bf16 v[48:51], v[68:71], v[84:87], v[48:51]
  ds_read_b128 v[56:59], v5 offset:25600
  s_barrier
  s_waitcnt vmcnt(0)
  s_bitcmp1_b32 s25, 0
  s_cselect_b64 vcc, -1, 0
  v_lshlrev_b32 v108, 16, v10
  v_and_b32 v109, 0xffff0000, v10
  v_lshlrev_b32 v110, 16, v11
  v_and_b32 v111, 0xffff0000, v11
  ds_read_b128 v[92:95], v8 offset:35840
  s_waitcnt lgkmcnt(5)
  v_mfma_f32_16x16x32_bf16 v[32:35], v[72:75], v[88:91], v[32:35]
  ds_read_b128 v[60:63], v5 offset:26624
  s_waitcnt lgkmcnt(5)
  v_mfma_f32_16x16x32_bf16 v[36:39], v[76:79], v[88:91], v[36:39]
  ds_read_b128 v[64:67], v5 offset:27648
  s_waitcnt lgkmcnt(5)
  v_mfma_f32_16x16x32_bf16 v[40:43], v[80:83], v[88:91], v[40:43]
  ds_read_b128 v[68:71], v5 offset:28672
  s_waitcnt lgkmcnt(5)
  v_mfma_f32_16x16x32_bf16 v[44:47], v[52:55], v[88:91], v[44:47]
  ds_read_b128 v[72:75], v5 offset:29696
  s_waitcnt lgkmcnt(5)
  v_mfma_f32_16x16x32_bf16 v[48:51], v[56:59], v[88:91], v[48:51]
  ds_read_b128 v[76:79], v5 offset:30720
  ds_read_b128 v[96:99], v8 offset:36864
  s_waitcnt lgkmcnt(5)
  v_mfma_f32_16x16x32_bf16 v[32:35], v[60:63], v[92:95], v[32:35]
  ds_read_b128 v[80:83], v5 offset:31744
  s_waitcnt lgkmcnt(5)
  v_mfma_f32_16x16x32_bf16 v[36:39], v[64:67], v[92:95], v[36:39]
  ds_read_b128 v[52:55], v5 offset:32768
  s_waitcnt lgkmcnt(5)
  v_mfma_f32_16x16x32_bf16 v[40:43], v[68:71], v[92:95], v[40:43]
  ds_read_b128 v[56:59], v5 offset:33792
  s_waitcnt lgkmcnt(5)
  v_mfma_f32_16x16x32_bf16 v[44:47], v[72:75], v[92:95], v[44:47]
  ds_read_b128 v[60:63], v5 offset:34816
  s_waitcnt lgkmcnt(5)
  v_mfma_f32_16x16x32_bf16 v[48:51], v[76:79], v[92:95], v[48:51]
  ds_read_b128 v[64:67], v5 offset:44032
  s_barrier
  v_lshlrev_b32 v112, 16, v12
  v_and_b32 v113, 0xffff0000, v12
  v_lshlrev_b32 v114, 16, v13
  v_and_b32 v115, 0xffff0000, v13
  ds_read_b128 v[84:87], v8 offset:54272
  s_waitcnt lgkmcnt(5)
  v_mfma_f32_16x16x32_bf16 v[32:35], v[80:83], v[96:99], v[32:35]
  ds_read_b128 v[68:71], v5 offset:45056
  s_waitcnt lgkmcnt(5)
  v_mfma_f32_16x16x32_bf16 v[36:39], v[52:55], v[96:99], v[36:39]
  ds_read_b128 v[72:75], v5 offset:46080
  s_waitcnt lgkmcnt(5)
  v_mfma_f32_16x16x32_bf16 v[40:43], v[56:59], v[96:99], v[40:43]
  ds_read_b128 v[76:79], v5 offset:47104
  s_waitcnt lgkmcnt(5)
  v_mfma_f32_16x16x32_bf16 v[44:47], v[60:63], v[96:99], v[44:47]
  ds_read_b128 v[80:83], v5 offset:48128
  s_waitcnt lgkmcnt(5)
  v_mfma_f32_16x16x32_bf16 v[48:51], v[64:67], v[96:99], v[48:51]
  ds_read_b128 v[52:55], v5 offset:49152
  ds_read_b128 v[88:91], v8 offset:55296
  s_waitcnt lgkmcnt(5)
  v_mfma_f32_16x16x32_bf16 v[32:35], v[68:71], v[84:87], v[32:35]
  ds_read_b128 v[56:59], v5 offset:50176
  s_waitcnt lgkmcnt(5)
  v_mfma_f32_16x16x32_bf16 v[36:39], v[72:75], v[84:87], v[36:39]
  ds_read_b128 v[60:63], v5 offset:51200
  s_waitcnt lgkmcnt(5)
  v_mfma_f32_16x16x32_bf16 v[40:43], v[76:79], v[84:87], v[40:43]
  ds_read_b128 v[64:67], v5 offset:52224
  s_waitcnt lgkmcnt(5)
  v_mfma_f32_16x16x32_bf16 v[44:47], v[80:83], v[84:87], v[44:47]
  ds_read_b128 v[68:71], v5 offset:53248
  s_waitcnt lgkmcnt(5)
  v_mfma_f32_16x16x32_bf16 v[48:51], v[52:55], v[84:87], v[48:51]
  ds_read_b128 v[72:75], v5 offset:62464
  s_barrier
  v_lshlrev_b32 v116, 16, v14
  v_and_b32 v117, 0xffff0000, v14
  v_lshlrev_b32 v118, 16, v15
  v_and_b32 v119, 0xffff0000, v15
  ds_read_b128 v[92:95], v9 offset:7168
  s_waitcnt lgkmcnt(5)
  v_mfma_f32_16x16x32_bf16 v[32:35], v[56:59], v[88:91], v[32:35]
  ds_read_b128 v[76:79], v5 offset:63488
  s_waitcnt lgkmcnt(5)
  v_mfma_f32_16x16x32_bf16 v[36:39], v[60:63], v[88:91], v[36:39]
  ds_read_b128 v[80:83], v5 offset:64512
  s_waitcnt lgkmcnt(5)
  v_mfma_f32_16x16x32_bf16 v[40:43], v[64:67], v[88:91], v[40:43]
  ds_read_b128 v[52:55], v6 offset:0
  s_waitcnt lgkmcnt(5)
  v_mfma_f32_16x16x32_bf16 v[44:47], v[68:71], v[88:91], v[44:47]
  ds_read_b128 v[56:59], v6 offset:1024
  s_waitcnt lgkmcnt(5)
  v_mfma_f32_16x16x32_bf16 v[48:51], v[72:75], v[88:91], v[48:51]
  ds_read_b128 v[60:63], v6 offset:2048
  ds_read_b128 v[96:99], v9 offset:8192
  s_waitcnt lgkmcnt(5)
  v_mfma_f32_16x16x32_bf16 v[32:35], v[76:79], v[92:95], v[32:35]
  ds_read_b128 v[64:67], v6 offset:3072
  s_waitcnt lgkmcnt(5)
  v_mfma_f32_16x16x32_bf16 v[36:39], v[80:83], v[92:95], v[36:39]
  ds_read_b128 v[68:71], v6 offset:4096
  s_waitcnt lgkmcnt(5)
  v_mfma_f32_16x16x32_bf16 v[40:43], v[52:55], v[92:95], v[40:43]
  ds_read_b128 v[72:75], v6 offset:5120
  s_waitcnt lgkmcnt(5)
  v_mfma_f32_16x16x32_bf16 v[44:47], v[56:59], v[92:95], v[44:47]
  ds_read_b128 v[76:79], v6 offset:6144
  s_waitcnt lgkmcnt(5)
  v_mfma_f32_16x16x32_bf16 v[48:51], v[60:63], v[92:95], v[48:51]
  ds_read_b128 v[80:83], v6 offset:15360
  s_barrier
  v_lshlrev_b32 v120, 16, v16
  v_and_b32 v121, 0xffff0000, v16
  v_lshlrev_b32 v122, 16, v17
  v_and_b32 v123, 0xffff0000, v17
  ds_read_b128 v[84:87], v7 offset:9216
  s_waitcnt lgkmcnt(5)
  v_mfma_f32_16x16x32_bf16 v[32:35], v[64:67], v[96:99], v[32:35]
  ds_read_b128 v[52:55], v4 offset:0
  s_waitcnt lgkmcnt(5)
  v_mfma_f32_16x16x32_bf16 v[36:39], v[68:71], v[96:99], v[36:39]
  ds_read_b128 v[56:59], v4 offset:1024
  s_waitcnt lgkmcnt(5)
  v_mfma_f32_16x16x32_bf16 v[40:43], v[72:75], v[96:99], v[40:43]
  ds_read_b128 v[60:63], v4 offset:2048
  s_waitcnt lgkmcnt(5)
  v_mfma_f32_16x16x32_bf16 v[44:47], v[76:79], v[96:99], v[44:47]
  ds_read_b128 v[64:67], v4 offset:3072
  s_waitcnt lgkmcnt(5)
  v_mfma_f32_16x16x32_bf16 v[48:51], v[80:83], v[96:99], v[48:51]
  ds_read_b128 v[68:71], v4 offset:4096
  ds_read_b128 v[88:91], v7 offset:10240
  s_waitcnt lgkmcnt(5)
  v_mfma_f32_16x16x32_bf16 v[32:35], v[52:55], v[84:87], v[32:35]
  ds_read_b128 v[72:75], v4 offset:5120
  s_waitcnt lgkmcnt(5)
  v_mfma_f32_16x16x32_bf16 v[36:39], v[56:59], v[84:87], v[36:39]
  ds_read_b128 v[76:79], v4 offset:6144
  s_waitcnt lgkmcnt(5)
  v_mfma_f32_16x16x32_bf16 v[40:43], v[60:63], v[84:87], v[40:43]
  ds_read_b128 v[80:83], v4 offset:7168
  s_waitcnt lgkmcnt(5)
  v_mfma_f32_16x16x32_bf16 v[44:47], v[64:67], v[84:87], v[44:47]
  ds_read_b128 v[52:55], v4 offset:8192
  s_waitcnt lgkmcnt(5)
  v_mfma_f32_16x16x32_bf16 v[48:51], v[68:71], v[84:87], v[48:51]
  ds_read_b128 v[56:59], v4 offset:17408
  s_barrier
  v_lshlrev_b32 v124, 16, v24
  v_and_b32 v125, 0xffff0000, v24
  v_lshlrev_b32 v126, 16, v25
  v_and_b32 v127, 0xffff0000, v25
  ds_read_b128 v[92:95], v7 offset:27648
  s_waitcnt lgkmcnt(5)
  v_mfma_f32_16x16x32_bf16 v[32:35], v[72:75], v[88:91], v[32:35]
  ds_read_b128 v[60:63], v4 offset:18432
  s_waitcnt lgkmcnt(5)
  v_mfma_f32_16x16x32_bf16 v[36:39], v[76:79], v[88:91], v[36:39]
  ds_read_b128 v[64:67], v4 offset:19456
  s_waitcnt lgkmcnt(5)
  v_mfma_f32_16x16x32_bf16 v[40:43], v[80:83], v[88:91], v[40:43]
  ds_read_b128 v[68:71], v4 offset:20480
  s_waitcnt lgkmcnt(5)
  v_mfma_f32_16x16x32_bf16 v[44:47], v[52:55], v[88:91], v[44:47]
  ds_read_b128 v[72:75], v4 offset:21504
  s_waitcnt lgkmcnt(5)
  v_mfma_f32_16x16x32_bf16 v[48:51], v[56:59], v[88:91], v[48:51]
  ds_read_b128 v[76:79], v4 offset:22528
  ds_read_b128 v[96:99], v7 offset:28672
  s_waitcnt lgkmcnt(5)
  v_mfma_f32_16x16x32_bf16 v[32:35], v[60:63], v[92:95], v[32:35]
  ds_read_b128 v[80:83], v4 offset:23552
  s_waitcnt lgkmcnt(5)
  v_mfma_f32_16x16x32_bf16 v[36:39], v[64:67], v[92:95], v[36:39]
  ds_read_b128 v[52:55], v4 offset:24576
  s_waitcnt lgkmcnt(5)
  v_mfma_f32_16x16x32_bf16 v[40:43], v[68:71], v[92:95], v[40:43]
  ds_read_b128 v[56:59], v4 offset:25600
  s_waitcnt lgkmcnt(5)
  v_mfma_f32_16x16x32_bf16 v[44:47], v[72:75], v[92:95], v[44:47]
  ds_read_b128 v[60:63], v4 offset:26624
  s_waitcnt lgkmcnt(5)
  v_mfma_f32_16x16x32_bf16 v[48:51], v[76:79], v[92:95], v[48:51]
  ds_read_b128 v[64:67], v4 offset:35840
  s_barrier
  ds_read_b128 v[84:87], v7 offset:46080
  s_waitcnt lgkmcnt(5)
  v_mfma_f32_16x16x32_bf16 v[32:35], v[80:83], v[96:99], v[32:35]
  ds_read_b128 v[68:71], v4 offset:36864
  s_waitcnt lgkmcnt(5)
  v_mfma_f32_16x16x32_bf16 v[36:39], v[52:55], v[96:99], v[36:39]
  ds_read_b128 v[72:75], v4 offset:37888
  s_waitcnt lgkmcnt(5)
  v_mfma_f32_16x16x32_bf16 v[40:43], v[56:59], v[96:99], v[40:43]
  ds_read_b128 v[76:79], v4 offset:38912
  s_waitcnt lgkmcnt(5)
  v_mfma_f32_16x16x32_bf16 v[44:47], v[60:63], v[96:99], v[44:47]
  ds_read_b128 v[80:83], v4 offset:39936
  s_waitcnt lgkmcnt(5)
  v_mfma_f32_16x16x32_bf16 v[48:51], v[64:67], v[96:99], v[48:51]
  ds_read_b128 v[52:55], v4 offset:40960
  ds_read_b128 v[88:91], v7 offset:47104
  s_waitcnt lgkmcnt(5)
  v_mfma_f32_16x16x32_bf16 v[32:35], v[68:71], v[84:87], v[32:35]
  ds_read_b128 v[56:59], v4 offset:41984
  s_waitcnt lgkmcnt(5)
  v_mfma_f32_16x16x32_bf16 v[36:39], v[72:75], v[84:87], v[36:39]
  ds_read_b128 v[60:63], v4 offset:43008
  s_waitcnt lgkmcnt(5)
  v_mfma_f32_16x16x32_bf16 v[40:43], v[76:79], v[84:87], v[40:43]
  ds_read_b128 v[64:67], v4 offset:44032
  s_waitcnt lgkmcnt(5)
  v_mfma_f32_16x16x32_bf16 v[44:47], v[80:83], v[84:87], v[44:47]
  ds_read_b128 v[68:71], v4 offset:45056
  s_waitcnt lgkmcnt(5)
  v_mfma_f32_16x16x32_bf16 v[48:51], v[52:55], v[84:87], v[48:51]
  ds_read_b128 v[72:75], v4 offset:54272
  s_waitcnt lgkmcnt(4)
  v_mfma_f32_16x16x32_bf16 v[32:35], v[56:59], v[88:91], v[32:35]
  s_waitcnt lgkmcnt(3)
  v_mfma_f32_16x16x32_bf16 v[36:39], v[60:63], v[88:91], v[36:39]
  s_waitcnt lgkmcnt(2)
  v_mfma_f32_16x16x32_bf16 v[40:43], v[64:67], v[88:91], v[40:43]
  s_waitcnt lgkmcnt(1)
  v_mfma_f32_16x16x32_bf16 v[44:47], v[68:71], v[88:91], v[44:47]
  s_waitcnt lgkmcnt(0)
  v_mfma_f32_16x16x32_bf16 v[48:51], v[72:75], v[88:91], v[48:51]
  s_nop 3
  v_pk_fma_f32 v[32:33], v[32:33], v[30:31], v[108:109] op_sel:[0,0,0] op_sel_hi:[1,0,1]
  v_pk_fma_f32 v[34:35], v[34:35], v[30:31], v[110:111] op_sel:[0,0,0] op_sel_hi:[1,0,1]
  v_cvt_pk_bf16_f32 v52, v32, v33
  v_cvt_pk_bf16_f32 v53, v34, v35
  v_pk_fma_f32 v[36:37], v[36:37], v[30:31], v[112:113] op_sel:[0,0,0] op_sel_hi:[1,0,1]
  v_pk_fma_f32 v[38:39], v[38:39], v[30:31], v[114:115] op_sel:[0,0,0] op_sel_hi:[1,0,1]
  v_cvt_pk_bf16_f32 v54, v36, v37
  v_cvt_pk_bf16_f32 v55, v38, v39
  v_pk_fma_f32 v[40:41], v[40:41], v[30:31], v[116:117] op_sel:[0,0,0] op_sel_hi:[1,0,1]
  v_pk_fma_f32 v[42:43], v[42:43], v[30:31], v[118:119] op_sel:[0,0,0] op_sel_hi:[1,0,1]
  v_cvt_pk_bf16_f32 v56, v40, v41
  v_cvt_pk_bf16_f32 v57, v42, v43
  v_pk_fma_f32 v[44:45], v[44:45], v[30:31], v[120:121] op_sel:[0,0,0] op_sel_hi:[1,0,1]
  v_pk_fma_f32 v[46:47], v[46:47], v[30:31], v[122:123] op_sel:[0,0,0] op_sel_hi:[1,0,1]
  v_cvt_pk_bf16_f32 v58, v44, v45
  v_cvt_pk_bf16_f32 v59, v46, v47
  v_pk_fma_f32 v[48:49], v[48:49], v[30:31], v[124:125] op_sel:[0,0,0] op_sel_hi:[1,0,1]
  v_pk_fma_f32 v[50:51], v[50:51], v[30:31], v[126:127] op_sel:[0,0,0] op_sel_hi:[1,0,1]
  v_cvt_pk_bf16_f32 v60, v48, v49
  v_cvt_pk_bf16_f32 v61, v50, v51
  buffer_store_dwordx2 v[60:61], v21, s[16:19], 0 offen offset:128
  v_permlane16_swap_b32 v52, v54
  v_permlane16_swap_b32 v53, v55
  v_permlane16_swap_b32 v56, v58
  v_permlane16_swap_b32 v57, v59
  s_nop 1
  buffer_store_dwordx4 v[52:55], v18, s[16:19], 0 offen offset:0
  buffer_store_dwordx4 v[56:59], v18, s[16:19], 0 offen offset:64
s5_dn_end_1:
  s_endpgm
s2_att_fb_6:
  s_mov_b32 s31, 1
  s_mov_b32 s32, 0
  v_mov_b32 v124, v2
  v_lshlrev_b32 v125, 3, v9
  v_xor_b32 v125, s30, v125
  v_add_u32 v125, v3, v125
  v_mov_b32 v6, 0xff800000
s2_att_fl_9:
  ds_read_b128 v[96:99], v124
  ds_read_b128 v[100:103], v124 offset:1024
  ds_read_b64 v[104:105], v125 offset:2048
  s_waitcnt lgkmcnt(0)
  v_mfma_f32_32x32x16_bf16 v[56:71], v[96:99], v[16:19], 0
  v_mfma_f32_32x32x8bf16_1k v[56:71], v[104:105], v[20:21], v[56:71]
  v_mfma_f32_32x32x16_bf16 v[72:87], v[100:103], v[16:19], 0
  v_mfma_f32_32x32x8bf16_1k v[72:87], v[104:105], v[22:23], v[72:87]
  v_add_u32 v124, 5120, v124
  v_add_u32 v125, 5120, v125
  s_nop 15
  v_max3_f32 v6, v6, v56, v57
  v_max3_f32 v6, v6, v58, v59
  v_max3_f32 v6, v6, v60, v61
  v_max3_f32 v6, v6, v62, v63
  v_max3_f32 v6, v6, v64, v65
  v_max3_f32 v6, v6, v66, v67
  v_max3_f32 v6, v6, v68, v69
  v_max3_f32 v6, v6, v70, v71
  v_max3_f32 v6, v6, v72, v73
  v_max3_f32 v6, v6, v74, v75
  v_max3_f32 v6, v6, v76, v77
  v_max3_f32 v6, v6, v78, v79
  v_max3_f32 v6, v6, v80, v81
  v_max3_f32 v6, v6, v82, v83
  v_max3_f32 v6, v6, v84, v85
  v_max3_f32 v6, v6, v86, v87
  s_add_u32 s32, s32, 1
  s_cmp_lt_u32 s32, 32
  s_cbranch_scc1 s2_att_fl_9
  v_mov_b32 v124, v2
  v_lshlrev_b32 v125, 3, v9
  v_xor_b32 v125, s30, v125
  v_add_u32 v125, v3, v125
  v_lshrrev_b32 v10, 2, v8
  v_lshrrev_b32 v11, 3, v8
  v_xor_b32 v11, v11, v10
  v_xor_b32 v11, v11, v9
  v_and_b32 v11, 1, v11
  v_lshl_add_u32 v10, v10, 1, v11
  v_and_b32 v11, 48, v3
  v_lshl_add_u32 v126, v10, 6, v11
  ds_read_b128 v[96:99], v124
  ds_read_b64 v[104:105], v125 offset:2048
  v_mov_b32 v40, 0
  v_mov_b32 v41, 0
  v_mov_b32 v42, 0
  v_mov_b32 v43, 0
  v_mov_b32 v44, 0
  v_mov_b32 v45, 0
  v_mov_b32 v46, 0
  v_mov_b32 v47, 0
  v_mov_b32 v48, 0
  v_mov_b32 v49, 0
  v_mov_b32 v50, 0
  v_mov_b32 v51, 0
  v_mov_b32 v52, 0
  v_mov_b32 v53, 0
  v_mov_b32 v54, 0
  v_mov_b32 v55, 0
  v_mov_b32 v88, 0
  v_mov_b32 v89, 0
  v_mov_b32 v90, 0
  v_mov_b32 v91, 0
  v_mov_b32 v92, 0
  v_mov_b32 v93, 0
  v_mov_b32 v94, 0
  v_mov_b32 v95, 0
  s_waitcnt lgkmcnt(0)
  v_mfma_f32_32x32x16_bf16 v[56:71], v[96:99], v[16:19], 0
  v_mfma_f32_32x32x8bf16_1k v[56:71], v[104:105], v[20:21], v[56:71]
  ds_read_b128 v[100:103], v124 offset:1024
  ds_read_b64 v[106:107], v125 offset:7168
  ds_read_b128 v[96:99], v124 offset:5120
  s_nop 13
  v_mov_b32 v7, v6
  s_mov_b32 s32, 0
  s_nop 0
  v_permlane32_swap_b32 v6, v7
  s_nop 1
  v_max_f32 v6, v6, v7
  v_sub_f32 v24, 0, v6
  v_sub_f32 v25, 0, v6
  v_mov_b64 v[26:27], v[24:25]
  v_mov_b64 v[28:29], v[24:25]
  v_mov_b64 v[30:31], v[24:25]
  v_mov_b64 v[32:33], v[24:25]
  v_mov_b64 v[34:35], v[24:25]
  v_mov_b64 v[36:37], v[24:25]
  v_mov_b64 v[38:39], v[24:25]
  v_pk_add_f32 v[56:57], v[56:57], v[24:25]
  v_pk_add_f32 v[58:59], v[58:59], v[24:25]
  v_pk_add_f32 v[60:61], v[60:61], v[24:25]
  v_pk_add_f32 v[62:63], v[62:63], v[24:25]
  v_pk_add_f32 v[64:65], v[64:65], v[24:25]
  v_pk_add_f32 v[66:67], v[66:67], v[24:25]
  v_pk_add_f32 v[68:69], v[68:69], v[24:25]
  v_pk_add_f32 v[70:71], v[70:71], v[24:25]
  s_waitcnt lgkmcnt(0)
s2_att_loop_3:
  s_setprio 1
  v_mfma_f32_32x32x16_bf16 v[72:87], v[100:103], v[16:19], v[24:39]
  ds_read_b128 v[100:103], v124 offset:6144
  v_exp_f32 v56, v56
  v_exp_f32 v57, v57
  v_exp_f32 v58, v58
  v_exp_f32 v59, v59
  s_waitcnt lgkmcnt(1)
  v_mfma_f32_32x32x16_bf16 v[40:55], v[120:123], v[92:95], v[40:55]
  s_mov_b64 exec, s[20:21]
  ds_read_b128 v[108:111], v126 offset:2560
  ds_read_b128 v[112:115], v126 offset:3200
  s_mov_b64 exec, -1
  v_exp_f32 v60, v60
  v_exp_f32 v61, v61
  v_exp_f32 v62, v62
  v_exp_f32 v63, v63
  v_mfma_f32_32x32x8bf16_1k v[72:87], v[104:105], v[22:23], v[72:87]
  v_exp_f32 v64, v64
  v_exp_f32 v65, v65
  v_exp_f32 v66, v66
  v_exp_f32 v67, v67
  v_mfma_f32_32x32x16_bf16 v[40:55], v[116:119], v[88:91], v[40:55]
  v_exp_f32 v68, v68
  v_exp_f32 v69, v69
  v_exp_f32 v70, v70
  v_exp_f32 v71, v71
  s_setprio 0
  v_cvt_pk_bf16_f32 v88, v56, v57
  v_cvt_pk_bf16_f32 v89, v58, v59
  v_cvt_pk_bf16_f32 v90, v60, v61
  v_cvt_pk_bf16_f32 v91, v62, v63
  v_cvt_pk_bf16_f32 v92, v64, v65
  v_cvt_pk_bf16_f32 v93, v66, v67
  v_cvt_pk_bf16_f32 v94, v68, v69
  v_cvt_pk_bf16_f32 v95, v70, v71
  s_setprio 1
  v_mfma_f32_32x32x16_bf16 v[56:71], v[96:99], v[16:19], v[24:39]
  ds_read_b128 v[96:99], v124 offset:10240
  ds_read_b64 v[104:105], v125 offset:12288
  v_exp_f32 v72, v72
  v_exp_f32 v73, v73
  v_exp_f32 v74, v74
  v_exp_f32 v75, v75
  s_waitcnt lgkmcnt(2)
  v_mfma_f32_32x32x16_bf16 v[40:55], v[112:115], v[92:95], v[40:55]
  s_mov_b64 exec, s[20:21]
  ds_read_b128 v[116:119], v126 offset:3840
  ds_read_b128 v[120:123], v126 offset:4480
  s_mov_b64 exec, -1
  v_exp_f32 v76, v76
  v_exp_f32 v77, v77
  v_exp_f32 v78, v78
  v_exp_f32 v79, v79
  v_mfma_f32_32x32x8bf16_1k v[56:71], v[106:107], v[20:21], v[56:71]
  v_exp_f32 v80, v80
  v_exp_f32 v81, v81
  v_exp_f32 v82, v82
  v_exp_f32 v83, v83
  v_mfma_f32_32x32x16_bf16 v[40:55], v[108:111], v[88:91], v[40:55]
  v_exp_f32 v84, v84
  v_exp_f32 v85, v85
  v_exp_f32 v86, v86
  v_exp_f32 v87, v87
  s_setprio 0
  v_cvt_pk_bf16_f32 v88, v72, v73
  v_cvt_pk_bf16_f32 v89, v74, v75
  v_cvt_pk_bf16_f32 v90, v76, v77
  v_cvt_pk_bf16_f32 v91, v78, v79
  v_cvt_pk_bf16_f32 v92, v80, v81
  v_cvt_pk_bf16_f32 v93, v82, v83
  v_cvt_pk_bf16_f32 v94, v84, v85
  v_cvt_pk_bf16_f32 v95, v86, v87
  s_setprio 1
  v_mfma_f32_32x32x16_bf16 v[72:87], v[100:103], v[16:19], v[24:39]
  ds_read_b128 v[100:103], v124 offset:11264
  v_exp_f32 v56, v56
  v_exp_f32 v57, v57
  v_exp_f32 v58, v58
  v_exp_f32 v59, v59
  s_waitcnt lgkmcnt(1)
  v_mfma_f32_32x32x16_bf16 v[40:55], v[120:123], v[92:95], v[40:55]
  s_mov_b64 exec, s[20:21]
  ds_read_b128 v[108:111], v126 offset:7680
  ds_read_b128 v[112:115], v126 offset:8320
  s_mov_b64 exec, -1
  v_exp_f32 v60, v60
  v_exp_f32 v61, v61
  v_exp_f32 v62, v62
  v_exp_f32 v63, v63
  v_mfma_f32_32x32x8bf16_1k v[72:87], v[106:107], v[22:23], v[72:87]
  v_exp_f32 v64, v64
  v_exp_f32 v65, v65
  v_exp_f32 v66, v66
  v_exp_f32 v67, v67
  v_mfma_f32_32x32x16_bf16 v[40:55], v[116:119], v[88:91], v[40:55]
  v_exp_f32 v68, v68
  v_exp_f32 v69, v69
  v_exp_f32 v70, v70
  v_exp_f32 v71, v71
  s_setprio 0
  v_cvt_pk_bf16_f32 v88, v56, v57
  v_cvt_pk_bf16_f32 v89, v58, v59
  v_cvt_pk_bf16_f32 v90, v60, v61
  v_cvt_pk_bf16_f32 v91, v62, v63
  v_cvt_pk_bf16_f32 v92, v64, v65
  v_cvt_pk_bf16_f32 v93, v66, v67
  v_cvt_pk_bf16_f32 v94, v68, v69
  v_cvt_pk_bf16_f32 v95, v70, v71
  s_setprio 1
  v_mfma_f32_32x32x16_bf16 v[56:71], v[96:99], v[16:19], v[24:39]
  ds_read_b128 v[96:99], v124 offset:15360
  ds_read_b64 v[106:107], v125 offset:17408
  v_exp_f32 v72, v72
  v_exp_f32 v73, v73
  v_exp_f32 v74, v74
  v_exp_f32 v75, v75
  s_waitcnt lgkmcnt(2)
  v_mfma_f32_32x32x16_bf16 v[40:55], v[112:115], v[92:95], v[40:55]
  s_mov_b64 exec, s[20:21]
  ds_read_b128 v[116:119], v126 offset:8960
  ds_read_b128 v[120:123], v126 offset:9600
  s_mov_b64 exec, -1
  v_exp_f32 v76, v76
  v_exp_f32 v77, v77
  v_exp_f32 v78, v78
  v_exp_f32 v79, v79
  v_mfma_f32_32x32x8bf16_1k v[56:71], v[104:105], v[20:21], v[56:71]
  v_exp_f32 v80, v80
  v_exp_f32 v81, v81
  v_exp_f32 v82, v82
  v_exp_f32 v83, v83
  v_mfma_f32_32x32x16_bf16 v[40:55], v[108:111], v[88:91], v[40:55]
  v_exp_f32 v84, v84
  v_exp_f32 v85, v85
  v_exp_f32 v86, v86
  v_exp_f32 v87, v87
  s_setprio 0
  v_add_u32 v124, 10240, v124
  v_add_u32 v125, 10240, v125
  v_add_u32 v126, 10240, v126
  v_cvt_pk_bf16_f32 v88, v72, v73
  v_cvt_pk_bf16_f32 v89, v74, v75
  v_cvt_pk_bf16_f32 v90, v76, v77
  v_cvt_pk_bf16_f32 v91, v78, v79
  v_cvt_pk_bf16_f32 v92, v80, v81
  v_cvt_pk_bf16_f32 v93, v82, v83
  v_cvt_pk_bf16_f32 v94, v84, v85
  v_cvt_pk_bf16_f32 v95, v86, v87
  s_add_u32 s32, s32, 1
  s_cmp_lt_u32 s32, 16
  s_cbranch_scc1 s2_att_loop_3
  s_branch s2_att_fin_7
.section .rodata,"a"
.p2align 6
.amdhsa_kernel s1_qkv_kernel
  .amdhsa_next_free_vgpr 232
  .amdhsa_next_free_sgpr 102
  .amdhsa_accum_offset 232
  .amdhsa_group_segment_fixed_size 0
  .amdhsa_kernarg_size 80
  .amdhsa_user_sgpr_count 2
  .amdhsa_user_sgpr_kernarg_segment_ptr 1
  .amdhsa_system_sgpr_workgroup_id_x 1
.end_amdhsa_kernel
.p2align 6
.amdhsa_kernel s2_att_kernel
  .amdhsa_next_free_vgpr 168
  .amdhsa_next_free_sgpr 102
  .amdhsa_accum_offset 168
  .amdhsa_group_segment_fixed_size 0
  .amdhsa_kernarg_size 80
  .amdhsa_user_sgpr_count 2
  .amdhsa_user_sgpr_kernarg_segment_ptr 1
  .amdhsa_system_sgpr_workgroup_id_x 1
.end_amdhsa_kernel
.p2align 6
.amdhsa_kernel s3_wo_kernel
  .amdhsa_next_free_vgpr 128
  .amdhsa_next_free_sgpr 102
  .amdhsa_accum_offset 128
  .amdhsa_group_segment_fixed_size 0
  .amdhsa_kernarg_size 80
  .amdhsa_user_sgpr_count 2
  .amdhsa_user_sgpr_kernarg_segment_ptr 1
  .amdhsa_system_sgpr_workgroup_id_x 1
.end_amdhsa_kernel
.p2align 6
.amdhsa_kernel s4_gu_kernel
  .amdhsa_next_free_vgpr 240
  .amdhsa_next_free_sgpr 102
  .amdhsa_accum_offset 240
  .amdhsa_group_segment_fixed_size 0
  .amdhsa_kernarg_size 80
  .amdhsa_user_sgpr_count 2
  .amdhsa_user_sgpr_kernarg_segment_ptr 1
  .amdhsa_system_sgpr_workgroup_id_x 1
.end_amdhsa_kernel
.p2align 6
.amdhsa_kernel s5_dn_kernel
  .amdhsa_next_free_vgpr 128
  .amdhsa_next_free_sgpr 102
  .amdhsa_accum_offset 128
  .amdhsa_group_segment_fixed_size 0
  .amdhsa_kernarg_size 80
  .amdhsa_user_sgpr_count 2
  .amdhsa_user_sgpr_kernarg_segment_ptr 1
  .amdhsa_system_sgpr_workgroup_id_x 1
.end_amdhsa_kernel
```
